```python
import torch

def _softmax(x, axis=-1):
    return torch.softmax(x, dim=axis)

def _gelu(x):
    return torch.nn.functional.gelu(x, approximate='tanh')

def _silu(x):
    return torch.nn.functional.silu(x)

def _sigmoid(x):
    return torch.sigmoid(x)

def _layernorm(x, axis=-1, eps=1e-05):
    m = x.mean(dim=axis, keepdim=True)
    v = x.var(dim=axis, keepdim=True, unbiased=False)
    return (x - m) / torch.sqrt(v + eps)

def _scatter_add(tgt, idx, src, axis=0):
    return tgt.clone().index_add_(axis, idx, src)

def _segment_sum(src, seg, n):
    out = torch.zeros((n,) + src.shape[1:], dtype=src.dtype)
    return out.index_add_(0, seg, src)

def _pad(x, pw):
    flat = tuple((v for pair in reversed(pw) for v in pair))
    return torch.nn.functional.pad(x, flat)
kernel_name = 'gated_mix__memory_aug_recurrent_mem_tr__glu_gated_geglu__prompt'

def setup_inputs():

    _w = lambda a: (lambda t: t.to(torch.bfloat16) if t.is_floating_point() else t)(torch.as_tensor(a))

    def _A_setup():
        B, S, Dm = (1, 2048, 576)
        H, Dh = (32, 128)
        M, seg = (8, 32)
        seg = min(seg, S)
        S = S // seg * seg
        return {'x': _w((lambda *s: torch.randn(*s, dtype=torch.bfloat16) * 0.05)(B, S, Dm)), 'mem0': _w((lambda *s: torch.randn(*s, dtype=torch.bfloat16) * 0.4)(B, M, Dm)), 'Wq': _w((lambda *s: torch.randn(*s, dtype=torch.bfloat16) * 6.4)(Dm, H, Dh) * Dm ** (-0.5)), 'Wk': _w((lambda *s: torch.randn(*s, dtype=torch.bfloat16) * 6.4)(Dm, H, Dh) * Dm ** (-0.5)), 'Wv': _w((lambda *s: torch.randn(*s, dtype=torch.bfloat16) * 0.4)(Dm, H, Dh) * Dm ** (-0.5)), 'Wo': _w((lambda *s: torch.randn(*s, dtype=torch.bfloat16) * 0.4)(H, Dh, Dm) * (H * Dh) ** (-0.5)), 'seg_len': seg}
    _A_in = _A_setup()

    def _B_setup():
        B, S, Dm, Df = (1, 2048, 576, 4608)
        return {'x': _w((lambda *s: torch.randn(*s, dtype=torch.bfloat16) * 0.05)(B, S, Dm)), 'w_gate': _w((lambda *s: torch.randn(*s, dtype=torch.bfloat16) * 1.6)(Dm, Df) * Dm ** (-0.5)), 'w_up': _w((lambda *s: torch.randn(*s, dtype=torch.bfloat16) * 1.6)(Dm, Df) * Dm ** (-0.5)), 'w_down': _w((lambda *s: torch.randn(*s, dtype=torch.bfloat16) * 1.6)(Df, Dm) * Df ** (-0.5))}
    _B_in = _B_setup()
    return {'A_x': _A_in['x'], 'A_mem0': _A_in['mem0'], 'A_Wq': _A_in['Wq'], 'A_Wk': _A_in['Wk'], 'A_Wv': _A_in['Wv'], 'A_Wo': _A_in['Wo'], 'A_seg_len': _A_in['seg_len'], 'B_x': _B_in['x'], 'B_w_gate': _B_in['w_gate'], 'B_w_up': _B_in['w_up'], 'B_w_down': _B_in['w_down'], 'gate_w': _w((lambda *s: torch.randn(*s, dtype=torch.bfloat16) * 0.05)(576) * 16.0)}

def reference(A_x, A_mem0, A_Wq, A_Wk, A_Wv, A_Wo, A_seg_len, B_x, B_w_gate, B_w_up, B_w_down, gate_w):

    def _A_ref(x, mem0, Wq, Wk, Wv, Wo, seg_len):
        B, S, Dm = x.shape
        H, Dh = (Wq.shape[1], Wq.shape[2])
        M = mem0.shape[1]
        scale = Dh ** (-0.5)
        n_seg = S // seg_len
        L = M + seg_len
        idx = torch.arange(L)
        mask = (idx[:, None] < M) | (idx[:, None] >= idx[None, :])
        mem = mem0
        outs = []
        for s in range(n_seg):
            xs = x[:, s * seg_len:(s + 1) * seg_len, :].clone()
            h = torch.concatenate([mem, xs], axis=1)
            q = torch.einsum('btd,dhe->bhte', h, Wq)
            k = torch.einsum('btd,dhe->bhte', h, Wk)
            v = torch.einsum('btd,dhe->bhte', h, Wv)
            scores = torch.einsum('bhqe,bhke->bhqk', q, k) * scale
            scores = torch.where(mask[None, None], scores, -1000000000.0)
            p = _softmax(scores, axis=-1)
            o = torch.einsum('bhqk,bhke->bhqe', p, v)
            o = torch.einsum('bhte,hed->btd', o, Wo)
            mem = o[:, :M, :].clone()
            outs.append(o[:, M:, :])
        return torch.concatenate(outs, axis=1)

    def _B_ref(x, w_gate, w_up, w_down):
        g = torch.einsum('bsd,df->bsf', x, w_gate)
        u = torch.einsum('bsd,df->bsf', x, w_up)
        h = _gelu(g) * u
        return torch.einsum('bsf,fd->bsd', h, w_down)
    x = A_x
    g = _sigmoid((x * gate_w).sum(-1, keepdims=True))
    a = _A_ref(x, A_mem0, A_Wq, A_Wk, A_Wv, A_Wo, A_seg_len)
    b = _B_ref(x, B_w_gate, B_w_up, B_w_down)
    return g * a + (1 - g) * b
```

```asm
; @launch grid=(256,1,1) block=(256,1,1) lds=163840
.amdgcn_target "amdgcn-amd-amdhsa--gfx950"
.text
.globl gated_mix__memory_aug_recurrent_mem_tr__glu_gated_geglu__prompt_kernel
.p2align 8
.type gated_mix__memory_aug_recurrent_mem_tr__glu_gated_geglu__prompt_kernel,@function
gated_mix__memory_aug_recurrent_mem_tr__glu_gated_geglu__prompt_kernel:
  s_cmp_ge_u32 s2, 256
  s_cbranch_scc1 L_exit
  s_load_dwordx16 s[16:31], s[0:1], 0
  s_load_dwordx8 s[32:39], s[0:1], 64
  s_load_dwordx4 s[40:43], s[0:1], 96
  s_load_dwordx2 s[44:45], s[0:1], 112
  v_lshrrev_b32 v1, 6, v0
  v_and_b32 v0, 63, v0
  s_mov_b32 s47, 0
  v_readfirstlane_b32 s3, v1
  s_waitcnt lgkmcnt(0)
  s_mov_b32 s48, s44
  s_mov_b32 s49, s45
  s_mov_b32 s50, 268435456
  s_mov_b32 s51, 0x20000
  s_and_b32 s4, s2, 7
  s_cmp_eq_u32 s4, 0
  s_cbranch_scc1 L_chain
L_wstart:
  s_lshr_b32 s15, s2, 3
  s_and_b32 s4, s2, 7
  s_sub_u32 s4, s4, 1
  s_lshl_b32 s14, s4, 5
  s_add_u32 s14, s14, s15
  s_mov_b32 s52, s20
  s_mov_b32 s53, s21
  s_mov_b32 s54, 4718592
  s_mov_b32 s55, 0x20000
  s_mul_i32 s4, s14, 24576
  s_lshl_b32 s5, s3, 10
  s_add_u32 s4, s4, s5
  v_lshlrev_b32 v28, 4, v0
  buffer_load_dword v29, v28, s[52:55], s4 offen
  s_add_u32 s4, s4, 4096
  buffer_load_dword v29, v28, s[52:55], s4 offen
  s_add_u32 s4, s4, 4096
  buffer_load_dword v29, v28, s[52:55], s4 offen
  s_add_u32 s4, s4, 4096
  buffer_load_dword v29, v28, s[52:55], s4 offen
  s_add_u32 s4, s4, 4096
  buffer_load_dword v29, v28, s[52:55], s4 offen
  s_add_u32 s4, s4, 4096
  buffer_load_dword v29, v28, s[52:55], s4 offen
  s_add_u32 s4, s4, 4096
  s_mov_b32 s52, s26
  s_mov_b32 s53, s27
  s_mov_b32 s54, 4718592
  s_mov_b32 s55, 0x20000
  s_mul_i32 s4, s14, 24576
  s_lshl_b32 s5, s3, 10
  s_add_u32 s4, s4, s5
  v_lshlrev_b32 v28, 4, v0
  buffer_load_dword v29, v28, s[52:55], s4 offen
  s_add_u32 s4, s4, 4096
  buffer_load_dword v29, v28, s[52:55], s4 offen
  s_add_u32 s4, s4, 4096
  buffer_load_dword v29, v28, s[52:55], s4 offen
  s_add_u32 s4, s4, 4096
  buffer_load_dword v29, v28, s[52:55], s4 offen
  s_add_u32 s4, s4, 4096
  buffer_load_dword v29, v28, s[52:55], s4 offen
  s_add_u32 s4, s4, 4096
  buffer_load_dword v29, v28, s[52:55], s4 offen
  s_add_u32 s4, s4, 4096
  s_mov_b32 s52, s22
  s_mov_b32 s53, s23
  s_mov_b32 s54, 4718592
  s_mov_b32 s55, 0x20000
  s_mul_i32 s4, s14, 24576
  s_lshl_b32 s5, s3, 10
  s_add_u32 s4, s4, s5
  v_lshlrev_b32 v28, 4, v0
  buffer_load_dword v29, v28, s[52:55], s4 offen
  s_add_u32 s4, s4, 4096
  buffer_load_dword v29, v28, s[52:55], s4 offen
  s_add_u32 s4, s4, 4096
  buffer_load_dword v29, v28, s[52:55], s4 offen
  s_add_u32 s4, s4, 4096
  buffer_load_dword v29, v28, s[52:55], s4 offen
  s_add_u32 s4, s4, 4096
  buffer_load_dword v29, v28, s[52:55], s4 offen
  s_add_u32 s4, s4, 4096
  buffer_load_dword v29, v28, s[52:55], s4 offen
  s_add_u32 s4, s4, 4096
  s_mov_b32 s52, s24
  s_mov_b32 s53, s25
  s_mov_b32 s54, 4718592
  s_mov_b32 s55, 0x20000
  s_mul_i32 s4, s14, 24576
  s_lshl_b32 s5, s3, 10
  s_add_u32 s4, s4, s5
  v_lshlrev_b32 v28, 4, v0
  buffer_load_dword v29, v28, s[52:55], s4 offen
  s_add_u32 s4, s4, 4096
  buffer_load_dword v29, v28, s[52:55], s4 offen
  s_add_u32 s4, s4, 4096
  buffer_load_dword v29, v28, s[52:55], s4 offen
  s_add_u32 s4, s4, 4096
  buffer_load_dword v29, v28, s[52:55], s4 offen
  s_add_u32 s4, s4, 4096
  buffer_load_dword v29, v28, s[52:55], s4 offen
  s_add_u32 s4, s4, 4096
  buffer_load_dword v29, v28, s[52:55], s4 offen
  s_add_u32 s4, s4, 4096
  s_mov_b32 s79, 0
  s_mul_hi_u32 s4, s14, 0x24924925
  s_mul_i32 s5, s4, 7
  s_sub_u32 s5, s14, s5
  s_mov_b32 s85, s4
  s_mov_b32 s68, s5
  s_mov_b32 s69, 32
  s_mov_b32 s75, 7
  s_lshr_b32 s4, s14, 2
  s_add_u32 s4, s4, 32
  s_cmp_lt_u32 s14, 208
  s_cselect_b32 s86, s4, -1
  s_and_b32 s87, s14, 3
  s_mov_b32 s88, 32
L_w1_disp:
  s_cmp_ge_u32 s85, 68
  s_cbranch_scc1 L_w1_q
  s_cmp_ge_u32 s85, 32
  s_cbranch_scc1 L_w1_h
  s_lshr_b32 s12, s85, 1
  s_mov_b32 s83, 0
  s_and_b32 s4, s85, 1
  s_cmp_eq_u32 s4, 1
  s_cbranch_scc1 L_w1_v
  s_mov_b32 s10, s22
  s_mov_b32 s11, s23
  s_mov_b32 s84, 1048576
  s_branch L_w1_kq
L_w1_q:
  s_sub_u32 s12, s85, 68
  s_mov_b32 s10, s20
  s_mov_b32 s11, s21
  s_mov_b32 s84, 34603008
  s_mov_b32 s83, 4096
L_w1_kq:
  s_lshl_b32 s13, s12, 9
  s_add_u32 s56, s10, s13
  s_addc_u32 s57, s11, 0
  s_mov_b32 s58, 4718592
  s_mov_b32 s59, 0x20000
  s_add_u32 s13, s13, 256
  s_add_u32 s60, s10, s13
  s_addc_u32 s61, s11, 0
  s_mov_b32 s62, 4718592
  s_mov_b32 s63, 0x20000
  s_mov_b32 s52, s16
  s_mov_b32 s53, s17
  s_mov_b32 s54, 2359296
  s_mov_b32 s55, 0x20000
  v_lshrrev_b32 v12, 4, v0
  v_and_b32 v13, 15, v0
  v_lshlrev_b32 v14, 2, v12
  v_xor_b32 v13, v13, v14
  v_lshlrev_b32 v13, 4, v13
  s_mov_b32 s4, 8192
  v_mul_lo_u32 v12, v12, s4
  v_add_u32 v11, v12, v13
  v_lshrrev_b32 v12, 5, v0
  v_lshlrev_b32 v12, 3, v12
  v_bfe_u32 v13, v0, 2, 2
  v_add_u32 v12, v12, v13
  v_lshlrev_b32 v12, 8, v12
  v_bfe_u32 v14, v0, 4, 1
  v_lshlrev_b32 v14, 1, v14
  v_bfe_u32 v15, v0, 1, 1
  v_add_u32 v14, v14, v15
  v_lshlrev_b32 v13, 2, v13
  v_and_b32 v15, 1, v0
  v_lshlrev_b32 v15, 3, v15
  v_add_u32 v12, v12, v15
  s_and_b32 s4, s3, 1
  s_lshl_b32 s4, s4, 3
  s_lshr_b32 s5, s3, 1
  s_lshl_b32 s5, s5, 14
  v_add_u32 v16, s4, v14
  v_xor_b32 v17, v16, v13
  v_lshlrev_b32 v17, 4, v17
  v_add3_u32 v2, v17, v12, s5
  v_add_u32 v16, 4, v16
  v_xor_b32 v17, v16, v13
  v_lshlrev_b32 v17, 4, v17
  v_add3_u32 v3, v17, v12, s5
  s_lshl_b32 s5, s3, 12
  s_add_u32 m0, s5, 0
  s_mul_i32 s4, s3, 131072
  s_add_u32 s4, s4, 0
  buffer_load_dwordx4 v11, s[56:59], s4 offen lds
  s_lshl_b32 s5, s3, 12
  s_add_u32 m0, s5, 1024
  s_mul_i32 s4, s3, 131072
  s_add_u32 s4, s4, 32768
  buffer_load_dwordx4 v11, s[56:59], s4 offen lds
  s_lshl_b32 s5, s3, 12
  s_add_u32 m0, s5, 2048
  s_mul_i32 s4, s3, 131072
  s_add_u32 s4, s4, 65536
  buffer_load_dwordx4 v11, s[56:59], s4 offen lds
  s_lshl_b32 s5, s3, 12
  s_add_u32 m0, s5, 3072
  s_mul_i32 s4, s3, 131072
  s_add_u32 s4, s4, 98304
  buffer_load_dwordx4 v11, s[56:59], s4 offen lds
  s_lshl_b32 s5, s3, 12
  s_add_u32 m0, s5, 16384
  s_mul_i32 s4, s3, 131072
  s_add_u32 s4, s4, 0
  buffer_load_dwordx4 v11, s[60:63], s4 offen lds
  s_lshl_b32 s5, s3, 12
  s_add_u32 m0, s5, 17408
  s_mul_i32 s4, s3, 131072
  s_add_u32 s4, s4, 32768
  buffer_load_dwordx4 v11, s[60:63], s4 offen lds
  s_lshl_b32 s5, s3, 12
  s_add_u32 m0, s5, 18432
  s_mul_i32 s4, s3, 131072
  s_add_u32 s4, s4, 65536
  buffer_load_dwordx4 v11, s[60:63], s4 offen lds
  s_lshl_b32 s5, s3, 12
  s_add_u32 m0, s5, 19456
  s_mul_i32 s4, s3, 131072
  s_add_u32 s4, s4, 98304
  buffer_load_dwordx4 v11, s[60:63], s4 offen lds
  s_lshl_b32 s5, s3, 12
  s_add_u32 m0, s5, 32768
  s_mul_i32 s4, s3, 131072
  s_add_u32 s4, s4, 524288
  buffer_load_dwordx4 v11, s[56:59], s4 offen lds
  s_lshl_b32 s5, s3, 12
  s_add_u32 m0, s5, 33792
  s_mul_i32 s4, s3, 131072
  s_add_u32 s4, s4, 557056
  buffer_load_dwordx4 v11, s[56:59], s4 offen lds
  s_lshl_b32 s5, s3, 12
  s_add_u32 m0, s5, 34816
  s_mul_i32 s4, s3, 131072
  s_add_u32 s4, s4, 589824
  buffer_load_dwordx4 v11, s[56:59], s4 offen lds
  s_lshl_b32 s5, s3, 12
  s_add_u32 m0, s5, 35840
  s_mul_i32 s4, s3, 131072
  s_add_u32 s4, s4, 622592
  buffer_load_dwordx4 v11, s[56:59], s4 offen lds
  s_lshl_b32 s5, s3, 12
  s_add_u32 m0, s5, 49152
  s_mul_i32 s4, s3, 131072
  s_add_u32 s4, s4, 524288
  buffer_load_dwordx4 v11, s[60:63], s4 offen lds
  s_lshl_b32 s5, s3, 12
  s_add_u32 m0, s5, 50176
  s_mul_i32 s4, s3, 131072
  s_add_u32 s4, s4, 557056
  buffer_load_dwordx4 v11, s[60:63], s4 offen lds
  s_lshl_b32 s5, s3, 12
  s_add_u32 m0, s5, 51200
  s_mul_i32 s4, s3, 131072
  s_add_u32 s4, s4, 589824
  buffer_load_dwordx4 v11, s[60:63], s4 offen lds
  s_lshl_b32 s5, s3, 12
  s_add_u32 m0, s5, 52224
  s_mul_i32 s4, s3, 131072
  s_add_u32 s4, s4, 622592
  buffer_load_dwordx4 v11, s[60:63], s4 offen lds
  s_lshl_b32 s5, s3, 12
  s_add_u32 m0, s5, 65536
  s_mul_i32 s4, s3, 131072
  s_add_u32 s4, s4, 1048576
  buffer_load_dwordx4 v11, s[56:59], s4 offen lds
  s_lshl_b32 s5, s3, 12
  s_add_u32 m0, s5, 66560
  s_mul_i32 s4, s3, 131072
  s_add_u32 s4, s4, 1081344
  buffer_load_dwordx4 v11, s[56:59], s4 offen lds
  s_lshl_b32 s5, s3, 12
  s_add_u32 m0, s5, 67584
  s_mul_i32 s4, s3, 131072
  s_add_u32 s4, s4, 1114112
  buffer_load_dwordx4 v11, s[56:59], s4 offen lds
  s_lshl_b32 s5, s3, 12
  s_add_u32 m0, s5, 68608
  s_mul_i32 s4, s3, 131072
  s_add_u32 s4, s4, 1146880
  buffer_load_dwordx4 v11, s[56:59], s4 offen lds
  s_lshl_b32 s5, s3, 12
  s_add_u32 m0, s5, 81920
  s_mul_i32 s4, s3, 131072
  s_add_u32 s4, s4, 1048576
  buffer_load_dwordx4 v11, s[60:63], s4 offen lds
  s_lshl_b32 s5, s3, 12
  s_add_u32 m0, s5, 82944
  s_mul_i32 s4, s3, 131072
  s_add_u32 s4, s4, 1081344
  buffer_load_dwordx4 v11, s[60:63], s4 offen lds
  s_lshl_b32 s5, s3, 12
  s_add_u32 m0, s5, 83968
  s_mul_i32 s4, s3, 131072
  s_add_u32 s4, s4, 1114112
  buffer_load_dwordx4 v11, s[60:63], s4 offen lds
  s_lshl_b32 s5, s3, 12
  s_add_u32 m0, s5, 84992
  s_mul_i32 s4, s3, 131072
  s_add_u32 s4, s4, 1146880
  buffer_load_dwordx4 v11, s[60:63], s4 offen lds
  s_lshl_b32 s5, s3, 12
  s_add_u32 m0, s5, 98304
  s_mul_i32 s4, s3, 131072
  s_add_u32 s4, s4, 1572864
  buffer_load_dwordx4 v11, s[56:59], s4 offen lds
  s_lshl_b32 s5, s3, 12
  s_add_u32 m0, s5, 99328
  s_mul_i32 s4, s3, 131072
  s_add_u32 s4, s4, 1605632
  buffer_load_dwordx4 v11, s[56:59], s4 offen lds
  s_lshl_b32 s5, s3, 12
  s_add_u32 m0, s5, 100352
  s_mul_i32 s4, s3, 131072
  s_add_u32 s4, s4, 1638400
  buffer_load_dwordx4 v11, s[56:59], s4 offen lds
  s_lshl_b32 s5, s3, 12
  s_add_u32 m0, s5, 101376
  s_mul_i32 s4, s3, 131072
  s_add_u32 s4, s4, 1671168
  buffer_load_dwordx4 v11, s[56:59], s4 offen lds
  s_lshl_b32 s5, s3, 12
  s_add_u32 m0, s5, 114688
  s_mul_i32 s4, s3, 131072
  s_add_u32 s4, s4, 1572864
  buffer_load_dwordx4 v11, s[60:63], s4 offen lds
  s_lshl_b32 s5, s3, 12
  s_add_u32 m0, s5, 115712
  s_mul_i32 s4, s3, 131072
  s_add_u32 s4, s4, 1605632
  buffer_load_dwordx4 v11, s[60:63], s4 offen lds
  s_lshl_b32 s5, s3, 12
  s_add_u32 m0, s5, 116736
  s_mul_i32 s4, s3, 131072
  s_add_u32 s4, s4, 1638400
  buffer_load_dwordx4 v11, s[60:63], s4 offen lds
  s_lshl_b32 s5, s3, 12
  s_add_u32 m0, s5, 117760
  s_mul_i32 s4, s3, 131072
  s_add_u32 s4, s4, 1671168
  buffer_load_dwordx4 v11, s[60:63], s4 offen lds
  s_lshl_b32 s5, s3, 12
  s_add_u32 m0, s5, 131072
  s_mul_i32 s4, s3, 131072
  s_add_u32 s4, s4, 2097152
  buffer_load_dwordx4 v11, s[56:59], s4 offen lds
  s_lshl_b32 s5, s3, 12
  s_add_u32 m0, s5, 132096
  s_mul_i32 s4, s3, 131072
  s_add_u32 s4, s4, 2129920
  buffer_load_dwordx4 v11, s[56:59], s4 offen lds
  s_lshl_b32 s5, s3, 12
  s_add_u32 m0, s5, 133120
  s_mul_i32 s4, s3, 131072
  s_add_u32 s4, s4, 2162688
  buffer_load_dwordx4 v11, s[56:59], s4 offen lds
  s_lshl_b32 s5, s3, 12
  s_add_u32 m0, s5, 134144
  s_mul_i32 s4, s3, 131072
  s_add_u32 s4, s4, 2195456
  buffer_load_dwordx4 v11, s[56:59], s4 offen lds
  s_lshl_b32 s5, s3, 12
  s_add_u32 m0, s5, 147456
  s_mul_i32 s4, s3, 131072
  s_add_u32 s4, s4, 2097152
  buffer_load_dwordx4 v11, s[60:63], s4 offen lds
  s_lshl_b32 s5, s3, 12
  s_add_u32 m0, s5, 148480
  s_mul_i32 s4, s3, 131072
  s_add_u32 s4, s4, 2129920
  buffer_load_dwordx4 v11, s[60:63], s4 offen lds
  s_lshl_b32 s5, s3, 12
  s_add_u32 m0, s5, 149504
  s_mul_i32 s4, s3, 131072
  s_add_u32 s4, s4, 2162688
  buffer_load_dwordx4 v11, s[60:63], s4 offen lds
  s_lshl_b32 s5, s3, 12
  s_add_u32 m0, s5, 150528
  s_mul_i32 s4, s3, 131072
  s_add_u32 s4, s4, 2195456
  buffer_load_dwordx4 v11, s[60:63], s4 offen lds
  s_waitcnt vmcnt(32)
  s_barrier
  v_add_u32 v18, 0, v2
  v_add_u32 v19, 0, v3
  ds_read_b64_tr_b16 a[0:1], v18 offset:0
  ds_read_b64_tr_b16 a[2:3], v18 offset:1024
  ds_read_b64_tr_b16 a[4:5], v19 offset:0
  ds_read_b64_tr_b16 a[6:7], v19 offset:1024
  ds_read_b64_tr_b16 a[8:9], v18 offset:4096
  ds_read_b64_tr_b16 a[10:11], v18 offset:5120
  ds_read_b64_tr_b16 a[12:13], v19 offset:4096
  ds_read_b64_tr_b16 a[14:15], v19 offset:5120
  ds_read_b64_tr_b16 a[16:17], v18 offset:8192
  ds_read_b64_tr_b16 a[18:19], v18 offset:9216
  ds_read_b64_tr_b16 a[20:21], v19 offset:8192
  ds_read_b64_tr_b16 a[22:23], v19 offset:9216
  ds_read_b64_tr_b16 a[24:25], v18 offset:12288
  ds_read_b64_tr_b16 a[26:27], v18 offset:13312
  ds_read_b64_tr_b16 a[28:29], v19 offset:12288
  ds_read_b64_tr_b16 a[30:31], v19 offset:13312
  s_waitcnt lgkmcnt(0)
  s_waitcnt vmcnt(24)
  s_barrier
  s_lshl_b32 s5, s3, 12
  s_add_u32 m0, s5, 0
  s_mul_i32 s4, s3, 131072
  s_add_u32 s4, s4, 2621440
  buffer_load_dwordx4 v11, s[56:59], s4 offen lds
  s_lshl_b32 s5, s3, 12
  s_add_u32 m0, s5, 1024
  s_mul_i32 s4, s3, 131072
  s_add_u32 s4, s4, 2654208
  buffer_load_dwordx4 v11, s[56:59], s4 offen lds
  s_lshl_b32 s5, s3, 12
  s_add_u32 m0, s5, 2048
  s_mul_i32 s4, s3, 131072
  s_add_u32 s4, s4, 2686976
  buffer_load_dwordx4 v11, s[56:59], s4 offen lds
  s_lshl_b32 s5, s3, 12
  s_add_u32 m0, s5, 3072
  s_mul_i32 s4, s3, 131072
  s_add_u32 s4, s4, 2719744
  buffer_load_dwordx4 v11, s[56:59], s4 offen lds
  s_lshl_b32 s5, s3, 12
  s_add_u32 m0, s5, 16384
  s_mul_i32 s4, s3, 131072
  s_add_u32 s4, s4, 2621440
  buffer_load_dwordx4 v11, s[60:63], s4 offen lds
  s_lshl_b32 s5, s3, 12
  s_add_u32 m0, s5, 17408
  s_mul_i32 s4, s3, 131072
  s_add_u32 s4, s4, 2654208
  buffer_load_dwordx4 v11, s[60:63], s4 offen lds
  s_lshl_b32 s5, s3, 12
  s_add_u32 m0, s5, 18432
  s_mul_i32 s4, s3, 131072
  s_add_u32 s4, s4, 2686976
  buffer_load_dwordx4 v11, s[60:63], s4 offen lds
  s_lshl_b32 s5, s3, 12
  s_add_u32 m0, s5, 19456
  s_mul_i32 s4, s3, 131072
  s_add_u32 s4, s4, 2719744
  buffer_load_dwordx4 v11, s[60:63], s4 offen lds
  v_add_u32 v18, 32768, v2
  v_add_u32 v19, 32768, v3
  ds_read_b64_tr_b16 a[32:33], v18 offset:0
  ds_read_b64_tr_b16 a[34:35], v18 offset:1024
  ds_read_b64_tr_b16 a[36:37], v19 offset:0
  ds_read_b64_tr_b16 a[38:39], v19 offset:1024
  ds_read_b64_tr_b16 a[40:41], v18 offset:4096
  ds_read_b64_tr_b16 a[42:43], v18 offset:5120
  ds_read_b64_tr_b16 a[44:45], v19 offset:4096
  ds_read_b64_tr_b16 a[46:47], v19 offset:5120
  ds_read_b64_tr_b16 a[48:49], v18 offset:8192
  ds_read_b64_tr_b16 a[50:51], v18 offset:9216
  ds_read_b64_tr_b16 a[52:53], v19 offset:8192
  ds_read_b64_tr_b16 a[54:55], v19 offset:9216
  ds_read_b64_tr_b16 a[56:57], v18 offset:12288
  ds_read_b64_tr_b16 a[58:59], v18 offset:13312
  ds_read_b64_tr_b16 a[60:61], v19 offset:12288
  ds_read_b64_tr_b16 a[62:63], v19 offset:13312
  s_waitcnt lgkmcnt(0)
  s_waitcnt vmcnt(24)
  s_barrier
  s_lshl_b32 s5, s3, 12
  s_add_u32 m0, s5, 32768
  s_mul_i32 s4, s3, 131072
  s_add_u32 s4, s4, 3145728
  buffer_load_dwordx4 v11, s[56:59], s4 offen lds
  s_lshl_b32 s5, s3, 12
  s_add_u32 m0, s5, 33792
  s_mul_i32 s4, s3, 131072
  s_add_u32 s4, s4, 3178496
  buffer_load_dwordx4 v11, s[56:59], s4 offen lds
  s_lshl_b32 s5, s3, 12
  s_add_u32 m0, s5, 34816
  s_mul_i32 s4, s3, 131072
  s_add_u32 s4, s4, 3211264
  buffer_load_dwordx4 v11, s[56:59], s4 offen lds
  s_lshl_b32 s5, s3, 12
  s_add_u32 m0, s5, 35840
  s_mul_i32 s4, s3, 131072
  s_add_u32 s4, s4, 3244032
  buffer_load_dwordx4 v11, s[56:59], s4 offen lds
  s_lshl_b32 s5, s3, 12
  s_add_u32 m0, s5, 49152
  s_mul_i32 s4, s3, 131072
  s_add_u32 s4, s4, 3145728
  buffer_load_dwordx4 v11, s[60:63], s4 offen lds
  s_lshl_b32 s5, s3, 12
  s_add_u32 m0, s5, 50176
  s_mul_i32 s4, s3, 131072
  s_add_u32 s4, s4, 3178496
  buffer_load_dwordx4 v11, s[60:63], s4 offen lds
  s_lshl_b32 s5, s3, 12
  s_add_u32 m0, s5, 51200
  s_mul_i32 s4, s3, 131072
  s_add_u32 s4, s4, 3211264
  buffer_load_dwordx4 v11, s[60:63], s4 offen lds
  s_lshl_b32 s5, s3, 12
  s_add_u32 m0, s5, 52224
  s_mul_i32 s4, s3, 131072
  s_add_u32 s4, s4, 3244032
  buffer_load_dwordx4 v11, s[60:63], s4 offen lds
  v_add_u32 v18, 65536, v2
  v_add_u32 v19, 65536, v3
  ds_read_b64_tr_b16 a[64:65], v18 offset:0
  ds_read_b64_tr_b16 a[66:67], v18 offset:1024
  ds_read_b64_tr_b16 a[68:69], v19 offset:0
  ds_read_b64_tr_b16 a[70:71], v19 offset:1024
  ds_read_b64_tr_b16 a[72:73], v18 offset:4096
  ds_read_b64_tr_b16 a[74:75], v18 offset:5120
  ds_read_b64_tr_b16 a[76:77], v19 offset:4096
  ds_read_b64_tr_b16 a[78:79], v19 offset:5120
  ds_read_b64_tr_b16 a[80:81], v18 offset:8192
  ds_read_b64_tr_b16 a[82:83], v18 offset:9216
  ds_read_b64_tr_b16 a[84:85], v19 offset:8192
  ds_read_b64_tr_b16 a[86:87], v19 offset:9216
  ds_read_b64_tr_b16 a[88:89], v18 offset:12288
  ds_read_b64_tr_b16 a[90:91], v18 offset:13312
  ds_read_b64_tr_b16 a[92:93], v19 offset:12288
  ds_read_b64_tr_b16 a[94:95], v19 offset:13312
  s_waitcnt lgkmcnt(0)
  s_waitcnt vmcnt(24)
  s_barrier
  s_lshl_b32 s5, s3, 12
  s_add_u32 m0, s5, 65536
  s_mul_i32 s4, s3, 131072
  s_add_u32 s4, s4, 3670016
  buffer_load_dwordx4 v11, s[56:59], s4 offen lds
  s_lshl_b32 s5, s3, 12
  s_add_u32 m0, s5, 66560
  s_mul_i32 s4, s3, 131072
  s_add_u32 s4, s4, 3702784
  buffer_load_dwordx4 v11, s[56:59], s4 offen lds
  s_lshl_b32 s5, s3, 12
  s_add_u32 m0, s5, 67584
  s_mul_i32 s4, s3, 131072
  s_add_u32 s4, s4, 3735552
  buffer_load_dwordx4 v11, s[56:59], s4 offen lds
  s_lshl_b32 s5, s3, 12
  s_add_u32 m0, s5, 68608
  s_mul_i32 s4, s3, 131072
  s_add_u32 s4, s4, 3768320
  buffer_load_dwordx4 v11, s[56:59], s4 offen lds
  s_lshl_b32 s5, s3, 12
  s_add_u32 m0, s5, 81920
  s_mul_i32 s4, s3, 131072
  s_add_u32 s4, s4, 3670016
  buffer_load_dwordx4 v11, s[60:63], s4 offen lds
  s_lshl_b32 s5, s3, 12
  s_add_u32 m0, s5, 82944
  s_mul_i32 s4, s3, 131072
  s_add_u32 s4, s4, 3702784
  buffer_load_dwordx4 v11, s[60:63], s4 offen lds
  s_lshl_b32 s5, s3, 12
  s_add_u32 m0, s5, 83968
  s_mul_i32 s4, s3, 131072
  s_add_u32 s4, s4, 3735552
  buffer_load_dwordx4 v11, s[60:63], s4 offen lds
  s_lshl_b32 s5, s3, 12
  s_add_u32 m0, s5, 84992
  s_mul_i32 s4, s3, 131072
  s_add_u32 s4, s4, 3768320
  buffer_load_dwordx4 v11, s[60:63], s4 offen lds
  v_add_u32 v18, 98304, v2
  v_add_u32 v19, 98304, v3
  ds_read_b64_tr_b16 a[96:97], v18 offset:0
  ds_read_b64_tr_b16 a[98:99], v18 offset:1024
  ds_read_b64_tr_b16 a[100:101], v19 offset:0
  ds_read_b64_tr_b16 a[102:103], v19 offset:1024
  ds_read_b64_tr_b16 a[104:105], v18 offset:4096
  ds_read_b64_tr_b16 a[106:107], v18 offset:5120
  ds_read_b64_tr_b16 a[108:109], v19 offset:4096
  ds_read_b64_tr_b16 a[110:111], v19 offset:5120
  ds_read_b64_tr_b16 a[112:113], v18 offset:8192
  ds_read_b64_tr_b16 a[114:115], v18 offset:9216
  ds_read_b64_tr_b16 a[116:117], v19 offset:8192
  ds_read_b64_tr_b16 a[118:119], v19 offset:9216
  ds_read_b64_tr_b16 a[120:121], v18 offset:12288
  ds_read_b64_tr_b16 a[122:123], v18 offset:13312
  ds_read_b64_tr_b16 a[124:125], v19 offset:12288
  ds_read_b64_tr_b16 a[126:127], v19 offset:13312
  s_waitcnt lgkmcnt(0)
  s_waitcnt vmcnt(24)
  s_barrier
  s_lshl_b32 s5, s3, 12
  s_add_u32 m0, s5, 98304
  s_mul_i32 s4, s3, 131072
  s_add_u32 s4, s4, 4194304
  buffer_load_dwordx4 v11, s[56:59], s4 offen lds
  s_lshl_b32 s5, s3, 12
  s_add_u32 m0, s5, 99328
  s_mul_i32 s4, s3, 131072
  s_add_u32 s4, s4, 4227072
  buffer_load_dwordx4 v11, s[56:59], s4 offen lds
  s_lshl_b32 s5, s3, 12
  s_add_u32 m0, s5, 100352
  s_mul_i32 s4, s3, 131072
  s_add_u32 s4, s4, 4259840
  buffer_load_dwordx4 v11, s[56:59], s4 offen lds
  s_lshl_b32 s5, s3, 12
  s_add_u32 m0, s5, 101376
  s_mul_i32 s4, s3, 131072
  s_add_u32 s4, s4, 4292608
  buffer_load_dwordx4 v11, s[56:59], s4 offen lds
  s_lshl_b32 s5, s3, 12
  s_add_u32 m0, s5, 114688
  s_mul_i32 s4, s3, 131072
  s_add_u32 s4, s4, 4194304
  buffer_load_dwordx4 v11, s[60:63], s4 offen lds
  s_lshl_b32 s5, s3, 12
  s_add_u32 m0, s5, 115712
  s_mul_i32 s4, s3, 131072
  s_add_u32 s4, s4, 4227072
  buffer_load_dwordx4 v11, s[60:63], s4 offen lds
  s_lshl_b32 s5, s3, 12
  s_add_u32 m0, s5, 116736
  s_mul_i32 s4, s3, 131072
  s_add_u32 s4, s4, 4259840
  buffer_load_dwordx4 v11, s[60:63], s4 offen lds
  s_lshl_b32 s5, s3, 12
  s_add_u32 m0, s5, 117760
  s_mul_i32 s4, s3, 131072
  s_add_u32 s4, s4, 4292608
  buffer_load_dwordx4 v11, s[60:63], s4 offen lds
  v_add_u32 v18, 131072, v2
  v_add_u32 v19, 131072, v3
  ds_read_b64_tr_b16 a[128:129], v18 offset:0
  ds_read_b64_tr_b16 a[130:131], v18 offset:1024
  ds_read_b64_tr_b16 a[132:133], v19 offset:0
  ds_read_b64_tr_b16 a[134:135], v19 offset:1024
  ds_read_b64_tr_b16 a[136:137], v18 offset:4096
  ds_read_b64_tr_b16 a[138:139], v18 offset:5120
  ds_read_b64_tr_b16 a[140:141], v19 offset:4096
  ds_read_b64_tr_b16 a[142:143], v19 offset:5120
  ds_read_b64_tr_b16 a[144:145], v18 offset:8192
  ds_read_b64_tr_b16 a[146:147], v18 offset:9216
  ds_read_b64_tr_b16 a[148:149], v19 offset:8192
  ds_read_b64_tr_b16 a[150:151], v19 offset:9216
  ds_read_b64_tr_b16 a[152:153], v18 offset:12288
  ds_read_b64_tr_b16 a[154:155], v18 offset:13312
  ds_read_b64_tr_b16 a[156:157], v19 offset:12288
  ds_read_b64_tr_b16 a[158:159], v19 offset:13312
  s_waitcnt lgkmcnt(0)
  s_waitcnt vmcnt(24)
  s_barrier
  v_add_u32 v18, 0, v2
  v_add_u32 v19, 0, v3
  ds_read_b64_tr_b16 a[160:161], v18 offset:0
  ds_read_b64_tr_b16 a[162:163], v18 offset:1024
  ds_read_b64_tr_b16 a[164:165], v19 offset:0
  ds_read_b64_tr_b16 a[166:167], v19 offset:1024
  ds_read_b64_tr_b16 a[168:169], v18 offset:4096
  ds_read_b64_tr_b16 a[170:171], v18 offset:5120
  ds_read_b64_tr_b16 a[172:173], v19 offset:4096
  ds_read_b64_tr_b16 a[174:175], v19 offset:5120
  ds_read_b64_tr_b16 a[176:177], v18 offset:8192
  ds_read_b64_tr_b16 a[178:179], v18 offset:9216
  ds_read_b64_tr_b16 a[180:181], v19 offset:8192
  ds_read_b64_tr_b16 a[182:183], v19 offset:9216
  ds_read_b64_tr_b16 a[184:185], v18 offset:12288
  ds_read_b64_tr_b16 a[186:187], v18 offset:13312
  ds_read_b64_tr_b16 a[188:189], v19 offset:12288
  ds_read_b64_tr_b16 a[190:191], v19 offset:13312
  s_waitcnt lgkmcnt(0)
  s_waitcnt vmcnt(16)
  s_barrier
  v_add_u32 v18, 32768, v2
  v_add_u32 v19, 32768, v3
  ds_read_b64_tr_b16 a[192:193], v18 offset:0
  ds_read_b64_tr_b16 a[194:195], v18 offset:1024
  ds_read_b64_tr_b16 a[196:197], v19 offset:0
  ds_read_b64_tr_b16 a[198:199], v19 offset:1024
  ds_read_b64_tr_b16 a[200:201], v18 offset:4096
  ds_read_b64_tr_b16 a[202:203], v18 offset:5120
  ds_read_b64_tr_b16 a[204:205], v19 offset:4096
  ds_read_b64_tr_b16 a[206:207], v19 offset:5120
  ds_read_b64_tr_b16 a[208:209], v18 offset:8192
  ds_read_b64_tr_b16 a[210:211], v18 offset:9216
  ds_read_b64_tr_b16 a[212:213], v19 offset:8192
  ds_read_b64_tr_b16 a[214:215], v19 offset:9216
  ds_read_b64_tr_b16 a[216:217], v18 offset:12288
  ds_read_b64_tr_b16 a[218:219], v18 offset:13312
  ds_read_b64_tr_b16 a[220:221], v19 offset:12288
  ds_read_b64_tr_b16 a[222:223], v19 offset:13312
  s_waitcnt lgkmcnt(0)
  s_waitcnt vmcnt(8)
  s_barrier
  v_add_u32 v18, 65536, v2
  v_add_u32 v19, 65536, v3
  ds_read_b64_tr_b16 a[224:225], v18 offset:0
  ds_read_b64_tr_b16 a[226:227], v18 offset:1024
  ds_read_b64_tr_b16 a[228:229], v19 offset:0
  ds_read_b64_tr_b16 a[230:231], v19 offset:1024
  ds_read_b64_tr_b16 a[232:233], v18 offset:4096
  ds_read_b64_tr_b16 a[234:235], v18 offset:5120
  ds_read_b64_tr_b16 a[236:237], v19 offset:4096
  ds_read_b64_tr_b16 a[238:239], v19 offset:5120
  ds_read_b64_tr_b16 a[240:241], v18 offset:8192
  ds_read_b64_tr_b16 a[242:243], v18 offset:9216
  ds_read_b64_tr_b16 a[244:245], v19 offset:8192
  ds_read_b64_tr_b16 a[246:247], v19 offset:9216
  ds_read_b64_tr_b16 a[248:249], v18 offset:12288
  ds_read_b64_tr_b16 a[250:251], v18 offset:13312
  ds_read_b64_tr_b16 a[252:253], v19 offset:12288
  ds_read_b64_tr_b16 a[254:255], v19 offset:13312
  s_waitcnt lgkmcnt(0)
  s_waitcnt vmcnt(0)
  s_barrier
  v_add_u32 v18, 98304, v2
  v_add_u32 v19, 98304, v3
  ds_read_b64_tr_b16 v[224:225], v18 offset:0
  ds_read_b64_tr_b16 v[226:227], v18 offset:1024
  ds_read_b64_tr_b16 v[228:229], v19 offset:0
  ds_read_b64_tr_b16 v[230:231], v19 offset:1024
  ds_read_b64_tr_b16 v[232:233], v18 offset:4096
  ds_read_b64_tr_b16 v[234:235], v18 offset:5120
  ds_read_b64_tr_b16 v[236:237], v19 offset:4096
  ds_read_b64_tr_b16 v[238:239], v19 offset:5120
  ds_read_b64_tr_b16 v[240:241], v18 offset:8192
  ds_read_b64_tr_b16 v[242:243], v18 offset:9216
  ds_read_b64_tr_b16 v[244:245], v19 offset:8192
  ds_read_b64_tr_b16 v[246:247], v19 offset:9216
  ds_read_b64_tr_b16 v[248:249], v18 offset:12288
  ds_read_b64_tr_b16 v[250:251], v18 offset:13312
  ds_read_b64_tr_b16 v[252:253], v19 offset:12288
  ds_read_b64_tr_b16 v[254:255], v19 offset:13312
  s_waitcnt lgkmcnt(0)
  s_barrier
  v_lshrrev_b32 v12, 5, v0
  v_lshlrev_b32 v12, 8, v12
  v_and_b32 v13, 15, v0
  v_lshlrev_b32 v13, 4, v13
  v_add_u32 v12, v12, v13
  v_bfe_u32 v13, v0, 4, 1
  v_mul_u32_u24 v13, 4096, v13
  v_add_u32 v10, v12, v13
  v_lshrrev_b32 v12, 3, v0
  s_movk_i32 s4, 1152
  v_mul_lo_u32 v12, v12, s4
  v_and_b32 v13, 7, v0
  v_lshrrev_b32 v14, 4, v0
  v_xor_b32 v15, v13, v14
  v_lshlrev_b32 v15, 4, v15
  v_add_u32 v4, v12, v15
  v_add_u32 v14, 4, v14
  v_xor_b32 v15, v13, v14
  v_lshlrev_b32 v15, 4, v15
  v_add_u32 v5, v12, v15
  v_and_b32 v12, 31, v0
  v_lshrrev_b32 v13, 5, v0
  v_bfe_u32 v14, v0, 1, 3
  v_lshlrev_b32 v12, 7, v12
  v_add_u32 v15, 0, v13
  v_xor_b32 v15, v15, v14
  v_lshlrev_b32 v15, 4, v15
  v_add_u32 v6, v12, v15
  v_add_u32 v15, 2, v13
  v_xor_b32 v15, v15, v14
  v_lshlrev_b32 v15, 4, v15
  v_add_u32 v7, v12, v15
  v_add_u32 v15, 4, v13
  v_xor_b32 v15, v15, v14
  v_lshlrev_b32 v15, 4, v15
  v_add_u32 v8, v12, v15
  v_add_u32 v15, 6, v13
  v_xor_b32 v15, v15, v14
  v_lshlrev_b32 v15, 4, v15
  v_add_u32 v9, v12, v15
  s_mov_b32 s71, 0
  s_lshl_b32 s4, s3, 11
  s_add_u32 s71, s71, s4
  s_mul_i32 s72, s68, 73728
  s_mul_i32 s5, s3, 18432
  s_add_u32 s72, s72, s5
  s_add_u32 m0, s71, 0
  s_add_u32 s73, s72, 0
  buffer_load_dwordx4 v4, s[52:55], s73 offen lds
  s_add_u32 m0, s71, 1024
  s_add_u32 s73, s72, 9216
  buffer_load_dwordx4 v5, s[52:55], s73 offen lds
  s_add_u32 m0, s71, 8192
  s_add_u32 s73, s72, 128
  buffer_load_dwordx4 v4, s[52:55], s73 offen lds
  s_add_u32 m0, s71, 9216
  s_add_u32 s73, s72, 9344
  buffer_load_dwordx4 v5, s[52:55], s73 offen lds
  s_add_u32 m0, s71, 16384
  s_add_u32 s73, s72, 256
  buffer_load_dwordx4 v4, s[52:55], s73 offen lds
  s_add_u32 m0, s71, 17408
  s_add_u32 s73, s72, 9472
  buffer_load_dwordx4 v5, s[52:55], s73 offen lds
  s_add_u32 m0, s71, 24576
  s_add_u32 s73, s72, 384
  buffer_load_dwordx4 v4, s[52:55], s73 offen lds
  s_add_u32 m0, s71, 25600
  s_add_u32 s73, s72, 9600
  buffer_load_dwordx4 v5, s[52:55], s73 offen lds
  s_add_u32 m0, s71, 32768
  s_add_u32 s73, s72, 512
  buffer_load_dwordx4 v4, s[52:55], s73 offen lds
  s_add_u32 m0, s71, 33792
  s_add_u32 s73, s72, 9728
  buffer_load_dwordx4 v5, s[52:55], s73 offen lds
  s_add_u32 m0, s71, 40960
  s_add_u32 s73, s72, 640
  buffer_load_dwordx4 v4, s[52:55], s73 offen lds
  s_add_u32 m0, s71, 41984
  s_add_u32 s73, s72, 9856
  buffer_load_dwordx4 v5, s[52:55], s73 offen lds
  s_add_u32 m0, s71, 49152
  s_add_u32 s73, s72, 768
  buffer_load_dwordx4 v4, s[52:55], s73 offen lds
  s_add_u32 m0, s71, 50176
  s_add_u32 s73, s72, 9984
  buffer_load_dwordx4 v5, s[52:55], s73 offen lds
  s_add_u32 m0, s71, 57344
  s_add_u32 s73, s72, 896
  buffer_load_dwordx4 v4, s[52:55], s73 offen lds
  s_add_u32 m0, s71, 58368
  s_add_u32 s73, s72, 10112
  buffer_load_dwordx4 v5, s[52:55], s73 offen lds
  s_add_u32 m0, s71, 65536
  s_add_u32 s73, s72, 1024
  buffer_load_dwordx4 v4, s[52:55], s73 offen lds
  s_add_u32 m0, s71, 66560
  s_add_u32 s73, s72, 10240
  buffer_load_dwordx4 v5, s[52:55], s73 offen lds
  s_mov_b32 s70, 0
  s_mov_b32 s77, -1
  s_waitcnt vmcnt(0)
  s_barrier
L_w1loop_1:
  s_add_u32 s10, s68, s75
  s_xor_b32 s71, s70, 73728
  s_lshl_b32 s4, s3, 11
  s_mul_i32 s72, s10, 73728
  s_mul_i32 s5, s3, 18432
  s_add_u32 s72, s72, s5
  s_mov_b32 s11, s71
  s_add_u32 s71, s71, s4
  v_add_u32 v120, s70, v6
  v_add_u32 v121, s70, v7
  v_add_u32 v122, s70, v8
  v_add_u32 v123, s70, v9
  ds_read_b128 v[96:99], v120 offset:0
  ds_read_b128 v[100:103], v120 offset:4096
  ds_read_b128 v[104:107], v121 offset:0
  ds_read_b128 v[108:111], v121 offset:4096
  ds_read_b128 v[112:115], v122 offset:0
  ds_read_b128 v[116:119], v122 offset:4096
  s_waitcnt lgkmcnt(4)
  v_mfma_f32_32x32x16_bf16 v[32:47], a[0:3], v[96:99], 0
  v_mfma_f32_32x32x16_bf16 v[48:63], a[4:7], v[96:99], 0
  s_add_u32 m0, s71, 0
  s_add_u32 s73, s72, 0
  buffer_load_dwordx4 v4, s[52:55], s73 offen lds
  v_mfma_f32_32x32x16_bf16 v[64:79], a[0:3], v[100:103], 0
  v_mfma_f32_32x32x16_bf16 v[80:95], a[4:7], v[100:103], 0
  ds_read_b128 v[96:99], v123 offset:0
  ds_read_b128 v[100:103], v123 offset:4096
  s_waitcnt lgkmcnt(4)
  v_mfma_f32_32x32x16_bf16 v[32:47], a[8:11], v[104:107], v[32:47]
  v_mfma_f32_32x32x16_bf16 v[48:63], a[12:15], v[104:107], v[48:63]
  v_mfma_f32_32x32x16_bf16 v[64:79], a[8:11], v[108:111], v[64:79]
  v_mfma_f32_32x32x16_bf16 v[80:95], a[12:15], v[108:111], v[80:95]
  ds_read_b128 v[104:107], v120 offset:8192
  ds_read_b128 v[108:111], v120 offset:12288
  s_waitcnt lgkmcnt(4)
  v_mfma_f32_32x32x16_bf16 v[32:47], a[16:19], v[112:115], v[32:47]
  v_mfma_f32_32x32x16_bf16 v[48:63], a[20:23], v[112:115], v[48:63]
  s_add_u32 m0, s71, 1024
  s_add_u32 s73, s72, 9216
  buffer_load_dwordx4 v5, s[52:55], s73 offen lds
  v_mfma_f32_32x32x16_bf16 v[64:79], a[16:19], v[116:119], v[64:79]
  v_mfma_f32_32x32x16_bf16 v[80:95], a[20:23], v[116:119], v[80:95]
  ds_read_b128 v[112:115], v121 offset:8192
  ds_read_b128 v[116:119], v121 offset:12288
  s_waitcnt lgkmcnt(4)
  v_mfma_f32_32x32x16_bf16 v[32:47], a[24:27], v[96:99], v[32:47]
  v_mfma_f32_32x32x16_bf16 v[48:63], a[28:31], v[96:99], v[48:63]
  v_mfma_f32_32x32x16_bf16 v[64:79], a[24:27], v[100:103], v[64:79]
  v_mfma_f32_32x32x16_bf16 v[80:95], a[28:31], v[100:103], v[80:95]
  ds_read_b128 v[96:99], v122 offset:8192
  ds_read_b128 v[100:103], v122 offset:12288
  s_waitcnt lgkmcnt(4)
  v_mfma_f32_32x32x16_bf16 v[32:47], a[32:35], v[104:107], v[32:47]
  v_mfma_f32_32x32x16_bf16 v[48:63], a[36:39], v[104:107], v[48:63]
  s_add_u32 m0, s71, 8192
  s_add_u32 s73, s72, 128
  buffer_load_dwordx4 v4, s[52:55], s73 offen lds
  v_mfma_f32_32x32x16_bf16 v[64:79], a[32:35], v[108:111], v[64:79]
  v_mfma_f32_32x32x16_bf16 v[80:95], a[36:39], v[108:111], v[80:95]
  ds_read_b128 v[104:107], v123 offset:8192
  ds_read_b128 v[108:111], v123 offset:12288
  s_waitcnt lgkmcnt(4)
  v_mfma_f32_32x32x16_bf16 v[32:47], a[40:43], v[112:115], v[32:47]
  v_mfma_f32_32x32x16_bf16 v[48:63], a[44:47], v[112:115], v[48:63]
  v_mfma_f32_32x32x16_bf16 v[64:79], a[40:43], v[116:119], v[64:79]
  v_mfma_f32_32x32x16_bf16 v[80:95], a[44:47], v[116:119], v[80:95]
  ds_read_b128 v[112:115], v120 offset:16384
  ds_read_b128 v[116:119], v120 offset:20480
  s_waitcnt lgkmcnt(4)
  v_mfma_f32_32x32x16_bf16 v[32:47], a[48:51], v[96:99], v[32:47]
  v_mfma_f32_32x32x16_bf16 v[48:63], a[52:55], v[96:99], v[48:63]
  s_add_u32 m0, s71, 9216
  s_add_u32 s73, s72, 9344
  buffer_load_dwordx4 v5, s[52:55], s73 offen lds
  v_mfma_f32_32x32x16_bf16 v[64:79], a[48:51], v[100:103], v[64:79]
  v_mfma_f32_32x32x16_bf16 v[80:95], a[52:55], v[100:103], v[80:95]
  ds_read_b128 v[96:99], v121 offset:16384
  ds_read_b128 v[100:103], v121 offset:20480
  s_waitcnt lgkmcnt(4)
  v_mfma_f32_32x32x16_bf16 v[32:47], a[56:59], v[104:107], v[32:47]
  v_mfma_f32_32x32x16_bf16 v[48:63], a[60:63], v[104:107], v[48:63]
  v_mfma_f32_32x32x16_bf16 v[64:79], a[56:59], v[108:111], v[64:79]
  v_mfma_f32_32x32x16_bf16 v[80:95], a[60:63], v[108:111], v[80:95]
  ds_read_b128 v[104:107], v122 offset:16384
  ds_read_b128 v[108:111], v122 offset:20480
  s_waitcnt lgkmcnt(4)
  v_mfma_f32_32x32x16_bf16 v[32:47], a[64:67], v[112:115], v[32:47]
  v_mfma_f32_32x32x16_bf16 v[48:63], a[68:71], v[112:115], v[48:63]
  s_add_u32 m0, s71, 16384
  s_add_u32 s73, s72, 256
  buffer_load_dwordx4 v4, s[52:55], s73 offen lds
  v_mfma_f32_32x32x16_bf16 v[64:79], a[64:67], v[116:119], v[64:79]
  v_mfma_f32_32x32x16_bf16 v[80:95], a[68:71], v[116:119], v[80:95]
  ds_read_b128 v[112:115], v123 offset:16384
  ds_read_b128 v[116:119], v123 offset:20480
  s_waitcnt lgkmcnt(4)
  v_mfma_f32_32x32x16_bf16 v[32:47], a[72:75], v[96:99], v[32:47]
  v_mfma_f32_32x32x16_bf16 v[48:63], a[76:79], v[96:99], v[48:63]
  v_mfma_f32_32x32x16_bf16 v[64:79], a[72:75], v[100:103], v[64:79]
  v_mfma_f32_32x32x16_bf16 v[80:95], a[76:79], v[100:103], v[80:95]
  ds_read_b128 v[96:99], v120 offset:24576
  ds_read_b128 v[100:103], v120 offset:28672
  s_waitcnt lgkmcnt(4)
  v_mfma_f32_32x32x16_bf16 v[32:47], a[80:83], v[104:107], v[32:47]
  v_mfma_f32_32x32x16_bf16 v[48:63], a[84:87], v[104:107], v[48:63]
  s_add_u32 m0, s71, 17408
  s_add_u32 s73, s72, 9472
  buffer_load_dwordx4 v5, s[52:55], s73 offen lds
  v_mfma_f32_32x32x16_bf16 v[64:79], a[80:83], v[108:111], v[64:79]
  v_mfma_f32_32x32x16_bf16 v[80:95], a[84:87], v[108:111], v[80:95]
  ds_read_b128 v[104:107], v121 offset:24576
  ds_read_b128 v[108:111], v121 offset:28672
  s_waitcnt lgkmcnt(4)
  v_mfma_f32_32x32x16_bf16 v[32:47], a[88:91], v[112:115], v[32:47]
  v_mfma_f32_32x32x16_bf16 v[48:63], a[92:95], v[112:115], v[48:63]
  v_mfma_f32_32x32x16_bf16 v[64:79], a[88:91], v[116:119], v[64:79]
  v_mfma_f32_32x32x16_bf16 v[80:95], a[92:95], v[116:119], v[80:95]
  ds_read_b128 v[112:115], v122 offset:24576
  ds_read_b128 v[116:119], v122 offset:28672
  s_waitcnt lgkmcnt(4)
  v_mfma_f32_32x32x16_bf16 v[32:47], a[96:99], v[96:99], v[32:47]
  v_mfma_f32_32x32x16_bf16 v[48:63], a[100:103], v[96:99], v[48:63]
  s_add_u32 m0, s71, 24576
  s_add_u32 s73, s72, 384
  buffer_load_dwordx4 v4, s[52:55], s73 offen lds
  v_mfma_f32_32x32x16_bf16 v[64:79], a[96:99], v[100:103], v[64:79]
  v_mfma_f32_32x32x16_bf16 v[80:95], a[100:103], v[100:103], v[80:95]
  ds_read_b128 v[96:99], v123 offset:24576
  ds_read_b128 v[100:103], v123 offset:28672
  s_waitcnt lgkmcnt(4)
  v_mfma_f32_32x32x16_bf16 v[32:47], a[104:107], v[104:107], v[32:47]
  v_mfma_f32_32x32x16_bf16 v[48:63], a[108:111], v[104:107], v[48:63]
  v_mfma_f32_32x32x16_bf16 v[64:79], a[104:107], v[108:111], v[64:79]
  v_mfma_f32_32x32x16_bf16 v[80:95], a[108:111], v[108:111], v[80:95]
  v_add_u32 v120, 0x8000, v120
  v_add_u32 v121, 0x8000, v121
  v_add_u32 v122, 0x8000, v122
  v_add_u32 v123, 0x8000, v123
  ds_read_b128 v[104:107], v120 offset:0
  ds_read_b128 v[108:111], v120 offset:4096
  s_waitcnt lgkmcnt(4)
  v_mfma_f32_32x32x16_bf16 v[32:47], a[112:115], v[112:115], v[32:47]
  v_mfma_f32_32x32x16_bf16 v[48:63], a[116:119], v[112:115], v[48:63]
  s_add_u32 m0, s71, 25600
  s_add_u32 s73, s72, 9600
  buffer_load_dwordx4 v5, s[52:55], s73 offen lds
  v_mfma_f32_32x32x16_bf16 v[64:79], a[112:115], v[116:119], v[64:79]
  v_mfma_f32_32x32x16_bf16 v[80:95], a[116:119], v[116:119], v[80:95]
  ds_read_b128 v[112:115], v121 offset:0
  ds_read_b128 v[116:119], v121 offset:4096
  s_waitcnt lgkmcnt(4)
  v_mfma_f32_32x32x16_bf16 v[32:47], a[120:123], v[96:99], v[32:47]
  v_mfma_f32_32x32x16_bf16 v[48:63], a[124:127], v[96:99], v[48:63]
  v_mfma_f32_32x32x16_bf16 v[64:79], a[120:123], v[100:103], v[64:79]
  v_mfma_f32_32x32x16_bf16 v[80:95], a[124:127], v[100:103], v[80:95]
  ds_read_b128 v[96:99], v122 offset:0
  ds_read_b128 v[100:103], v122 offset:4096
  s_waitcnt lgkmcnt(4)
  v_mfma_f32_32x32x16_bf16 v[32:47], a[128:131], v[104:107], v[32:47]
  v_mfma_f32_32x32x16_bf16 v[48:63], a[132:135], v[104:107], v[48:63]
  s_add_u32 m0, s71, 32768
  s_add_u32 s73, s72, 512
  buffer_load_dwordx4 v4, s[52:55], s73 offen lds
  v_mfma_f32_32x32x16_bf16 v[64:79], a[128:131], v[108:111], v[64:79]
  v_mfma_f32_32x32x16_bf16 v[80:95], a[132:135], v[108:111], v[80:95]
  ds_read_b128 v[104:107], v123 offset:0
  ds_read_b128 v[108:111], v123 offset:4096
  s_waitcnt lgkmcnt(4)
  v_mfma_f32_32x32x16_bf16 v[32:47], a[136:139], v[112:115], v[32:47]
  v_mfma_f32_32x32x16_bf16 v[48:63], a[140:143], v[112:115], v[48:63]
  v_mfma_f32_32x32x16_bf16 v[64:79], a[136:139], v[116:119], v[64:79]
  v_mfma_f32_32x32x16_bf16 v[80:95], a[140:143], v[116:119], v[80:95]
  ds_read_b128 v[112:115], v120 offset:8192
  ds_read_b128 v[116:119], v120 offset:12288
  s_waitcnt lgkmcnt(4)
  v_mfma_f32_32x32x16_bf16 v[32:47], a[144:147], v[96:99], v[32:47]
  v_mfma_f32_32x32x16_bf16 v[48:63], a[148:151], v[96:99], v[48:63]
  s_add_u32 m0, s71, 33792
  s_add_u32 s73, s72, 9728
  buffer_load_dwordx4 v5, s[52:55], s73 offen lds
  v_mfma_f32_32x32x16_bf16 v[64:79], a[144:147], v[100:103], v[64:79]
  v_mfma_f32_32x32x16_bf16 v[80:95], a[148:151], v[100:103], v[80:95]
  ds_read_b128 v[96:99], v121 offset:8192
  ds_read_b128 v[100:103], v121 offset:12288
  s_waitcnt lgkmcnt(4)
  v_mfma_f32_32x32x16_bf16 v[32:47], a[152:155], v[104:107], v[32:47]
  v_mfma_f32_32x32x16_bf16 v[48:63], a[156:159], v[104:107], v[48:63]
  v_mfma_f32_32x32x16_bf16 v[64:79], a[152:155], v[108:111], v[64:79]
  v_mfma_f32_32x32x16_bf16 v[80:95], a[156:159], v[108:111], v[80:95]
  ds_read_b128 v[104:107], v122 offset:8192
  ds_read_b128 v[108:111], v122 offset:12288
  s_waitcnt lgkmcnt(4)
  v_mfma_f32_32x32x16_bf16 v[32:47], a[160:163], v[112:115], v[32:47]
  v_mfma_f32_32x32x16_bf16 v[48:63], a[164:167], v[112:115], v[48:63]
  s_add_u32 m0, s71, 40960
  s_add_u32 s73, s72, 640
  buffer_load_dwordx4 v4, s[52:55], s73 offen lds
  v_mfma_f32_32x32x16_bf16 v[64:79], a[160:163], v[116:119], v[64:79]
  v_mfma_f32_32x32x16_bf16 v[80:95], a[164:167], v[116:119], v[80:95]
  ds_read_b128 v[112:115], v123 offset:8192
  ds_read_b128 v[116:119], v123 offset:12288
  s_waitcnt lgkmcnt(4)
  v_mfma_f32_32x32x16_bf16 v[32:47], a[168:171], v[96:99], v[32:47]
  v_mfma_f32_32x32x16_bf16 v[48:63], a[172:175], v[96:99], v[48:63]
  v_mfma_f32_32x32x16_bf16 v[64:79], a[168:171], v[100:103], v[64:79]
  v_mfma_f32_32x32x16_bf16 v[80:95], a[172:175], v[100:103], v[80:95]
  ds_read_b128 v[96:99], v120 offset:16384
  ds_read_b128 v[100:103], v120 offset:20480
  s_waitcnt lgkmcnt(4)
  v_mfma_f32_32x32x16_bf16 v[32:47], a[176:179], v[104:107], v[32:47]
  v_mfma_f32_32x32x16_bf16 v[48:63], a[180:183], v[104:107], v[48:63]
  s_add_u32 m0, s71, 41984
  s_add_u32 s73, s72, 9856
  buffer_load_dwordx4 v5, s[52:55], s73 offen lds
  v_mfma_f32_32x32x16_bf16 v[64:79], a[176:179], v[108:111], v[64:79]
  v_mfma_f32_32x32x16_bf16 v[80:95], a[180:183], v[108:111], v[80:95]
  ds_read_b128 v[104:107], v121 offset:16384
  ds_read_b128 v[108:111], v121 offset:20480
  s_waitcnt lgkmcnt(4)
  v_mfma_f32_32x32x16_bf16 v[32:47], a[184:187], v[112:115], v[32:47]
  v_mfma_f32_32x32x16_bf16 v[48:63], a[188:191], v[112:115], v[48:63]
  v_mfma_f32_32x32x16_bf16 v[64:79], a[184:187], v[116:119], v[64:79]
  v_mfma_f32_32x32x16_bf16 v[80:95], a[188:191], v[116:119], v[80:95]
  ds_read_b128 v[112:115], v122 offset:16384
  ds_read_b128 v[116:119], v122 offset:20480
  s_waitcnt lgkmcnt(4)
  v_mfma_f32_32x32x16_bf16 v[32:47], a[192:195], v[96:99], v[32:47]
  v_mfma_f32_32x32x16_bf16 v[48:63], a[196:199], v[96:99], v[48:63]
  s_add_u32 m0, s71, 49152
  s_add_u32 s73, s72, 768
  buffer_load_dwordx4 v4, s[52:55], s73 offen lds
  v_mfma_f32_32x32x16_bf16 v[64:79], a[192:195], v[100:103], v[64:79]
  v_mfma_f32_32x32x16_bf16 v[80:95], a[196:199], v[100:103], v[80:95]
  ds_read_b128 v[96:99], v123 offset:16384
  ds_read_b128 v[100:103], v123 offset:20480
  s_waitcnt lgkmcnt(4)
  v_mfma_f32_32x32x16_bf16 v[32:47], a[200:203], v[104:107], v[32:47]
  v_mfma_f32_32x32x16_bf16 v[48:63], a[204:207], v[104:107], v[48:63]
  v_mfma_f32_32x32x16_bf16 v[64:79], a[200:203], v[108:111], v[64:79]
  v_mfma_f32_32x32x16_bf16 v[80:95], a[204:207], v[108:111], v[80:95]
  ds_read_b128 v[104:107], v120 offset:24576
  ds_read_b128 v[108:111], v120 offset:28672
  s_waitcnt lgkmcnt(4)
  v_mfma_f32_32x32x16_bf16 v[32:47], a[208:211], v[112:115], v[32:47]
  v_mfma_f32_32x32x16_bf16 v[48:63], a[212:215], v[112:115], v[48:63]
  s_add_u32 m0, s71, 50176
  s_add_u32 s73, s72, 9984
  buffer_load_dwordx4 v5, s[52:55], s73 offen lds
  v_mfma_f32_32x32x16_bf16 v[64:79], a[208:211], v[116:119], v[64:79]
  v_mfma_f32_32x32x16_bf16 v[80:95], a[212:215], v[116:119], v[80:95]
  ds_read_b128 v[112:115], v121 offset:24576
  ds_read_b128 v[116:119], v121 offset:28672
  s_waitcnt lgkmcnt(4)
  v_mfma_f32_32x32x16_bf16 v[32:47], a[216:219], v[96:99], v[32:47]
  v_mfma_f32_32x32x16_bf16 v[48:63], a[220:223], v[96:99], v[48:63]
  v_mfma_f32_32x32x16_bf16 v[64:79], a[216:219], v[100:103], v[64:79]
  v_mfma_f32_32x32x16_bf16 v[80:95], a[220:223], v[100:103], v[80:95]
  ds_read_b128 v[96:99], v122 offset:24576
  ds_read_b128 v[100:103], v122 offset:28672
  s_waitcnt lgkmcnt(4)
  v_mfma_f32_32x32x16_bf16 v[32:47], a[224:227], v[104:107], v[32:47]
  v_mfma_f32_32x32x16_bf16 v[48:63], a[228:231], v[104:107], v[48:63]
  s_add_u32 m0, s71, 57344
  s_add_u32 s73, s72, 896
  buffer_load_dwordx4 v4, s[52:55], s73 offen lds
  v_mfma_f32_32x32x16_bf16 v[64:79], a[224:227], v[108:111], v[64:79]
  v_mfma_f32_32x32x16_bf16 v[80:95], a[228:231], v[108:111], v[80:95]
  ds_read_b128 v[104:107], v123 offset:24576
  ds_read_b128 v[108:111], v123 offset:28672
  s_waitcnt lgkmcnt(4)
  v_mfma_f32_32x32x16_bf16 v[32:47], a[232:235], v[112:115], v[32:47]
  v_mfma_f32_32x32x16_bf16 v[48:63], a[236:239], v[112:115], v[48:63]
  v_mfma_f32_32x32x16_bf16 v[64:79], a[232:235], v[116:119], v[64:79]
  v_mfma_f32_32x32x16_bf16 v[80:95], a[236:239], v[116:119], v[80:95]
  ds_read_b128 v[112:115], v120 offset:32768
  ds_read_b128 v[116:119], v120 offset:36864
  s_waitcnt lgkmcnt(4)
  v_mfma_f32_32x32x16_bf16 v[32:47], a[240:243], v[96:99], v[32:47]
  v_mfma_f32_32x32x16_bf16 v[48:63], a[244:247], v[96:99], v[48:63]
  s_add_u32 m0, s71, 58368
  s_add_u32 s73, s72, 10112
  buffer_load_dwordx4 v5, s[52:55], s73 offen lds
  v_mfma_f32_32x32x16_bf16 v[64:79], a[240:243], v[100:103], v[64:79]
  v_mfma_f32_32x32x16_bf16 v[80:95], a[244:247], v[100:103], v[80:95]
  ds_read_b128 v[96:99], v121 offset:32768
  ds_read_b128 v[100:103], v121 offset:36864
  s_waitcnt lgkmcnt(4)
  v_mfma_f32_32x32x16_bf16 v[32:47], a[248:251], v[104:107], v[32:47]
  v_mfma_f32_32x32x16_bf16 v[48:63], a[252:255], v[104:107], v[48:63]
  v_mfma_f32_32x32x16_bf16 v[64:79], a[248:251], v[108:111], v[64:79]
  v_mfma_f32_32x32x16_bf16 v[80:95], a[252:255], v[108:111], v[80:95]
  ds_read_b128 v[104:107], v122 offset:32768
  ds_read_b128 v[108:111], v122 offset:36864
  s_waitcnt lgkmcnt(4)
  v_mfma_f32_32x32x16_bf16 v[32:47], v[224:227], v[112:115], v[32:47]
  v_mfma_f32_32x32x16_bf16 v[48:63], v[228:231], v[112:115], v[48:63]
  s_add_u32 m0, s71, 65536
  s_add_u32 s73, s72, 1024
  buffer_load_dwordx4 v4, s[52:55], s73 offen lds
  v_mfma_f32_32x32x16_bf16 v[64:79], v[224:227], v[116:119], v[64:79]
  v_mfma_f32_32x32x16_bf16 v[80:95], v[228:231], v[116:119], v[80:95]
  ds_read_b128 v[112:115], v123 offset:32768
  ds_read_b128 v[116:119], v123 offset:36864
  s_waitcnt lgkmcnt(4)
  v_mfma_f32_32x32x16_bf16 v[32:47], v[232:235], v[96:99], v[32:47]
  v_mfma_f32_32x32x16_bf16 v[48:63], v[236:239], v[96:99], v[48:63]
  v_mfma_f32_32x32x16_bf16 v[64:79], v[232:235], v[100:103], v[64:79]
  v_mfma_f32_32x32x16_bf16 v[80:95], v[236:239], v[100:103], v[80:95]
  s_waitcnt lgkmcnt(2)
  v_mfma_f32_32x32x16_bf16 v[32:47], v[240:243], v[104:107], v[32:47]
  v_mfma_f32_32x32x16_bf16 v[48:63], v[244:247], v[104:107], v[48:63]
  s_add_u32 m0, s71, 66560
  s_add_u32 s73, s72, 10240
  buffer_load_dwordx4 v5, s[52:55], s73 offen lds
  v_mfma_f32_32x32x16_bf16 v[64:79], v[240:243], v[108:111], v[64:79]
  v_mfma_f32_32x32x16_bf16 v[80:95], v[244:247], v[108:111], v[80:95]
  s_waitcnt lgkmcnt(0)
  v_mfma_f32_32x32x16_bf16 v[32:47], v[248:251], v[112:115], v[32:47]
  v_mfma_f32_32x32x16_bf16 v[48:63], v[252:255], v[112:115], v[48:63]
  v_mfma_f32_32x32x16_bf16 v[64:79], v[248:251], v[116:119], v[64:79]
  v_mfma_f32_32x32x16_bf16 v[80:95], v[252:255], v[116:119], v[80:95]
  s_lshl_b32 s4, s68, 6
  s_lshl_b32 s5, s12, 1
  s_add_u32 s4, s4, s5
  s_lshr_b32 s5, s3, 1
  s_add_u32 s4, s4, s5
  s_lshl_b32 s4, s4, 3
  s_and_b32 s5, s3, 1
  s_lshl_b32 s5, s5, 1
  s_add_u32 s4, s4, s5
  s_lshl_b32 s4, s4, 10
  s_add_u32 s76, s4, s84
  s_mov_b32 s82, 262144
  s_waitcnt vmcnt(0)
  s_nop 11
  s_add_u32 s74, s76, 0
  v_cvt_pk_bf16_f32 v120, v32, v33
  v_cvt_pk_bf16_f32 v121, v34, v35
  v_cvt_pk_bf16_f32 v122, v40, v41
  v_cvt_pk_bf16_f32 v123, v42, v43
  buffer_store_dwordx4 v[120:123], v10, s[48:51], s74 offen offset:0 sc1
  v_cvt_pk_bf16_f32 v124, v36, v37
  v_cvt_pk_bf16_f32 v125, v38, v39
  v_cvt_pk_bf16_f32 v126, v44, v45
  v_cvt_pk_bf16_f32 v127, v46, v47
  buffer_store_dwordx4 v[124:127], v10, s[48:51], s74 offen offset:512 sc1
  s_add_u32 s74, s76, 1024
  v_cvt_pk_bf16_f32 v128, v48, v49
  v_cvt_pk_bf16_f32 v129, v50, v51
  v_cvt_pk_bf16_f32 v130, v56, v57
  v_cvt_pk_bf16_f32 v131, v58, v59
  buffer_store_dwordx4 v[128:131], v10, s[48:51], s74 offen offset:0 sc1
  v_cvt_pk_bf16_f32 v132, v52, v53
  v_cvt_pk_bf16_f32 v133, v54, v55
  v_cvt_pk_bf16_f32 v134, v60, v61
  v_cvt_pk_bf16_f32 v135, v62, v63
  buffer_store_dwordx4 v[132:135], v10, s[48:51], s74 offen offset:512 sc1
  s_add_u32 s74, s76, 0
  s_add_u32 s74, s74, s82
  v_cvt_pk_bf16_f32 v120, v64, v65
  v_cvt_pk_bf16_f32 v121, v66, v67
  v_cvt_pk_bf16_f32 v122, v72, v73
  v_cvt_pk_bf16_f32 v123, v74, v75
  buffer_store_dwordx4 v[120:123], v10, s[48:51], s74 offen offset:0 sc1
  v_cvt_pk_bf16_f32 v124, v68, v69
  v_cvt_pk_bf16_f32 v125, v70, v71
  v_cvt_pk_bf16_f32 v126, v76, v77
  v_cvt_pk_bf16_f32 v127, v78, v79
  buffer_store_dwordx4 v[124:127], v10, s[48:51], s74 offen offset:512 sc1
  s_add_u32 s74, s76, 1024
  s_add_u32 s74, s74, s82
  v_cvt_pk_bf16_f32 v128, v80, v81
  v_cvt_pk_bf16_f32 v129, v82, v83
  v_cvt_pk_bf16_f32 v130, v88, v89
  v_cvt_pk_bf16_f32 v131, v90, v91
  buffer_store_dwordx4 v[128:131], v10, s[48:51], s74 offen offset:0 sc1
  v_cvt_pk_bf16_f32 v132, v84, v85
  v_cvt_pk_bf16_f32 v133, v86, v87
  v_cvt_pk_bf16_f32 v134, v92, v93
  v_cvt_pk_bf16_f32 v135, v94, v95
  buffer_store_dwordx4 v[132:135], v10, s[48:51], s74 offen offset:512 sc1
  s_barrier
  s_cmp_eq_u32 s77, -1
  s_cbranch_scc1 L_ns_4
  s_cmp_lg_u32 s79, 0
  s_cbranch_scc1 L_iwskip_5
  s_cmp_lg_u32 s3, 0
  s_cbranch_scc1 L_iwd_7
  v_mov_b32 v28, 0
L_iw_6:
  global_load_dword v29, v28, s[42:43] offset:16 sc1
  s_waitcnt vmcnt(0)
  v_readfirstlane_b32 s4, v29
  s_nop 1
  s_cmp_ge_u32 s4, 32
  s_cbranch_scc1 L_iwd_7
  s_sleep 4
  s_add_u32 s47, s47, 1
  s_cmp_gt_u32 s47, 131072
  s_cbranch_scc1 L_exit
  s_branch L_iw_6
L_iwd_7:
  s_mov_b32 s79, 1
L_iwskip_5:
  s_lshl_b32 s78, s77, 7
  s_add_u32 s78, s78, s83
  s_cmp_lg_u32 s3, 0
  s_cbranch_scc1 L_sig_8
  s_mov_b64 s[8:9], exec
  s_mov_b64 exec, 1
  v_mov_b32 v28, 0
  v_mov_b32 v29, 1
  buffer_atomic_add v29, v28, s[48:51], s78 offen
  s_mov_b64 exec, s[8:9]
L_sig_8:
L_ns_4:
  s_mov_b32 s77, s68
  s_mov_b32 s68, s10
  s_mov_b32 s70, s11
  s_cmp_lt_u32 s68, s69
  s_cbranch_scc1 L_w1loop_1
  s_waitcnt vmcnt(0)
  s_barrier
  s_lshl_b32 s78, s77, 7
  s_add_u32 s78, s78, s83
  s_cmp_lg_u32 s3, 0
  s_cbranch_scc1 L_iwd_10
  v_mov_b32 v28, 0
L_iw_9:
  global_load_dword v29, v28, s[42:43] offset:16 sc1
  s_waitcnt vmcnt(0)
  v_readfirstlane_b32 s4, v29
  s_nop 1
  s_cmp_ge_u32 s4, 32
  s_cbranch_scc1 L_iwd_10
  s_sleep 4
  s_add_u32 s47, s47, 1
  s_cmp_gt_u32 s47, 131072
  s_cbranch_scc1 L_exit
  s_branch L_iw_9
L_iwd_10:
  s_cmp_lg_u32 s3, 0
  s_cbranch_scc1 L_sig_11
  s_mov_b64 s[8:9], exec
  s_mov_b64 exec, 1
  v_mov_b32 v28, 0
  v_mov_b32 v29, 1
  buffer_atomic_add v29, v28, s[48:51], s78 offen
  s_mov_b64 exec, s[8:9]
L_sig_11:
  s_waitcnt vmcnt(0)
  s_branch L_w1_next
L_w1_v:
  s_mov_b32 s10, s24
  s_mov_b32 s11, s25
  s_mov_b32 s84, 17825792
  s_lshl_b32 s13, s12, 9
  s_add_u32 s56, s10, s13
  s_addc_u32 s57, s11, 0
  s_mov_b32 s58, 4718592
  s_mov_b32 s59, 0x20000
  s_add_u32 s13, s13, 256
  s_add_u32 s60, s10, s13
  s_addc_u32 s61, s11, 0
  s_mov_b32 s62, 4718592
  s_mov_b32 s63, 0x20000
  s_mov_b32 s52, s16
  s_mov_b32 s53, s17
  s_mov_b32 s54, 2359296
  s_mov_b32 s55, 0x20000
  v_lshrrev_b32 v12, 4, v0
  v_and_b32 v13, 15, v0
  v_lshlrev_b32 v14, 2, v12
  v_xor_b32 v13, v13, v14
  v_lshlrev_b32 v13, 4, v13
  s_mov_b32 s4, 8192
  v_mul_lo_u32 v12, v12, s4
  v_add_u32 v11, v12, v13
  v_lshrrev_b32 v12, 5, v0
  v_lshlrev_b32 v12, 3, v12
  v_bfe_u32 v13, v0, 2, 2
  v_add_u32 v12, v12, v13
  v_lshlrev_b32 v12, 8, v12
  v_bfe_u32 v14, v0, 4, 1
  v_lshlrev_b32 v14, 1, v14
  v_bfe_u32 v15, v0, 1, 1
  v_add_u32 v14, v14, v15
  v_lshlrev_b32 v13, 2, v13
  v_and_b32 v15, 1, v0
  v_lshlrev_b32 v15, 3, v15
  v_add_u32 v12, v12, v15
  s_and_b32 s4, s3, 1
  s_lshl_b32 s4, s4, 3
  s_lshr_b32 s5, s3, 1
  s_lshl_b32 s5, s5, 14
  v_add_u32 v16, s4, v14
  v_xor_b32 v17, v16, v13
  v_lshlrev_b32 v17, 4, v17
  v_add3_u32 v2, v17, v12, s5
  v_add_u32 v16, 4, v16
  v_xor_b32 v17, v16, v13
  v_lshlrev_b32 v17, 4, v17
  v_add3_u32 v3, v17, v12, s5
  s_lshl_b32 s5, s3, 12
  s_add_u32 m0, s5, 0
  s_mul_i32 s4, s3, 131072
  s_add_u32 s4, s4, 0
  buffer_load_dwordx4 v11, s[56:59], s4 offen lds
  s_lshl_b32 s5, s3, 12
  s_add_u32 m0, s5, 1024
  s_mul_i32 s4, s3, 131072
  s_add_u32 s4, s4, 32768
  buffer_load_dwordx4 v11, s[56:59], s4 offen lds
  s_lshl_b32 s5, s3, 12
  s_add_u32 m0, s5, 2048
  s_mul_i32 s4, s3, 131072
  s_add_u32 s4, s4, 65536
  buffer_load_dwordx4 v11, s[56:59], s4 offen lds
  s_lshl_b32 s5, s3, 12
  s_add_u32 m0, s5, 3072
  s_mul_i32 s4, s3, 131072
  s_add_u32 s4, s4, 98304
  buffer_load_dwordx4 v11, s[56:59], s4 offen lds
  s_lshl_b32 s5, s3, 12
  s_add_u32 m0, s5, 16384
  s_mul_i32 s4, s3, 131072
  s_add_u32 s4, s4, 0
  buffer_load_dwordx4 v11, s[60:63], s4 offen lds
  s_lshl_b32 s5, s3, 12
  s_add_u32 m0, s5, 17408
  s_mul_i32 s4, s3, 131072
  s_add_u32 s4, s4, 32768
  buffer_load_dwordx4 v11, s[60:63], s4 offen lds
  s_lshl_b32 s5, s3, 12
  s_add_u32 m0, s5, 18432
  s_mul_i32 s4, s3, 131072
  s_add_u32 s4, s4, 65536
  buffer_load_dwordx4 v11, s[60:63], s4 offen lds
  s_lshl_b32 s5, s3, 12
  s_add_u32 m0, s5, 19456
  s_mul_i32 s4, s3, 131072
  s_add_u32 s4, s4, 98304
  buffer_load_dwordx4 v11, s[60:63], s4 offen lds
  s_lshl_b32 s5, s3, 12
  s_add_u32 m0, s5, 32768
  s_mul_i32 s4, s3, 131072
  s_add_u32 s4, s4, 524288
  buffer_load_dwordx4 v11, s[56:59], s4 offen lds
  s_lshl_b32 s5, s3, 12
  s_add_u32 m0, s5, 33792
  s_mul_i32 s4, s3, 131072
  s_add_u32 s4, s4, 557056
  buffer_load_dwordx4 v11, s[56:59], s4 offen lds
  s_lshl_b32 s5, s3, 12
  s_add_u32 m0, s5, 34816
  s_mul_i32 s4, s3, 131072
  s_add_u32 s4, s4, 589824
  buffer_load_dwordx4 v11, s[56:59], s4 offen lds
  s_lshl_b32 s5, s3, 12
  s_add_u32 m0, s5, 35840
  s_mul_i32 s4, s3, 131072
  s_add_u32 s4, s4, 622592
  buffer_load_dwordx4 v11, s[56:59], s4 offen lds
  s_lshl_b32 s5, s3, 12
  s_add_u32 m0, s5, 49152
  s_mul_i32 s4, s3, 131072
  s_add_u32 s4, s4, 524288
  buffer_load_dwordx4 v11, s[60:63], s4 offen lds
  s_lshl_b32 s5, s3, 12
  s_add_u32 m0, s5, 50176
  s_mul_i32 s4, s3, 131072
  s_add_u32 s4, s4, 557056
  buffer_load_dwordx4 v11, s[60:63], s4 offen lds
  s_lshl_b32 s5, s3, 12
  s_add_u32 m0, s5, 51200
  s_mul_i32 s4, s3, 131072
  s_add_u32 s4, s4, 589824
  buffer_load_dwordx4 v11, s[60:63], s4 offen lds
  s_lshl_b32 s5, s3, 12
  s_add_u32 m0, s5, 52224
  s_mul_i32 s4, s3, 131072
  s_add_u32 s4, s4, 622592
  buffer_load_dwordx4 v11, s[60:63], s4 offen lds
  s_lshl_b32 s5, s3, 12
  s_add_u32 m0, s5, 65536
  s_mul_i32 s4, s3, 131072
  s_add_u32 s4, s4, 1048576
  buffer_load_dwordx4 v11, s[56:59], s4 offen lds
  s_lshl_b32 s5, s3, 12
  s_add_u32 m0, s5, 66560
  s_mul_i32 s4, s3, 131072
  s_add_u32 s4, s4, 1081344
  buffer_load_dwordx4 v11, s[56:59], s4 offen lds
  s_lshl_b32 s5, s3, 12
  s_add_u32 m0, s5, 67584
  s_mul_i32 s4, s3, 131072
  s_add_u32 s4, s4, 1114112
  buffer_load_dwordx4 v11, s[56:59], s4 offen lds
  s_lshl_b32 s5, s3, 12
  s_add_u32 m0, s5, 68608
  s_mul_i32 s4, s3, 131072
  s_add_u32 s4, s4, 1146880
  buffer_load_dwordx4 v11, s[56:59], s4 offen lds
  s_lshl_b32 s5, s3, 12
  s_add_u32 m0, s5, 81920
  s_mul_i32 s4, s3, 131072
  s_add_u32 s4, s4, 1048576
  buffer_load_dwordx4 v11, s[60:63], s4 offen lds
  s_lshl_b32 s5, s3, 12
  s_add_u32 m0, s5, 82944
  s_mul_i32 s4, s3, 131072
  s_add_u32 s4, s4, 1081344
  buffer_load_dwordx4 v11, s[60:63], s4 offen lds
  s_lshl_b32 s5, s3, 12
  s_add_u32 m0, s5, 83968
  s_mul_i32 s4, s3, 131072
  s_add_u32 s4, s4, 1114112
  buffer_load_dwordx4 v11, s[60:63], s4 offen lds
  s_lshl_b32 s5, s3, 12
  s_add_u32 m0, s5, 84992
  s_mul_i32 s4, s3, 131072
  s_add_u32 s4, s4, 1146880
  buffer_load_dwordx4 v11, s[60:63], s4 offen lds
  s_lshl_b32 s5, s3, 12
  s_add_u32 m0, s5, 98304
  s_mul_i32 s4, s3, 131072
  s_add_u32 s4, s4, 1572864
  buffer_load_dwordx4 v11, s[56:59], s4 offen lds
  s_lshl_b32 s5, s3, 12
  s_add_u32 m0, s5, 99328
  s_mul_i32 s4, s3, 131072
  s_add_u32 s4, s4, 1605632
  buffer_load_dwordx4 v11, s[56:59], s4 offen lds
  s_lshl_b32 s5, s3, 12
  s_add_u32 m0, s5, 100352
  s_mul_i32 s4, s3, 131072
  s_add_u32 s4, s4, 1638400
  buffer_load_dwordx4 v11, s[56:59], s4 offen lds
  s_lshl_b32 s5, s3, 12
  s_add_u32 m0, s5, 101376
  s_mul_i32 s4, s3, 131072
  s_add_u32 s4, s4, 1671168
  buffer_load_dwordx4 v11, s[56:59], s4 offen lds
  s_lshl_b32 s5, s3, 12
  s_add_u32 m0, s5, 114688
  s_mul_i32 s4, s3, 131072
  s_add_u32 s4, s4, 1572864
  buffer_load_dwordx4 v11, s[60:63], s4 offen lds
  s_lshl_b32 s5, s3, 12
  s_add_u32 m0, s5, 115712
  s_mul_i32 s4, s3, 131072
  s_add_u32 s4, s4, 1605632
  buffer_load_dwordx4 v11, s[60:63], s4 offen lds
  s_lshl_b32 s5, s3, 12
  s_add_u32 m0, s5, 116736
  s_mul_i32 s4, s3, 131072
  s_add_u32 s4, s4, 1638400
  buffer_load_dwordx4 v11, s[60:63], s4 offen lds
  s_lshl_b32 s5, s3, 12
  s_add_u32 m0, s5, 117760
  s_mul_i32 s4, s3, 131072
  s_add_u32 s4, s4, 1671168
  buffer_load_dwordx4 v11, s[60:63], s4 offen lds
  s_lshl_b32 s5, s3, 12
  s_add_u32 m0, s5, 131072
  s_mul_i32 s4, s3, 131072
  s_add_u32 s4, s4, 2097152
  buffer_load_dwordx4 v11, s[56:59], s4 offen lds
  s_lshl_b32 s5, s3, 12
  s_add_u32 m0, s5, 132096
  s_mul_i32 s4, s3, 131072
  s_add_u32 s4, s4, 2129920
  buffer_load_dwordx4 v11, s[56:59], s4 offen lds
  s_lshl_b32 s5, s3, 12
  s_add_u32 m0, s5, 133120
  s_mul_i32 s4, s3, 131072
  s_add_u32 s4, s4, 2162688
  buffer_load_dwordx4 v11, s[56:59], s4 offen lds
  s_lshl_b32 s5, s3, 12
  s_add_u32 m0, s5, 134144
  s_mul_i32 s4, s3, 131072
  s_add_u32 s4, s4, 2195456
  buffer_load_dwordx4 v11, s[56:59], s4 offen lds
  s_lshl_b32 s5, s3, 12
  s_add_u32 m0, s5, 147456
  s_mul_i32 s4, s3, 131072
  s_add_u32 s4, s4, 2097152
  buffer_load_dwordx4 v11, s[60:63], s4 offen lds
  s_lshl_b32 s5, s3, 12
  s_add_u32 m0, s5, 148480
  s_mul_i32 s4, s3, 131072
  s_add_u32 s4, s4, 2129920
  buffer_load_dwordx4 v11, s[60:63], s4 offen lds
  s_lshl_b32 s5, s3, 12
  s_add_u32 m0, s5, 149504
  s_mul_i32 s4, s3, 131072
  s_add_u32 s4, s4, 2162688
  buffer_load_dwordx4 v11, s[60:63], s4 offen lds
  s_lshl_b32 s5, s3, 12
  s_add_u32 m0, s5, 150528
  s_mul_i32 s4, s3, 131072
  s_add_u32 s4, s4, 2195456
  buffer_load_dwordx4 v11, s[60:63], s4 offen lds
  s_waitcnt vmcnt(32)
  s_barrier
  v_add_u32 v18, 0, v2
  v_add_u32 v19, 0, v3
  ds_read_b64_tr_b16 a[0:1], v18 offset:0
  ds_read_b64_tr_b16 a[2:3], v18 offset:1024
  ds_read_b64_tr_b16 a[4:5], v19 offset:0
  ds_read_b64_tr_b16 a[6:7], v19 offset:1024
  ds_read_b64_tr_b16 a[8:9], v18 offset:4096
  ds_read_b64_tr_b16 a[10:11], v18 offset:5120
  ds_read_b64_tr_b16 a[12:13], v19 offset:4096
  ds_read_b64_tr_b16 a[14:15], v19 offset:5120
  ds_read_b64_tr_b16 a[16:17], v18 offset:8192
  ds_read_b64_tr_b16 a[18:19], v18 offset:9216
  ds_read_b64_tr_b16 a[20:21], v19 offset:8192
  ds_read_b64_tr_b16 a[22:23], v19 offset:9216
  ds_read_b64_tr_b16 a[24:25], v18 offset:12288
  ds_read_b64_tr_b16 a[26:27], v18 offset:13312
  ds_read_b64_tr_b16 a[28:29], v19 offset:12288
  ds_read_b64_tr_b16 a[30:31], v19 offset:13312
  s_waitcnt lgkmcnt(0)
  s_waitcnt vmcnt(24)
  s_barrier
  s_lshl_b32 s5, s3, 12
  s_add_u32 m0, s5, 0
  s_mul_i32 s4, s3, 131072
  s_add_u32 s4, s4, 2621440
  buffer_load_dwordx4 v11, s[56:59], s4 offen lds
  s_lshl_b32 s5, s3, 12
  s_add_u32 m0, s5, 1024
  s_mul_i32 s4, s3, 131072
  s_add_u32 s4, s4, 2654208
  buffer_load_dwordx4 v11, s[56:59], s4 offen lds
  s_lshl_b32 s5, s3, 12
  s_add_u32 m0, s5, 2048
  s_mul_i32 s4, s3, 131072
  s_add_u32 s4, s4, 2686976
  buffer_load_dwordx4 v11, s[56:59], s4 offen lds
  s_lshl_b32 s5, s3, 12
  s_add_u32 m0, s5, 3072
  s_mul_i32 s4, s3, 131072
  s_add_u32 s4, s4, 2719744
  buffer_load_dwordx4 v11, s[56:59], s4 offen lds
  s_lshl_b32 s5, s3, 12
  s_add_u32 m0, s5, 16384
  s_mul_i32 s4, s3, 131072
  s_add_u32 s4, s4, 2621440
  buffer_load_dwordx4 v11, s[60:63], s4 offen lds
  s_lshl_b32 s5, s3, 12
  s_add_u32 m0, s5, 17408
  s_mul_i32 s4, s3, 131072
  s_add_u32 s4, s4, 2654208
  buffer_load_dwordx4 v11, s[60:63], s4 offen lds
  s_lshl_b32 s5, s3, 12
  s_add_u32 m0, s5, 18432
  s_mul_i32 s4, s3, 131072
  s_add_u32 s4, s4, 2686976
  buffer_load_dwordx4 v11, s[60:63], s4 offen lds
  s_lshl_b32 s5, s3, 12
  s_add_u32 m0, s5, 19456
  s_mul_i32 s4, s3, 131072
  s_add_u32 s4, s4, 2719744
  buffer_load_dwordx4 v11, s[60:63], s4 offen lds
  v_add_u32 v18, 32768, v2
  v_add_u32 v19, 32768, v3
  ds_read_b64_tr_b16 a[32:33], v18 offset:0
  ds_read_b64_tr_b16 a[34:35], v18 offset:1024
  ds_read_b64_tr_b16 a[36:37], v19 offset:0
  ds_read_b64_tr_b16 a[38:39], v19 offset:1024
  ds_read_b64_tr_b16 a[40:41], v18 offset:4096
  ds_read_b64_tr_b16 a[42:43], v18 offset:5120
  ds_read_b64_tr_b16 a[44:45], v19 offset:4096
  ds_read_b64_tr_b16 a[46:47], v19 offset:5120
  ds_read_b64_tr_b16 a[48:49], v18 offset:8192
  ds_read_b64_tr_b16 a[50:51], v18 offset:9216
  ds_read_b64_tr_b16 a[52:53], v19 offset:8192
  ds_read_b64_tr_b16 a[54:55], v19 offset:9216
  ds_read_b64_tr_b16 a[56:57], v18 offset:12288
  ds_read_b64_tr_b16 a[58:59], v18 offset:13312
  ds_read_b64_tr_b16 a[60:61], v19 offset:12288
  ds_read_b64_tr_b16 a[62:63], v19 offset:13312
  s_waitcnt lgkmcnt(0)
  s_waitcnt vmcnt(24)
  s_barrier
  s_lshl_b32 s5, s3, 12
  s_add_u32 m0, s5, 32768
  s_mul_i32 s4, s3, 131072
  s_add_u32 s4, s4, 3145728
  buffer_load_dwordx4 v11, s[56:59], s4 offen lds
  s_lshl_b32 s5, s3, 12
  s_add_u32 m0, s5, 33792
  s_mul_i32 s4, s3, 131072
  s_add_u32 s4, s4, 3178496
  buffer_load_dwordx4 v11, s[56:59], s4 offen lds
  s_lshl_b32 s5, s3, 12
  s_add_u32 m0, s5, 34816
  s_mul_i32 s4, s3, 131072
  s_add_u32 s4, s4, 3211264
  buffer_load_dwordx4 v11, s[56:59], s4 offen lds
  s_lshl_b32 s5, s3, 12
  s_add_u32 m0, s5, 35840
  s_mul_i32 s4, s3, 131072
  s_add_u32 s4, s4, 3244032
  buffer_load_dwordx4 v11, s[56:59], s4 offen lds
  s_lshl_b32 s5, s3, 12
  s_add_u32 m0, s5, 49152
  s_mul_i32 s4, s3, 131072
  s_add_u32 s4, s4, 3145728
  buffer_load_dwordx4 v11, s[60:63], s4 offen lds
  s_lshl_b32 s5, s3, 12
  s_add_u32 m0, s5, 50176
  s_mul_i32 s4, s3, 131072
  s_add_u32 s4, s4, 3178496
  buffer_load_dwordx4 v11, s[60:63], s4 offen lds
  s_lshl_b32 s5, s3, 12
  s_add_u32 m0, s5, 51200
  s_mul_i32 s4, s3, 131072
  s_add_u32 s4, s4, 3211264
  buffer_load_dwordx4 v11, s[60:63], s4 offen lds
  s_lshl_b32 s5, s3, 12
  s_add_u32 m0, s5, 52224
  s_mul_i32 s4, s3, 131072
  s_add_u32 s4, s4, 3244032
  buffer_load_dwordx4 v11, s[60:63], s4 offen lds
  v_add_u32 v18, 65536, v2
  v_add_u32 v19, 65536, v3
  ds_read_b64_tr_b16 a[64:65], v18 offset:0
  ds_read_b64_tr_b16 a[66:67], v18 offset:1024
  ds_read_b64_tr_b16 a[68:69], v19 offset:0
  ds_read_b64_tr_b16 a[70:71], v19 offset:1024
  ds_read_b64_tr_b16 a[72:73], v18 offset:4096
  ds_read_b64_tr_b16 a[74:75], v18 offset:5120
  ds_read_b64_tr_b16 a[76:77], v19 offset:4096
  ds_read_b64_tr_b16 a[78:79], v19 offset:5120
  ds_read_b64_tr_b16 a[80:81], v18 offset:8192
  ds_read_b64_tr_b16 a[82:83], v18 offset:9216
  ds_read_b64_tr_b16 a[84:85], v19 offset:8192
  ds_read_b64_tr_b16 a[86:87], v19 offset:9216
  ds_read_b64_tr_b16 a[88:89], v18 offset:12288
  ds_read_b64_tr_b16 a[90:91], v18 offset:13312
  ds_read_b64_tr_b16 a[92:93], v19 offset:12288
  ds_read_b64_tr_b16 a[94:95], v19 offset:13312
  s_waitcnt lgkmcnt(0)
  s_waitcnt vmcnt(24)
  s_barrier
  s_lshl_b32 s5, s3, 12
  s_add_u32 m0, s5, 65536
  s_mul_i32 s4, s3, 131072
  s_add_u32 s4, s4, 3670016
  buffer_load_dwordx4 v11, s[56:59], s4 offen lds
  s_lshl_b32 s5, s3, 12
  s_add_u32 m0, s5, 66560
  s_mul_i32 s4, s3, 131072
  s_add_u32 s4, s4, 3702784
  buffer_load_dwordx4 v11, s[56:59], s4 offen lds
  s_lshl_b32 s5, s3, 12
  s_add_u32 m0, s5, 67584
  s_mul_i32 s4, s3, 131072
  s_add_u32 s4, s4, 3735552
  buffer_load_dwordx4 v11, s[56:59], s4 offen lds
  s_lshl_b32 s5, s3, 12
  s_add_u32 m0, s5, 68608
  s_mul_i32 s4, s3, 131072
  s_add_u32 s4, s4, 3768320
  buffer_load_dwordx4 v11, s[56:59], s4 offen lds
  s_lshl_b32 s5, s3, 12
  s_add_u32 m0, s5, 81920
  s_mul_i32 s4, s3, 131072
  s_add_u32 s4, s4, 3670016
  buffer_load_dwordx4 v11, s[60:63], s4 offen lds
  s_lshl_b32 s5, s3, 12
  s_add_u32 m0, s5, 82944
  s_mul_i32 s4, s3, 131072
  s_add_u32 s4, s4, 3702784
  buffer_load_dwordx4 v11, s[60:63], s4 offen lds
  s_lshl_b32 s5, s3, 12
  s_add_u32 m0, s5, 83968
  s_mul_i32 s4, s3, 131072
  s_add_u32 s4, s4, 3735552
  buffer_load_dwordx4 v11, s[60:63], s4 offen lds
  s_lshl_b32 s5, s3, 12
  s_add_u32 m0, s5, 84992
  s_mul_i32 s4, s3, 131072
  s_add_u32 s4, s4, 3768320
  buffer_load_dwordx4 v11, s[60:63], s4 offen lds
  v_add_u32 v18, 98304, v2
  v_add_u32 v19, 98304, v3
  ds_read_b64_tr_b16 a[96:97], v18 offset:0
  ds_read_b64_tr_b16 a[98:99], v18 offset:1024
  ds_read_b64_tr_b16 a[100:101], v19 offset:0
  ds_read_b64_tr_b16 a[102:103], v19 offset:1024
  ds_read_b64_tr_b16 a[104:105], v18 offset:4096
  ds_read_b64_tr_b16 a[106:107], v18 offset:5120
  ds_read_b64_tr_b16 a[108:109], v19 offset:4096
  ds_read_b64_tr_b16 a[110:111], v19 offset:5120
  ds_read_b64_tr_b16 a[112:113], v18 offset:8192
  ds_read_b64_tr_b16 a[114:115], v18 offset:9216
  ds_read_b64_tr_b16 a[116:117], v19 offset:8192
  ds_read_b64_tr_b16 a[118:119], v19 offset:9216
  ds_read_b64_tr_b16 a[120:121], v18 offset:12288
  ds_read_b64_tr_b16 a[122:123], v18 offset:13312
  ds_read_b64_tr_b16 a[124:125], v19 offset:12288
  ds_read_b64_tr_b16 a[126:127], v19 offset:13312
  s_waitcnt lgkmcnt(0)
  s_waitcnt vmcnt(24)
  s_barrier
  s_lshl_b32 s5, s3, 12
  s_add_u32 m0, s5, 98304
  s_mul_i32 s4, s3, 131072
  s_add_u32 s4, s4, 4194304
  buffer_load_dwordx4 v11, s[56:59], s4 offen lds
  s_lshl_b32 s5, s3, 12
  s_add_u32 m0, s5, 99328
  s_mul_i32 s4, s3, 131072
  s_add_u32 s4, s4, 4227072
  buffer_load_dwordx4 v11, s[56:59], s4 offen lds
  s_lshl_b32 s5, s3, 12
  s_add_u32 m0, s5, 100352
  s_mul_i32 s4, s3, 131072
  s_add_u32 s4, s4, 4259840
  buffer_load_dwordx4 v11, s[56:59], s4 offen lds
  s_lshl_b32 s5, s3, 12
  s_add_u32 m0, s5, 101376
  s_mul_i32 s4, s3, 131072
  s_add_u32 s4, s4, 4292608
  buffer_load_dwordx4 v11, s[56:59], s4 offen lds
  s_lshl_b32 s5, s3, 12
  s_add_u32 m0, s5, 114688
  s_mul_i32 s4, s3, 131072
  s_add_u32 s4, s4, 4194304
  buffer_load_dwordx4 v11, s[60:63], s4 offen lds
  s_lshl_b32 s5, s3, 12
  s_add_u32 m0, s5, 115712
  s_mul_i32 s4, s3, 131072
  s_add_u32 s4, s4, 4227072
  buffer_load_dwordx4 v11, s[60:63], s4 offen lds
  s_lshl_b32 s5, s3, 12
  s_add_u32 m0, s5, 116736
  s_mul_i32 s4, s3, 131072
  s_add_u32 s4, s4, 4259840
  buffer_load_dwordx4 v11, s[60:63], s4 offen lds
  s_lshl_b32 s5, s3, 12
  s_add_u32 m0, s5, 117760
  s_mul_i32 s4, s3, 131072
  s_add_u32 s4, s4, 4292608
  buffer_load_dwordx4 v11, s[60:63], s4 offen lds
  v_add_u32 v18, 131072, v2
  v_add_u32 v19, 131072, v3
  ds_read_b64_tr_b16 a[128:129], v18 offset:0
  ds_read_b64_tr_b16 a[130:131], v18 offset:1024
  ds_read_b64_tr_b16 a[132:133], v19 offset:0
  ds_read_b64_tr_b16 a[134:135], v19 offset:1024
  ds_read_b64_tr_b16 a[136:137], v18 offset:4096
  ds_read_b64_tr_b16 a[138:139], v18 offset:5120
  ds_read_b64_tr_b16 a[140:141], v19 offset:4096
  ds_read_b64_tr_b16 a[142:143], v19 offset:5120
  ds_read_b64_tr_b16 a[144:145], v18 offset:8192
  ds_read_b64_tr_b16 a[146:147], v18 offset:9216
  ds_read_b64_tr_b16 a[148:149], v19 offset:8192
  ds_read_b64_tr_b16 a[150:151], v19 offset:9216
  ds_read_b64_tr_b16 a[152:153], v18 offset:12288
  ds_read_b64_tr_b16 a[154:155], v18 offset:13312
  ds_read_b64_tr_b16 a[156:157], v19 offset:12288
  ds_read_b64_tr_b16 a[158:159], v19 offset:13312
  s_waitcnt lgkmcnt(0)
  s_waitcnt vmcnt(24)
  s_barrier
  v_add_u32 v18, 0, v2
  v_add_u32 v19, 0, v3
  ds_read_b64_tr_b16 a[160:161], v18 offset:0
  ds_read_b64_tr_b16 a[162:163], v18 offset:1024
  ds_read_b64_tr_b16 a[164:165], v19 offset:0
  ds_read_b64_tr_b16 a[166:167], v19 offset:1024
  ds_read_b64_tr_b16 a[168:169], v18 offset:4096
  ds_read_b64_tr_b16 a[170:171], v18 offset:5120
  ds_read_b64_tr_b16 a[172:173], v19 offset:4096
  ds_read_b64_tr_b16 a[174:175], v19 offset:5120
  ds_read_b64_tr_b16 a[176:177], v18 offset:8192
  ds_read_b64_tr_b16 a[178:179], v18 offset:9216
  ds_read_b64_tr_b16 a[180:181], v19 offset:8192
  ds_read_b64_tr_b16 a[182:183], v19 offset:9216
  ds_read_b64_tr_b16 a[184:185], v18 offset:12288
  ds_read_b64_tr_b16 a[186:187], v18 offset:13312
  ds_read_b64_tr_b16 a[188:189], v19 offset:12288
  ds_read_b64_tr_b16 a[190:191], v19 offset:13312
  s_waitcnt lgkmcnt(0)
  s_waitcnt vmcnt(16)
  s_barrier
  v_add_u32 v18, 32768, v2
  v_add_u32 v19, 32768, v3
  ds_read_b64_tr_b16 a[192:193], v18 offset:0
  ds_read_b64_tr_b16 a[194:195], v18 offset:1024
  ds_read_b64_tr_b16 a[196:197], v19 offset:0
  ds_read_b64_tr_b16 a[198:199], v19 offset:1024
  ds_read_b64_tr_b16 a[200:201], v18 offset:4096
  ds_read_b64_tr_b16 a[202:203], v18 offset:5120
  ds_read_b64_tr_b16 a[204:205], v19 offset:4096
  ds_read_b64_tr_b16 a[206:207], v19 offset:5120
  ds_read_b64_tr_b16 a[208:209], v18 offset:8192
  ds_read_b64_tr_b16 a[210:211], v18 offset:9216
  ds_read_b64_tr_b16 a[212:213], v19 offset:8192
  ds_read_b64_tr_b16 a[214:215], v19 offset:9216
  ds_read_b64_tr_b16 a[216:217], v18 offset:12288
  ds_read_b64_tr_b16 a[218:219], v18 offset:13312
  ds_read_b64_tr_b16 a[220:221], v19 offset:12288
  ds_read_b64_tr_b16 a[222:223], v19 offset:13312
  s_waitcnt lgkmcnt(0)
  s_waitcnt vmcnt(8)
  s_barrier
  v_add_u32 v18, 65536, v2
  v_add_u32 v19, 65536, v3
  ds_read_b64_tr_b16 a[224:225], v18 offset:0
  ds_read_b64_tr_b16 a[226:227], v18 offset:1024
  ds_read_b64_tr_b16 a[228:229], v19 offset:0
  ds_read_b64_tr_b16 a[230:231], v19 offset:1024
  ds_read_b64_tr_b16 a[232:233], v18 offset:4096
  ds_read_b64_tr_b16 a[234:235], v18 offset:5120
  ds_read_b64_tr_b16 a[236:237], v19 offset:4096
  ds_read_b64_tr_b16 a[238:239], v19 offset:5120
  ds_read_b64_tr_b16 a[240:241], v18 offset:8192
  ds_read_b64_tr_b16 a[242:243], v18 offset:9216
  ds_read_b64_tr_b16 a[244:245], v19 offset:8192
  ds_read_b64_tr_b16 a[246:247], v19 offset:9216
  ds_read_b64_tr_b16 a[248:249], v18 offset:12288
  ds_read_b64_tr_b16 a[250:251], v18 offset:13312
  ds_read_b64_tr_b16 a[252:253], v19 offset:12288
  ds_read_b64_tr_b16 a[254:255], v19 offset:13312
  s_waitcnt lgkmcnt(0)
  s_waitcnt vmcnt(0)
  s_barrier
  v_add_u32 v18, 98304, v2
  v_add_u32 v19, 98304, v3
  ds_read_b64_tr_b16 v[224:225], v18 offset:0
  ds_read_b64_tr_b16 v[226:227], v18 offset:1024
  ds_read_b64_tr_b16 v[228:229], v19 offset:0
  ds_read_b64_tr_b16 v[230:231], v19 offset:1024
  ds_read_b64_tr_b16 v[232:233], v18 offset:4096
  ds_read_b64_tr_b16 v[234:235], v18 offset:5120
  ds_read_b64_tr_b16 v[236:237], v19 offset:4096
  ds_read_b64_tr_b16 v[238:239], v19 offset:5120
  ds_read_b64_tr_b16 v[240:241], v18 offset:8192
  ds_read_b64_tr_b16 v[242:243], v18 offset:9216
  ds_read_b64_tr_b16 v[244:245], v19 offset:8192
  ds_read_b64_tr_b16 v[246:247], v19 offset:9216
  ds_read_b64_tr_b16 v[248:249], v18 offset:12288
  ds_read_b64_tr_b16 v[250:251], v18 offset:13312
  ds_read_b64_tr_b16 v[252:253], v19 offset:12288
  ds_read_b64_tr_b16 v[254:255], v19 offset:13312
  s_waitcnt lgkmcnt(0)
  s_barrier
  v_lshrrev_b32 v12, 5, v0
  v_lshlrev_b32 v12, 8, v12
  v_and_b32 v13, 15, v0
  v_lshlrev_b32 v13, 4, v13
  v_add_u32 v12, v12, v13
  v_bfe_u32 v13, v0, 4, 1
  v_mul_u32_u24 v13, 1024, v13
  v_add_u32 v10, v12, v13
  v_lshrrev_b32 v12, 3, v0
  s_movk_i32 s4, 1152
  v_mul_lo_u32 v12, v12, s4
  v_and_b32 v13, 7, v0
  v_lshrrev_b32 v14, 4, v0
  v_xor_b32 v15, v13, v14
  v_lshlrev_b32 v15, 4, v15
  v_add_u32 v4, v12, v15
  v_add_u32 v14, 4, v14
  v_xor_b32 v15, v13, v14
  v_lshlrev_b32 v15, 4, v15
  v_add_u32 v5, v12, v15
  v_and_b32 v12, 31, v0
  v_lshrrev_b32 v13, 5, v0
  v_bfe_u32 v14, v0, 1, 3
  v_lshlrev_b32 v12, 7, v12
  v_add_u32 v15, 0, v13
  v_xor_b32 v15, v15, v14
  v_lshlrev_b32 v15, 4, v15
  v_add_u32 v6, v12, v15
  v_add_u32 v15, 2, v13
  v_xor_b32 v15, v15, v14
  v_lshlrev_b32 v15, 4, v15
  v_add_u32 v7, v12, v15
  v_add_u32 v15, 4, v13
  v_xor_b32 v15, v15, v14
  v_lshlrev_b32 v15, 4, v15
  v_add_u32 v8, v12, v15
  v_add_u32 v15, 6, v13
  v_xor_b32 v15, v15, v14
  v_lshlrev_b32 v15, 4, v15
  v_add_u32 v9, v12, v15
  s_mov_b32 s71, 0
  s_lshl_b32 s4, s3, 11
  s_add_u32 s71, s71, s4
  s_mul_i32 s72, s68, 73728
  s_mul_i32 s5, s3, 18432
  s_add_u32 s72, s72, s5
  s_add_u32 m0, s71, 0
  s_add_u32 s73, s72, 0
  buffer_load_dwordx4 v4, s[52:55], s73 offen lds
  s_add_u32 m0, s71, 1024
  s_add_u32 s73, s72, 9216
  buffer_load_dwordx4 v5, s[52:55], s73 offen lds
  s_add_u32 m0, s71, 8192
  s_add_u32 s73, s72, 128
  buffer_load_dwordx4 v4, s[52:55], s73 offen lds
  s_add_u32 m0, s71, 9216
  s_add_u32 s73, s72, 9344
  buffer_load_dwordx4 v5, s[52:55], s73 offen lds
  s_add_u32 m0, s71, 16384
  s_add_u32 s73, s72, 256
  buffer_load_dwordx4 v4, s[52:55], s73 offen lds
  s_add_u32 m0, s71, 17408
  s_add_u32 s73, s72, 9472
  buffer_load_dwordx4 v5, s[52:55], s73 offen lds
  s_add_u32 m0, s71, 24576
  s_add_u32 s73, s72, 384
  buffer_load_dwordx4 v4, s[52:55], s73 offen lds
  s_add_u32 m0, s71, 25600
  s_add_u32 s73, s72, 9600
  buffer_load_dwordx4 v5, s[52:55], s73 offen lds
  s_add_u32 m0, s71, 32768
  s_add_u32 s73, s72, 512
  buffer_load_dwordx4 v4, s[52:55], s73 offen lds
  s_add_u32 m0, s71, 33792
  s_add_u32 s73, s72, 9728
  buffer_load_dwordx4 v5, s[52:55], s73 offen lds
  s_add_u32 m0, s71, 40960
  s_add_u32 s73, s72, 640
  buffer_load_dwordx4 v4, s[52:55], s73 offen lds
  s_add_u32 m0, s71, 41984
  s_add_u32 s73, s72, 9856
  buffer_load_dwordx4 v5, s[52:55], s73 offen lds
  s_add_u32 m0, s71, 49152
  s_add_u32 s73, s72, 768
  buffer_load_dwordx4 v4, s[52:55], s73 offen lds
  s_add_u32 m0, s71, 50176
  s_add_u32 s73, s72, 9984
  buffer_load_dwordx4 v5, s[52:55], s73 offen lds
  s_add_u32 m0, s71, 57344
  s_add_u32 s73, s72, 896
  buffer_load_dwordx4 v4, s[52:55], s73 offen lds
  s_add_u32 m0, s71, 58368
  s_add_u32 s73, s72, 10112
  buffer_load_dwordx4 v5, s[52:55], s73 offen lds
  s_add_u32 m0, s71, 65536
  s_add_u32 s73, s72, 1024
  buffer_load_dwordx4 v4, s[52:55], s73 offen lds
  s_add_u32 m0, s71, 66560
  s_add_u32 s73, s72, 10240
  buffer_load_dwordx4 v5, s[52:55], s73 offen lds
  s_mov_b32 s70, 0
  s_mov_b32 s77, -1
  s_waitcnt vmcnt(0)
  s_barrier
L_w1loop_12:
  s_add_u32 s10, s68, s75
  s_xor_b32 s71, s70, 73728
  s_lshl_b32 s4, s3, 11
  s_mul_i32 s72, s10, 73728
  s_mul_i32 s5, s3, 18432
  s_add_u32 s72, s72, s5
  s_mov_b32 s11, s71
  s_add_u32 s71, s71, s4
  v_add_u32 v120, s70, v6
  v_add_u32 v121, s70, v7
  v_add_u32 v122, s70, v8
  v_add_u32 v123, s70, v9
  ds_read_b128 v[96:99], v120 offset:0
  ds_read_b128 v[100:103], v120 offset:4096
  ds_read_b128 v[104:107], v121 offset:0
  ds_read_b128 v[108:111], v121 offset:4096
  ds_read_b128 v[112:115], v122 offset:0
  ds_read_b128 v[116:119], v122 offset:4096
  s_waitcnt lgkmcnt(4)
  v_mfma_f32_32x32x16_bf16 v[32:47], v[96:99], a[0:3], 0
  v_mfma_f32_32x32x16_bf16 v[48:63], v[96:99], a[4:7], 0
  s_add_u32 m0, s71, 0
  s_add_u32 s73, s72, 0
  buffer_load_dwordx4 v4, s[52:55], s73 offen lds
  v_mfma_f32_32x32x16_bf16 v[64:79], v[100:103], a[0:3], 0
  v_mfma_f32_32x32x16_bf16 v[80:95], v[100:103], a[4:7], 0
  ds_read_b128 v[96:99], v123 offset:0
  ds_read_b128 v[100:103], v123 offset:4096
  s_waitcnt lgkmcnt(4)
  v_mfma_f32_32x32x16_bf16 v[32:47], v[104:107], a[8:11], v[32:47]
  v_mfma_f32_32x32x16_bf16 v[48:63], v[104:107], a[12:15], v[48:63]
  v_mfma_f32_32x32x16_bf16 v[64:79], v[108:111], a[8:11], v[64:79]
  v_mfma_f32_32x32x16_bf16 v[80:95], v[108:111], a[12:15], v[80:95]
  ds_read_b128 v[104:107], v120 offset:8192
  ds_read_b128 v[108:111], v120 offset:12288
  s_waitcnt lgkmcnt(4)
  v_mfma_f32_32x32x16_bf16 v[32:47], v[112:115], a[16:19], v[32:47]
  v_mfma_f32_32x32x16_bf16 v[48:63], v[112:115], a[20:23], v[48:63]
  s_add_u32 m0, s71, 1024
  s_add_u32 s73, s72, 9216
  buffer_load_dwordx4 v5, s[52:55], s73 offen lds
  v_mfma_f32_32x32x16_bf16 v[64:79], v[116:119], a[16:19], v[64:79]
  v_mfma_f32_32x32x16_bf16 v[80:95], v[116:119], a[20:23], v[80:95]
  ds_read_b128 v[112:115], v121 offset:8192
  ds_read_b128 v[116:119], v121 offset:12288
  s_waitcnt lgkmcnt(4)
  v_mfma_f32_32x32x16_bf16 v[32:47], v[96:99], a[24:27], v[32:47]
  v_mfma_f32_32x32x16_bf16 v[48:63], v[96:99], a[28:31], v[48:63]
  v_mfma_f32_32x32x16_bf16 v[64:79], v[100:103], a[24:27], v[64:79]
  v_mfma_f32_32x32x16_bf16 v[80:95], v[100:103], a[28:31], v[80:95]
  ds_read_b128 v[96:99], v122 offset:8192
  ds_read_b128 v[100:103], v122 offset:12288
  s_waitcnt lgkmcnt(4)
  v_mfma_f32_32x32x16_bf16 v[32:47], v[104:107], a[32:35], v[32:47]
  v_mfma_f32_32x32x16_bf16 v[48:63], v[104:107], a[36:39], v[48:63]
  s_add_u32 m0, s71, 8192
  s_add_u32 s73, s72, 128
  buffer_load_dwordx4 v4, s[52:55], s73 offen lds
  v_mfma_f32_32x32x16_bf16 v[64:79], v[108:111], a[32:35], v[64:79]
  v_mfma_f32_32x32x16_bf16 v[80:95], v[108:111], a[36:39], v[80:95]
  ds_read_b128 v[104:107], v123 offset:8192
  ds_read_b128 v[108:111], v123 offset:12288
  s_waitcnt lgkmcnt(4)
  v_mfma_f32_32x32x16_bf16 v[32:47], v[112:115], a[40:43], v[32:47]
  v_mfma_f32_32x32x16_bf16 v[48:63], v[112:115], a[44:47], v[48:63]
  v_mfma_f32_32x32x16_bf16 v[64:79], v[116:119], a[40:43], v[64:79]
  v_mfma_f32_32x32x16_bf16 v[80:95], v[116:119], a[44:47], v[80:95]
  ds_read_b128 v[112:115], v120 offset:16384
  ds_read_b128 v[116:119], v120 offset:20480
  s_waitcnt lgkmcnt(4)
  v_mfma_f32_32x32x16_bf16 v[32:47], v[96:99], a[48:51], v[32:47]
  v_mfma_f32_32x32x16_bf16 v[48:63], v[96:99], a[52:55], v[48:63]
  s_add_u32 m0, s71, 9216
  s_add_u32 s73, s72, 9344
  buffer_load_dwordx4 v5, s[52:55], s73 offen lds
  v_mfma_f32_32x32x16_bf16 v[64:79], v[100:103], a[48:51], v[64:79]
  v_mfma_f32_32x32x16_bf16 v[80:95], v[100:103], a[52:55], v[80:95]
  ds_read_b128 v[96:99], v121 offset:16384
  ds_read_b128 v[100:103], v121 offset:20480
  s_waitcnt lgkmcnt(4)
  v_mfma_f32_32x32x16_bf16 v[32:47], v[104:107], a[56:59], v[32:47]
  v_mfma_f32_32x32x16_bf16 v[48:63], v[104:107], a[60:63], v[48:63]
  v_mfma_f32_32x32x16_bf16 v[64:79], v[108:111], a[56:59], v[64:79]
  v_mfma_f32_32x32x16_bf16 v[80:95], v[108:111], a[60:63], v[80:95]
  ds_read_b128 v[104:107], v122 offset:16384
  ds_read_b128 v[108:111], v122 offset:20480
  s_waitcnt lgkmcnt(4)
  v_mfma_f32_32x32x16_bf16 v[32:47], v[112:115], a[64:67], v[32:47]
  v_mfma_f32_32x32x16_bf16 v[48:63], v[112:115], a[68:71], v[48:63]
  s_add_u32 m0, s71, 16384
  s_add_u32 s73, s72, 256
  buffer_load_dwordx4 v4, s[52:55], s73 offen lds
  v_mfma_f32_32x32x16_bf16 v[64:79], v[116:119], a[64:67], v[64:79]
  v_mfma_f32_32x32x16_bf16 v[80:95], v[116:119], a[68:71], v[80:95]
  ds_read_b128 v[112:115], v123 offset:16384
  ds_read_b128 v[116:119], v123 offset:20480
  s_waitcnt lgkmcnt(4)
  v_mfma_f32_32x32x16_bf16 v[32:47], v[96:99], a[72:75], v[32:47]
  v_mfma_f32_32x32x16_bf16 v[48:63], v[96:99], a[76:79], v[48:63]
  v_mfma_f32_32x32x16_bf16 v[64:79], v[100:103], a[72:75], v[64:79]
  v_mfma_f32_32x32x16_bf16 v[80:95], v[100:103], a[76:79], v[80:95]
  ds_read_b128 v[96:99], v120 offset:24576
  ds_read_b128 v[100:103], v120 offset:28672
  s_waitcnt lgkmcnt(4)
  v_mfma_f32_32x32x16_bf16 v[32:47], v[104:107], a[80:83], v[32:47]
  v_mfma_f32_32x32x16_bf16 v[48:63], v[104:107], a[84:87], v[48:63]
  s_add_u32 m0, s71, 17408
  s_add_u32 s73, s72, 9472
  buffer_load_dwordx4 v5, s[52:55], s73 offen lds
  v_mfma_f32_32x32x16_bf16 v[64:79], v[108:111], a[80:83], v[64:79]
  v_mfma_f32_32x32x16_bf16 v[80:95], v[108:111], a[84:87], v[80:95]
  ds_read_b128 v[104:107], v121 offset:24576
  ds_read_b128 v[108:111], v121 offset:28672
  s_waitcnt lgkmcnt(4)
  v_mfma_f32_32x32x16_bf16 v[32:47], v[112:115], a[88:91], v[32:47]
  v_mfma_f32_32x32x16_bf16 v[48:63], v[112:115], a[92:95], v[48:63]
  v_mfma_f32_32x32x16_bf16 v[64:79], v[116:119], a[88:91], v[64:79]
  v_mfma_f32_32x32x16_bf16 v[80:95], v[116:119], a[92:95], v[80:95]
  ds_read_b128 v[112:115], v122 offset:24576
  ds_read_b128 v[116:119], v122 offset:28672
  s_waitcnt lgkmcnt(4)
  v_mfma_f32_32x32x16_bf16 v[32:47], v[96:99], a[96:99], v[32:47]
  v_mfma_f32_32x32x16_bf16 v[48:63], v[96:99], a[100:103], v[48:63]
  s_add_u32 m0, s71, 24576
  s_add_u32 s73, s72, 384
  buffer_load_dwordx4 v4, s[52:55], s73 offen lds
  v_mfma_f32_32x32x16_bf16 v[64:79], v[100:103], a[96:99], v[64:79]
  v_mfma_f32_32x32x16_bf16 v[80:95], v[100:103], a[100:103], v[80:95]
  ds_read_b128 v[96:99], v123 offset:24576
  ds_read_b128 v[100:103], v123 offset:28672
  s_waitcnt lgkmcnt(4)
  v_mfma_f32_32x32x16_bf16 v[32:47], v[104:107], a[104:107], v[32:47]
  v_mfma_f32_32x32x16_bf16 v[48:63], v[104:107], a[108:111], v[48:63]
  v_mfma_f32_32x32x16_bf16 v[64:79], v[108:111], a[104:107], v[64:79]
  v_mfma_f32_32x32x16_bf16 v[80:95], v[108:111], a[108:111], v[80:95]
  v_add_u32 v120, 0x8000, v120
  v_add_u32 v121, 0x8000, v121
  v_add_u32 v122, 0x8000, v122
  v_add_u32 v123, 0x8000, v123
  ds_read_b128 v[104:107], v120 offset:0
  ds_read_b128 v[108:111], v120 offset:4096
  s_waitcnt lgkmcnt(4)
  v_mfma_f32_32x32x16_bf16 v[32:47], v[112:115], a[112:115], v[32:47]
  v_mfma_f32_32x32x16_bf16 v[48:63], v[112:115], a[116:119], v[48:63]
  s_add_u32 m0, s71, 25600
  s_add_u32 s73, s72, 9600
  buffer_load_dwordx4 v5, s[52:55], s73 offen lds
  v_mfma_f32_32x32x16_bf16 v[64:79], v[116:119], a[112:115], v[64:79]
  v_mfma_f32_32x32x16_bf16 v[80:95], v[116:119], a[116:119], v[80:95]
  ds_read_b128 v[112:115], v121 offset:0
  ds_read_b128 v[116:119], v121 offset:4096
  s_waitcnt lgkmcnt(4)
  v_mfma_f32_32x32x16_bf16 v[32:47], v[96:99], a[120:123], v[32:47]
  v_mfma_f32_32x32x16_bf16 v[48:63], v[96:99], a[124:127], v[48:63]
  v_mfma_f32_32x32x16_bf16 v[64:79], v[100:103], a[120:123], v[64:79]
  v_mfma_f32_32x32x16_bf16 v[80:95], v[100:103], a[124:127], v[80:95]
  ds_read_b128 v[96:99], v122 offset:0
  ds_read_b128 v[100:103], v122 offset:4096
  s_waitcnt lgkmcnt(4)
  v_mfma_f32_32x32x16_bf16 v[32:47], v[104:107], a[128:131], v[32:47]
  v_mfma_f32_32x32x16_bf16 v[48:63], v[104:107], a[132:135], v[48:63]
  s_add_u32 m0, s71, 32768
  s_add_u32 s73, s72, 512
  buffer_load_dwordx4 v4, s[52:55], s73 offen lds
  v_mfma_f32_32x32x16_bf16 v[64:79], v[108:111], a[128:131], v[64:79]
  v_mfma_f32_32x32x16_bf16 v[80:95], v[108:111], a[132:135], v[80:95]
  ds_read_b128 v[104:107], v123 offset:0
  ds_read_b128 v[108:111], v123 offset:4096
  s_waitcnt lgkmcnt(4)
  v_mfma_f32_32x32x16_bf16 v[32:47], v[112:115], a[136:139], v[32:47]
  v_mfma_f32_32x32x16_bf16 v[48:63], v[112:115], a[140:143], v[48:63]
  v_mfma_f32_32x32x16_bf16 v[64:79], v[116:119], a[136:139], v[64:79]
  v_mfma_f32_32x32x16_bf16 v[80:95], v[116:119], a[140:143], v[80:95]
  ds_read_b128 v[112:115], v120 offset:8192
  ds_read_b128 v[116:119], v120 offset:12288
  s_waitcnt lgkmcnt(4)
  v_mfma_f32_32x32x16_bf16 v[32:47], v[96:99], a[144:147], v[32:47]
  v_mfma_f32_32x32x16_bf16 v[48:63], v[96:99], a[148:151], v[48:63]
  s_add_u32 m0, s71, 33792
  s_add_u32 s73, s72, 9728
  buffer_load_dwordx4 v5, s[52:55], s73 offen lds
  v_mfma_f32_32x32x16_bf16 v[64:79], v[100:103], a[144:147], v[64:79]
  v_mfma_f32_32x32x16_bf16 v[80:95], v[100:103], a[148:151], v[80:95]
  ds_read_b128 v[96:99], v121 offset:8192
  ds_read_b128 v[100:103], v121 offset:12288
  s_waitcnt lgkmcnt(4)
  v_mfma_f32_32x32x16_bf16 v[32:47], v[104:107], a[152:155], v[32:47]
  v_mfma_f32_32x32x16_bf16 v[48:63], v[104:107], a[156:159], v[48:63]
  v_mfma_f32_32x32x16_bf16 v[64:79], v[108:111], a[152:155], v[64:79]
  v_mfma_f32_32x32x16_bf16 v[80:95], v[108:111], a[156:159], v[80:95]
  ds_read_b128 v[104:107], v122 offset:8192
  ds_read_b128 v[108:111], v122 offset:12288
  s_waitcnt lgkmcnt(4)
  v_mfma_f32_32x32x16_bf16 v[32:47], v[112:115], a[160:163], v[32:47]
  v_mfma_f32_32x32x16_bf16 v[48:63], v[112:115], a[164:167], v[48:63]
  s_add_u32 m0, s71, 40960
  s_add_u32 s73, s72, 640
  buffer_load_dwordx4 v4, s[52:55], s73 offen lds
  v_mfma_f32_32x32x16_bf16 v[64:79], v[116:119], a[160:163], v[64:79]
  v_mfma_f32_32x32x16_bf16 v[80:95], v[116:119], a[164:167], v[80:95]
  ds_read_b128 v[112:115], v123 offset:8192
  ds_read_b128 v[116:119], v123 offset:12288
  s_waitcnt lgkmcnt(4)
  v_mfma_f32_32x32x16_bf16 v[32:47], v[96:99], a[168:171], v[32:47]
  v_mfma_f32_32x32x16_bf16 v[48:63], v[96:99], a[172:175], v[48:63]
  v_mfma_f32_32x32x16_bf16 v[64:79], v[100:103], a[168:171], v[64:79]
  v_mfma_f32_32x32x16_bf16 v[80:95], v[100:103], a[172:175], v[80:95]
  ds_read_b128 v[96:99], v120 offset:16384
  ds_read_b128 v[100:103], v120 offset:20480
  s_waitcnt lgkmcnt(4)
  v_mfma_f32_32x32x16_bf16 v[32:47], v[104:107], a[176:179], v[32:47]
  v_mfma_f32_32x32x16_bf16 v[48:63], v[104:107], a[180:183], v[48:63]
  s_add_u32 m0, s71, 41984
  s_add_u32 s73, s72, 9856
  buffer_load_dwordx4 v5, s[52:55], s73 offen lds
  v_mfma_f32_32x32x16_bf16 v[64:79], v[108:111], a[176:179], v[64:79]
  v_mfma_f32_32x32x16_bf16 v[80:95], v[108:111], a[180:183], v[80:95]
  ds_read_b128 v[104:107], v121 offset:16384
  ds_read_b128 v[108:111], v121 offset:20480
  s_waitcnt lgkmcnt(4)
  v_mfma_f32_32x32x16_bf16 v[32:47], v[112:115], a[184:187], v[32:47]
  v_mfma_f32_32x32x16_bf16 v[48:63], v[112:115], a[188:191], v[48:63]
  v_mfma_f32_32x32x16_bf16 v[64:79], v[116:119], a[184:187], v[64:79]
  v_mfma_f32_32x32x16_bf16 v[80:95], v[116:119], a[188:191], v[80:95]
  ds_read_b128 v[112:115], v122 offset:16384
  ds_read_b128 v[116:119], v122 offset:20480
  s_waitcnt lgkmcnt(4)
  v_mfma_f32_32x32x16_bf16 v[32:47], v[96:99], a[192:195], v[32:47]
  v_mfma_f32_32x32x16_bf16 v[48:63], v[96:99], a[196:199], v[48:63]
  s_add_u32 m0, s71, 49152
  s_add_u32 s73, s72, 768
  buffer_load_dwordx4 v4, s[52:55], s73 offen lds
  v_mfma_f32_32x32x16_bf16 v[64:79], v[100:103], a[192:195], v[64:79]
  v_mfma_f32_32x32x16_bf16 v[80:95], v[100:103], a[196:199], v[80:95]
  ds_read_b128 v[96:99], v123 offset:16384
  ds_read_b128 v[100:103], v123 offset:20480
  s_waitcnt lgkmcnt(4)
  v_mfma_f32_32x32x16_bf16 v[32:47], v[104:107], a[200:203], v[32:47]
  v_mfma_f32_32x32x16_bf16 v[48:63], v[104:107], a[204:207], v[48:63]
  v_mfma_f32_32x32x16_bf16 v[64:79], v[108:111], a[200:203], v[64:79]
  v_mfma_f32_32x32x16_bf16 v[80:95], v[108:111], a[204:207], v[80:95]
  ds_read_b128 v[104:107], v120 offset:24576
  ds_read_b128 v[108:111], v120 offset:28672
  s_waitcnt lgkmcnt(4)
  v_mfma_f32_32x32x16_bf16 v[32:47], v[112:115], a[208:211], v[32:47]
  v_mfma_f32_32x32x16_bf16 v[48:63], v[112:115], a[212:215], v[48:63]
  s_add_u32 m0, s71, 50176
  s_add_u32 s73, s72, 9984
  buffer_load_dwordx4 v5, s[52:55], s73 offen lds
  v_mfma_f32_32x32x16_bf16 v[64:79], v[116:119], a[208:211], v[64:79]
  v_mfma_f32_32x32x16_bf16 v[80:95], v[116:119], a[212:215], v[80:95]
  ds_read_b128 v[112:115], v121 offset:24576
  ds_read_b128 v[116:119], v121 offset:28672
  s_waitcnt lgkmcnt(4)
  v_mfma_f32_32x32x16_bf16 v[32:47], v[96:99], a[216:219], v[32:47]
  v_mfma_f32_32x32x16_bf16 v[48:63], v[96:99], a[220:223], v[48:63]
  v_mfma_f32_32x32x16_bf16 v[64:79], v[100:103], a[216:219], v[64:79]
  v_mfma_f32_32x32x16_bf16 v[80:95], v[100:103], a[220:223], v[80:95]
  ds_read_b128 v[96:99], v122 offset:24576
  ds_read_b128 v[100:103], v122 offset:28672
  s_waitcnt lgkmcnt(4)
  v_mfma_f32_32x32x16_bf16 v[32:47], v[104:107], a[224:227], v[32:47]
  v_mfma_f32_32x32x16_bf16 v[48:63], v[104:107], a[228:231], v[48:63]
  s_add_u32 m0, s71, 57344
  s_add_u32 s73, s72, 896
  buffer_load_dwordx4 v4, s[52:55], s73 offen lds
  v_mfma_f32_32x32x16_bf16 v[64:79], v[108:111], a[224:227], v[64:79]
  v_mfma_f32_32x32x16_bf16 v[80:95], v[108:111], a[228:231], v[80:95]
  ds_read_b128 v[104:107], v123 offset:24576
  ds_read_b128 v[108:111], v123 offset:28672
  s_waitcnt lgkmcnt(4)
  v_mfma_f32_32x32x16_bf16 v[32:47], v[112:115], a[232:235], v[32:47]
  v_mfma_f32_32x32x16_bf16 v[48:63], v[112:115], a[236:239], v[48:63]
  v_mfma_f32_32x32x16_bf16 v[64:79], v[116:119], a[232:235], v[64:79]
  v_mfma_f32_32x32x16_bf16 v[80:95], v[116:119], a[236:239], v[80:95]
  ds_read_b128 v[112:115], v120 offset:32768
  ds_read_b128 v[116:119], v120 offset:36864
  s_waitcnt lgkmcnt(4)
  v_mfma_f32_32x32x16_bf16 v[32:47], v[96:99], a[240:243], v[32:47]
  v_mfma_f32_32x32x16_bf16 v[48:63], v[96:99], a[244:247], v[48:63]
  s_add_u32 m0, s71, 58368
  s_add_u32 s73, s72, 10112
  buffer_load_dwordx4 v5, s[52:55], s73 offen lds
  v_mfma_f32_32x32x16_bf16 v[64:79], v[100:103], a[240:243], v[64:79]
  v_mfma_f32_32x32x16_bf16 v[80:95], v[100:103], a[244:247], v[80:95]
  ds_read_b128 v[96:99], v121 offset:32768
  ds_read_b128 v[100:103], v121 offset:36864
  s_waitcnt lgkmcnt(4)
  v_mfma_f32_32x32x16_bf16 v[32:47], v[104:107], a[248:251], v[32:47]
  v_mfma_f32_32x32x16_bf16 v[48:63], v[104:107], a[252:255], v[48:63]
  v_mfma_f32_32x32x16_bf16 v[64:79], v[108:111], a[248:251], v[64:79]
  v_mfma_f32_32x32x16_bf16 v[80:95], v[108:111], a[252:255], v[80:95]
  ds_read_b128 v[104:107], v122 offset:32768
  ds_read_b128 v[108:111], v122 offset:36864
  s_waitcnt lgkmcnt(4)
  v_mfma_f32_32x32x16_bf16 v[32:47], v[112:115], v[224:227], v[32:47]
  v_mfma_f32_32x32x16_bf16 v[48:63], v[112:115], v[228:231], v[48:63]
  s_add_u32 m0, s71, 65536
  s_add_u32 s73, s72, 1024
  buffer_load_dwordx4 v4, s[52:55], s73 offen lds
  v_mfma_f32_32x32x16_bf16 v[64:79], v[116:119], v[224:227], v[64:79]
  v_mfma_f32_32x32x16_bf16 v[80:95], v[116:119], v[228:231], v[80:95]
  ds_read_b128 v[112:115], v123 offset:32768
  ds_read_b128 v[116:119], v123 offset:36864
  s_waitcnt lgkmcnt(4)
  v_mfma_f32_32x32x16_bf16 v[32:47], v[96:99], v[232:235], v[32:47]
  v_mfma_f32_32x32x16_bf16 v[48:63], v[96:99], v[236:239], v[48:63]
  v_mfma_f32_32x32x16_bf16 v[64:79], v[100:103], v[232:235], v[64:79]
  v_mfma_f32_32x32x16_bf16 v[80:95], v[100:103], v[236:239], v[80:95]
  s_waitcnt lgkmcnt(2)
  v_mfma_f32_32x32x16_bf16 v[32:47], v[104:107], v[240:243], v[32:47]
  v_mfma_f32_32x32x16_bf16 v[48:63], v[104:107], v[244:247], v[48:63]
  s_add_u32 m0, s71, 66560
  s_add_u32 s73, s72, 10240
  buffer_load_dwordx4 v5, s[52:55], s73 offen lds
  v_mfma_f32_32x32x16_bf16 v[64:79], v[108:111], v[240:243], v[64:79]
  v_mfma_f32_32x32x16_bf16 v[80:95], v[108:111], v[244:247], v[80:95]
  s_waitcnt lgkmcnt(0)
  v_mfma_f32_32x32x16_bf16 v[32:47], v[112:115], v[248:251], v[32:47]
  v_mfma_f32_32x32x16_bf16 v[48:63], v[112:115], v[252:255], v[48:63]
  v_mfma_f32_32x32x16_bf16 v[64:79], v[116:119], v[248:251], v[64:79]
  v_mfma_f32_32x32x16_bf16 v[80:95], v[116:119], v[252:255], v[80:95]
  s_lshl_b32 s4, s68, 6
  s_lshl_b32 s5, s12, 1
  s_add_u32 s4, s4, s5
  s_lshr_b32 s5, s3, 1
  s_add_u32 s4, s4, s5
  s_lshl_b32 s4, s4, 3
  s_and_b32 s5, s3, 1
  s_lshl_b32 s5, s5, 2
  s_add_u32 s4, s4, s5
  s_lshl_b32 s4, s4, 10
  s_add_u32 s76, s4, s84
  s_mov_b32 s82, 262144
  s_waitcnt vmcnt(0)
  s_nop 11
  s_add_u32 s74, s76, 0
  v_cvt_pk_bf16_f32 v120, v32, v33
  v_cvt_pk_bf16_f32 v121, v34, v35
  v_cvt_pk_bf16_f32 v122, v40, v41
  v_cvt_pk_bf16_f32 v123, v42, v43
  buffer_store_dwordx4 v[120:123], v10, s[48:51], s74 offen offset:0 sc1
  v_cvt_pk_bf16_f32 v124, v36, v37
  v_cvt_pk_bf16_f32 v125, v38, v39
  v_cvt_pk_bf16_f32 v126, v44, v45
  v_cvt_pk_bf16_f32 v127, v46, v47
  buffer_store_dwordx4 v[124:127], v10, s[48:51], s74 offen offset:512 sc1
  s_add_u32 s74, s76, 2048
  v_cvt_pk_bf16_f32 v128, v48, v49
  v_cvt_pk_bf16_f32 v129, v50, v51
  v_cvt_pk_bf16_f32 v130, v56, v57
  v_cvt_pk_bf16_f32 v131, v58, v59
  buffer_store_dwordx4 v[128:131], v10, s[48:51], s74 offen offset:0 sc1
  v_cvt_pk_bf16_f32 v132, v52, v53
  v_cvt_pk_bf16_f32 v133, v54, v55
  v_cvt_pk_bf16_f32 v134, v60, v61
  v_cvt_pk_bf16_f32 v135, v62, v63
  buffer_store_dwordx4 v[132:135], v10, s[48:51], s74 offen offset:512 sc1
  s_add_u32 s74, s76, 0
  s_add_u32 s74, s74, s82
  v_cvt_pk_bf16_f32 v120, v64, v65
  v_cvt_pk_bf16_f32 v121, v66, v67
  v_cvt_pk_bf16_f32 v122, v72, v73
  v_cvt_pk_bf16_f32 v123, v74, v75
  buffer_store_dwordx4 v[120:123], v10, s[48:51], s74 offen offset:0 sc1
  v_cvt_pk_bf16_f32 v124, v68, v69
  v_cvt_pk_bf16_f32 v125, v70, v71
  v_cvt_pk_bf16_f32 v126, v76, v77
  v_cvt_pk_bf16_f32 v127, v78, v79
  buffer_store_dwordx4 v[124:127], v10, s[48:51], s74 offen offset:512 sc1
  s_add_u32 s74, s76, 2048
  s_add_u32 s74, s74, s82
  v_cvt_pk_bf16_f32 v128, v80, v81
  v_cvt_pk_bf16_f32 v129, v82, v83
  v_cvt_pk_bf16_f32 v130, v88, v89
  v_cvt_pk_bf16_f32 v131, v90, v91
  buffer_store_dwordx4 v[128:131], v10, s[48:51], s74 offen offset:0 sc1
  v_cvt_pk_bf16_f32 v132, v84, v85
  v_cvt_pk_bf16_f32 v133, v86, v87
  v_cvt_pk_bf16_f32 v134, v92, v93
  v_cvt_pk_bf16_f32 v135, v94, v95
  buffer_store_dwordx4 v[132:135], v10, s[48:51], s74 offen offset:512 sc1
  s_barrier
  s_cmp_eq_u32 s77, -1
  s_cbranch_scc1 L_ns_15
  s_cmp_lg_u32 s79, 0
  s_cbranch_scc1 L_iwskip_16
  s_cmp_lg_u32 s3, 0
  s_cbranch_scc1 L_iwd_18
  v_mov_b32 v28, 0
L_iw_17:
  global_load_dword v29, v28, s[42:43] offset:16 sc1
  s_waitcnt vmcnt(0)
  v_readfirstlane_b32 s4, v29
  s_nop 1
  s_cmp_ge_u32 s4, 32
  s_cbranch_scc1 L_iwd_18
  s_sleep 4
  s_add_u32 s47, s47, 1
  s_cmp_gt_u32 s47, 131072
  s_cbranch_scc1 L_exit
  s_branch L_iw_17
L_iwd_18:
  s_mov_b32 s79, 1
L_iwskip_16:
  s_lshl_b32 s78, s77, 7
  s_add_u32 s78, s78, s83
  s_cmp_lg_u32 s3, 0
  s_cbranch_scc1 L_sig_19
  s_mov_b64 s[8:9], exec
  s_mov_b64 exec, 1
  v_mov_b32 v28, 0
  v_mov_b32 v29, 1
  buffer_atomic_add v29, v28, s[48:51], s78 offen
  s_mov_b64 exec, s[8:9]
L_sig_19:
L_ns_15:
  s_mov_b32 s77, s68
  s_mov_b32 s68, s10
  s_mov_b32 s70, s11
  s_cmp_lt_u32 s68, s69
  s_cbranch_scc1 L_w1loop_12
  s_waitcnt vmcnt(0)
  s_barrier
  s_lshl_b32 s78, s77, 7
  s_add_u32 s78, s78, s83
  s_cmp_lg_u32 s3, 0
  s_cbranch_scc1 L_iwd_21
  v_mov_b32 v28, 0
L_iw_20:
  global_load_dword v29, v28, s[42:43] offset:16 sc1
  s_waitcnt vmcnt(0)
  v_readfirstlane_b32 s4, v29
  s_nop 1
  s_cmp_ge_u32 s4, 32
  s_cbranch_scc1 L_iwd_21
  s_sleep 4
  s_add_u32 s47, s47, 1
  s_cmp_gt_u32 s47, 131072
  s_cbranch_scc1 L_exit
  s_branch L_iw_20
L_iwd_21:
  s_cmp_lg_u32 s3, 0
  s_cbranch_scc1 L_sig_22
  s_mov_b64 s[8:9], exec
  s_mov_b64 exec, 1
  v_mov_b32 v28, 0
  v_mov_b32 v29, 1
  buffer_atomic_add v29, v28, s[48:51], s78 offen
  s_mov_b64 exec, s[8:9]
L_sig_22:
  s_waitcnt vmcnt(0)
  s_branch L_w1_next
L_w1_h:
  s_sub_u32 s12, s85, 32
  s_mov_b32 s83, 8192
  s_lshl_b32 s13, s12, 8
  s_add_u32 s56, s32, s13
  s_addc_u32 s57, s33, 0
  s_mov_b32 s58, 5308416
  s_mov_b32 s59, 0x20000
  s_add_u32 s60, s34, s13
  s_addc_u32 s61, s35, 0
  s_mov_b32 s62, 5308416
  s_mov_b32 s63, 0x20000
  s_mov_b32 s52, s16
  s_mov_b32 s53, s17
  s_mov_b32 s54, 2359296
  s_mov_b32 s55, 0x20000
  v_lshrrev_b32 v12, 4, v0
  v_and_b32 v13, 15, v0
  v_lshlrev_b32 v14, 2, v12
  v_xor_b32 v13, v13, v14
  v_lshlrev_b32 v13, 4, v13
  s_mov_b32 s4, 9216
  v_mul_lo_u32 v12, v12, s4
  v_add_u32 v11, v12, v13
  v_lshrrev_b32 v12, 5, v0
  v_lshlrev_b32 v12, 3, v12
  v_bfe_u32 v13, v0, 2, 2
  v_add_u32 v12, v12, v13
  v_lshlrev_b32 v12, 8, v12
  v_bfe_u32 v14, v0, 4, 1
  v_lshlrev_b32 v14, 1, v14
  v_bfe_u32 v15, v0, 1, 1
  v_add_u32 v14, v14, v15
  v_lshlrev_b32 v13, 2, v13
  v_and_b32 v15, 1, v0
  v_lshlrev_b32 v15, 3, v15
  v_add_u32 v12, v12, v15
  s_lshl_b32 s4, s3, 2
  v_add_u32 v16, s4, v14
  v_xor_b32 v17, v16, v13
  v_lshlrev_b32 v17, 4, v17
  v_add_u32 v2, v17, v12
  v_add_u32 v3, 16384, v2
  s_lshl_b32 s5, s3, 12
  s_add_u32 m0, s5, 0
  s_mul_i32 s4, s3, 147456
  s_add_u32 s4, s4, 0
  buffer_load_dwordx4 v11, s[56:59], s4 offen lds
  s_lshl_b32 s5, s3, 12
  s_add_u32 m0, s5, 1024
  s_mul_i32 s4, s3, 147456
  s_add_u32 s4, s4, 36864
  buffer_load_dwordx4 v11, s[56:59], s4 offen lds
  s_lshl_b32 s5, s3, 12
  s_add_u32 m0, s5, 2048
  s_mul_i32 s4, s3, 147456
  s_add_u32 s4, s4, 73728
  buffer_load_dwordx4 v11, s[56:59], s4 offen lds
  s_lshl_b32 s5, s3, 12
  s_add_u32 m0, s5, 3072
  s_mul_i32 s4, s3, 147456
  s_add_u32 s4, s4, 110592
  buffer_load_dwordx4 v11, s[56:59], s4 offen lds
  s_lshl_b32 s5, s3, 12
  s_add_u32 m0, s5, 16384
  s_mul_i32 s4, s3, 147456
  s_add_u32 s4, s4, 0
  buffer_load_dwordx4 v11, s[60:63], s4 offen lds
  s_lshl_b32 s5, s3, 12
  s_add_u32 m0, s5, 17408
  s_mul_i32 s4, s3, 147456
  s_add_u32 s4, s4, 36864
  buffer_load_dwordx4 v11, s[60:63], s4 offen lds
  s_lshl_b32 s5, s3, 12
  s_add_u32 m0, s5, 18432
  s_mul_i32 s4, s3, 147456
  s_add_u32 s4, s4, 73728
  buffer_load_dwordx4 v11, s[60:63], s4 offen lds
  s_lshl_b32 s5, s3, 12
  s_add_u32 m0, s5, 19456
  s_mul_i32 s4, s3, 147456
  s_add_u32 s4, s4, 110592
  buffer_load_dwordx4 v11, s[60:63], s4 offen lds
  s_lshl_b32 s5, s3, 12
  s_add_u32 m0, s5, 32768
  s_mul_i32 s4, s3, 147456
  s_add_u32 s4, s4, 589824
  buffer_load_dwordx4 v11, s[56:59], s4 offen lds
  s_lshl_b32 s5, s3, 12
  s_add_u32 m0, s5, 33792
  s_mul_i32 s4, s3, 147456
  s_add_u32 s4, s4, 626688
  buffer_load_dwordx4 v11, s[56:59], s4 offen lds
  s_lshl_b32 s5, s3, 12
  s_add_u32 m0, s5, 34816
  s_mul_i32 s4, s3, 147456
  s_add_u32 s4, s4, 663552
  buffer_load_dwordx4 v11, s[56:59], s4 offen lds
  s_lshl_b32 s5, s3, 12
  s_add_u32 m0, s5, 35840
  s_mul_i32 s4, s3, 147456
  s_add_u32 s4, s4, 700416
  buffer_load_dwordx4 v11, s[56:59], s4 offen lds
  s_lshl_b32 s5, s3, 12
  s_add_u32 m0, s5, 49152
  s_mul_i32 s4, s3, 147456
  s_add_u32 s4, s4, 589824
  buffer_load_dwordx4 v11, s[60:63], s4 offen lds
  s_lshl_b32 s5, s3, 12
  s_add_u32 m0, s5, 50176
  s_mul_i32 s4, s3, 147456
  s_add_u32 s4, s4, 626688
  buffer_load_dwordx4 v11, s[60:63], s4 offen lds
  s_lshl_b32 s5, s3, 12
  s_add_u32 m0, s5, 51200
  s_mul_i32 s4, s3, 147456
  s_add_u32 s4, s4, 663552
  buffer_load_dwordx4 v11, s[60:63], s4 offen lds
  s_lshl_b32 s5, s3, 12
  s_add_u32 m0, s5, 52224
  s_mul_i32 s4, s3, 147456
  s_add_u32 s4, s4, 700416
  buffer_load_dwordx4 v11, s[60:63], s4 offen lds
  s_lshl_b32 s5, s3, 12
  s_add_u32 m0, s5, 65536
  s_mul_i32 s4, s3, 147456
  s_add_u32 s4, s4, 1179648
  buffer_load_dwordx4 v11, s[56:59], s4 offen lds
  s_lshl_b32 s5, s3, 12
  s_add_u32 m0, s5, 66560
  s_mul_i32 s4, s3, 147456
  s_add_u32 s4, s4, 1216512
  buffer_load_dwordx4 v11, s[56:59], s4 offen lds
  s_lshl_b32 s5, s3, 12
  s_add_u32 m0, s5, 67584
  s_mul_i32 s4, s3, 147456
  s_add_u32 s4, s4, 1253376
  buffer_load_dwordx4 v11, s[56:59], s4 offen lds
  s_lshl_b32 s5, s3, 12
  s_add_u32 m0, s5, 68608
  s_mul_i32 s4, s3, 147456
  s_add_u32 s4, s4, 1290240
  buffer_load_dwordx4 v11, s[56:59], s4 offen lds
  s_lshl_b32 s5, s3, 12
  s_add_u32 m0, s5, 81920
  s_mul_i32 s4, s3, 147456
  s_add_u32 s4, s4, 1179648
  buffer_load_dwordx4 v11, s[60:63], s4 offen lds
  s_lshl_b32 s5, s3, 12
  s_add_u32 m0, s5, 82944
  s_mul_i32 s4, s3, 147456
  s_add_u32 s4, s4, 1216512
  buffer_load_dwordx4 v11, s[60:63], s4 offen lds
  s_lshl_b32 s5, s3, 12
  s_add_u32 m0, s5, 83968
  s_mul_i32 s4, s3, 147456
  s_add_u32 s4, s4, 1253376
  buffer_load_dwordx4 v11, s[60:63], s4 offen lds
  s_lshl_b32 s5, s3, 12
  s_add_u32 m0, s5, 84992
  s_mul_i32 s4, s3, 147456
  s_add_u32 s4, s4, 1290240
  buffer_load_dwordx4 v11, s[60:63], s4 offen lds
  s_lshl_b32 s5, s3, 12
  s_add_u32 m0, s5, 98304
  s_mul_i32 s4, s3, 147456
  s_add_u32 s4, s4, 1769472
  buffer_load_dwordx4 v11, s[56:59], s4 offen lds
  s_lshl_b32 s5, s3, 12
  s_add_u32 m0, s5, 99328
  s_mul_i32 s4, s3, 147456
  s_add_u32 s4, s4, 1806336
  buffer_load_dwordx4 v11, s[56:59], s4 offen lds
  s_lshl_b32 s5, s3, 12
  s_add_u32 m0, s5, 100352
  s_mul_i32 s4, s3, 147456
  s_add_u32 s4, s4, 1843200
  buffer_load_dwordx4 v11, s[56:59], s4 offen lds
  s_lshl_b32 s5, s3, 12
  s_add_u32 m0, s5, 101376
  s_mul_i32 s4, s3, 147456
  s_add_u32 s4, s4, 1880064
  buffer_load_dwordx4 v11, s[56:59], s4 offen lds
  s_lshl_b32 s5, s3, 12
  s_add_u32 m0, s5, 114688
  s_mul_i32 s4, s3, 147456
  s_add_u32 s4, s4, 1769472
  buffer_load_dwordx4 v11, s[60:63], s4 offen lds
  s_lshl_b32 s5, s3, 12
  s_add_u32 m0, s5, 115712
  s_mul_i32 s4, s3, 147456
  s_add_u32 s4, s4, 1806336
  buffer_load_dwordx4 v11, s[60:63], s4 offen lds
  s_lshl_b32 s5, s3, 12
  s_add_u32 m0, s5, 116736
  s_mul_i32 s4, s3, 147456
  s_add_u32 s4, s4, 1843200
  buffer_load_dwordx4 v11, s[60:63], s4 offen lds
  s_lshl_b32 s5, s3, 12
  s_add_u32 m0, s5, 117760
  s_mul_i32 s4, s3, 147456
  s_add_u32 s4, s4, 1880064
  buffer_load_dwordx4 v11, s[60:63], s4 offen lds
  s_lshl_b32 s5, s3, 12
  s_add_u32 m0, s5, 131072
  s_mul_i32 s4, s3, 147456
  s_add_u32 s4, s4, 2359296
  buffer_load_dwordx4 v11, s[56:59], s4 offen lds
  s_lshl_b32 s5, s3, 12
  s_add_u32 m0, s5, 132096
  s_mul_i32 s4, s3, 147456
  s_add_u32 s4, s4, 2396160
  buffer_load_dwordx4 v11, s[56:59], s4 offen lds
  s_lshl_b32 s5, s3, 12
  s_add_u32 m0, s5, 133120
  s_mul_i32 s4, s3, 147456
  s_add_u32 s4, s4, 2433024
  buffer_load_dwordx4 v11, s[56:59], s4 offen lds
  s_lshl_b32 s5, s3, 12
  s_add_u32 m0, s5, 134144
  s_mul_i32 s4, s3, 147456
  s_add_u32 s4, s4, 2469888
  buffer_load_dwordx4 v11, s[56:59], s4 offen lds
  s_lshl_b32 s5, s3, 12
  s_add_u32 m0, s5, 147456
  s_mul_i32 s4, s3, 147456
  s_add_u32 s4, s4, 2359296
  buffer_load_dwordx4 v11, s[60:63], s4 offen lds
  s_lshl_b32 s5, s3, 12
  s_add_u32 m0, s5, 148480
  s_mul_i32 s4, s3, 147456
  s_add_u32 s4, s4, 2396160
  buffer_load_dwordx4 v11, s[60:63], s4 offen lds
  s_lshl_b32 s5, s3, 12
  s_add_u32 m0, s5, 149504
  s_mul_i32 s4, s3, 147456
  s_add_u32 s4, s4, 2433024
  buffer_load_dwordx4 v11, s[60:63], s4 offen lds
  s_lshl_b32 s5, s3, 12
  s_add_u32 m0, s5, 150528
  s_mul_i32 s4, s3, 147456
  s_add_u32 s4, s4, 2469888
  buffer_load_dwordx4 v11, s[60:63], s4 offen lds
  s_waitcnt vmcnt(32)
  s_barrier
  v_add_u32 v18, 0, v2
  v_add_u32 v19, 0, v3
  ds_read_b64_tr_b16 a[0:1], v18 offset:0
  ds_read_b64_tr_b16 a[2:3], v18 offset:1024
  ds_read_b64_tr_b16 a[4:5], v19 offset:0
  ds_read_b64_tr_b16 a[6:7], v19 offset:1024
  ds_read_b64_tr_b16 a[8:9], v18 offset:4096
  ds_read_b64_tr_b16 a[10:11], v18 offset:5120
  ds_read_b64_tr_b16 a[12:13], v19 offset:4096
  ds_read_b64_tr_b16 a[14:15], v19 offset:5120
  ds_read_b64_tr_b16 a[16:17], v18 offset:8192
  ds_read_b64_tr_b16 a[18:19], v18 offset:9216
  ds_read_b64_tr_b16 a[20:21], v19 offset:8192
  ds_read_b64_tr_b16 a[22:23], v19 offset:9216
  ds_read_b64_tr_b16 a[24:25], v18 offset:12288
  ds_read_b64_tr_b16 a[26:27], v18 offset:13312
  ds_read_b64_tr_b16 a[28:29], v19 offset:12288
  ds_read_b64_tr_b16 a[30:31], v19 offset:13312
  s_waitcnt lgkmcnt(0)
  s_waitcnt vmcnt(24)
  s_barrier
  s_lshl_b32 s5, s3, 12
  s_add_u32 m0, s5, 0
  s_mul_i32 s4, s3, 147456
  s_add_u32 s4, s4, 2949120
  buffer_load_dwordx4 v11, s[56:59], s4 offen lds
  s_lshl_b32 s5, s3, 12
  s_add_u32 m0, s5, 1024
  s_mul_i32 s4, s3, 147456
  s_add_u32 s4, s4, 2985984
  buffer_load_dwordx4 v11, s[56:59], s4 offen lds
  s_lshl_b32 s5, s3, 12
  s_add_u32 m0, s5, 2048
  s_mul_i32 s4, s3, 147456
  s_add_u32 s4, s4, 3022848
  buffer_load_dwordx4 v11, s[56:59], s4 offen lds
  s_lshl_b32 s5, s3, 12
  s_add_u32 m0, s5, 3072
  s_mul_i32 s4, s3, 147456
  s_add_u32 s4, s4, 3059712
  buffer_load_dwordx4 v11, s[56:59], s4 offen lds
  s_lshl_b32 s5, s3, 12
  s_add_u32 m0, s5, 16384
  s_mul_i32 s4, s3, 147456
  s_add_u32 s4, s4, 2949120
  buffer_load_dwordx4 v11, s[60:63], s4 offen lds
  s_lshl_b32 s5, s3, 12
  s_add_u32 m0, s5, 17408
  s_mul_i32 s4, s3, 147456
  s_add_u32 s4, s4, 2985984
  buffer_load_dwordx4 v11, s[60:63], s4 offen lds
  s_lshl_b32 s5, s3, 12
  s_add_u32 m0, s5, 18432
  s_mul_i32 s4, s3, 147456
  s_add_u32 s4, s4, 3022848
  buffer_load_dwordx4 v11, s[60:63], s4 offen lds
  s_lshl_b32 s5, s3, 12
  s_add_u32 m0, s5, 19456
  s_mul_i32 s4, s3, 147456
  s_add_u32 s4, s4, 3059712
  buffer_load_dwordx4 v11, s[60:63], s4 offen lds
  v_add_u32 v18, 32768, v2
  v_add_u32 v19, 32768, v3
  ds_read_b64_tr_b16 a[32:33], v18 offset:0
  ds_read_b64_tr_b16 a[34:35], v18 offset:1024
  ds_read_b64_tr_b16 a[36:37], v19 offset:0
  ds_read_b64_tr_b16 a[38:39], v19 offset:1024
  ds_read_b64_tr_b16 a[40:41], v18 offset:4096
  ds_read_b64_tr_b16 a[42:43], v18 offset:5120
  ds_read_b64_tr_b16 a[44:45], v19 offset:4096
  ds_read_b64_tr_b16 a[46:47], v19 offset:5120
  ds_read_b64_tr_b16 a[48:49], v18 offset:8192
  ds_read_b64_tr_b16 a[50:51], v18 offset:9216
  ds_read_b64_tr_b16 a[52:53], v19 offset:8192
  ds_read_b64_tr_b16 a[54:55], v19 offset:9216
  ds_read_b64_tr_b16 a[56:57], v18 offset:12288
  ds_read_b64_tr_b16 a[58:59], v18 offset:13312
  ds_read_b64_tr_b16 a[60:61], v19 offset:12288
  ds_read_b64_tr_b16 a[62:63], v19 offset:13312
  s_waitcnt lgkmcnt(0)
  s_waitcnt vmcnt(24)
  s_barrier
  s_lshl_b32 s5, s3, 12
  s_add_u32 m0, s5, 32768
  s_mul_i32 s4, s3, 147456
  s_add_u32 s4, s4, 3538944
  buffer_load_dwordx4 v11, s[56:59], s4 offen lds
  s_lshl_b32 s5, s3, 12
  s_add_u32 m0, s5, 33792
  s_mul_i32 s4, s3, 147456
  s_add_u32 s4, s4, 3575808
  buffer_load_dwordx4 v11, s[56:59], s4 offen lds
  s_lshl_b32 s5, s3, 12
  s_add_u32 m0, s5, 34816
  s_mul_i32 s4, s3, 147456
  s_add_u32 s4, s4, 3612672
  buffer_load_dwordx4 v11, s[56:59], s4 offen lds
  s_lshl_b32 s5, s3, 12
  s_add_u32 m0, s5, 35840
  s_mul_i32 s4, s3, 147456
  s_add_u32 s4, s4, 3649536
  buffer_load_dwordx4 v11, s[56:59], s4 offen lds
  s_lshl_b32 s5, s3, 12
  s_add_u32 m0, s5, 49152
  s_mul_i32 s4, s3, 147456
  s_add_u32 s4, s4, 3538944
  buffer_load_dwordx4 v11, s[60:63], s4 offen lds
  s_lshl_b32 s5, s3, 12
  s_add_u32 m0, s5, 50176
  s_mul_i32 s4, s3, 147456
  s_add_u32 s4, s4, 3575808
  buffer_load_dwordx4 v11, s[60:63], s4 offen lds
  s_lshl_b32 s5, s3, 12
  s_add_u32 m0, s5, 51200
  s_mul_i32 s4, s3, 147456
  s_add_u32 s4, s4, 3612672
  buffer_load_dwordx4 v11, s[60:63], s4 offen lds
  s_lshl_b32 s5, s3, 12
  s_add_u32 m0, s5, 52224
  s_mul_i32 s4, s3, 147456
  s_add_u32 s4, s4, 3649536
  buffer_load_dwordx4 v11, s[60:63], s4 offen lds
  v_add_u32 v18, 65536, v2
  v_add_u32 v19, 65536, v3
  ds_read_b64_tr_b16 a[64:65], v18 offset:0
  ds_read_b64_tr_b16 a[66:67], v18 offset:1024
  ds_read_b64_tr_b16 a[68:69], v19 offset:0
  ds_read_b64_tr_b16 a[70:71], v19 offset:1024
  ds_read_b64_tr_b16 a[72:73], v18 offset:4096
  ds_read_b64_tr_b16 a[74:75], v18 offset:5120
  ds_read_b64_tr_b16 a[76:77], v19 offset:4096
  ds_read_b64_tr_b16 a[78:79], v19 offset:5120
  ds_read_b64_tr_b16 a[80:81], v18 offset:8192
  ds_read_b64_tr_b16 a[82:83], v18 offset:9216
  ds_read_b64_tr_b16 a[84:85], v19 offset:8192
  ds_read_b64_tr_b16 a[86:87], v19 offset:9216
  ds_read_b64_tr_b16 a[88:89], v18 offset:12288
  ds_read_b64_tr_b16 a[90:91], v18 offset:13312
  ds_read_b64_tr_b16 a[92:93], v19 offset:12288
  ds_read_b64_tr_b16 a[94:95], v19 offset:13312
  s_waitcnt lgkmcnt(0)
  s_waitcnt vmcnt(24)
  s_barrier
  s_lshl_b32 s5, s3, 12
  s_add_u32 m0, s5, 65536
  s_mul_i32 s4, s3, 147456
  s_add_u32 s4, s4, 4128768
  buffer_load_dwordx4 v11, s[56:59], s4 offen lds
  s_lshl_b32 s5, s3, 12
  s_add_u32 m0, s5, 66560
  s_mul_i32 s4, s3, 147456
  s_add_u32 s4, s4, 4165632
  buffer_load_dwordx4 v11, s[56:59], s4 offen lds
  s_lshl_b32 s5, s3, 12
  s_add_u32 m0, s5, 67584
  s_mul_i32 s4, s3, 147456
  s_add_u32 s4, s4, 4202496
  buffer_load_dwordx4 v11, s[56:59], s4 offen lds
  s_lshl_b32 s5, s3, 12
  s_add_u32 m0, s5, 68608
  s_mul_i32 s4, s3, 147456
  s_add_u32 s4, s4, 4239360
  buffer_load_dwordx4 v11, s[56:59], s4 offen lds
  s_lshl_b32 s5, s3, 12
  s_add_u32 m0, s5, 81920
  s_mul_i32 s4, s3, 147456
  s_add_u32 s4, s4, 4128768
  buffer_load_dwordx4 v11, s[60:63], s4 offen lds
  s_lshl_b32 s5, s3, 12
  s_add_u32 m0, s5, 82944
  s_mul_i32 s4, s3, 147456
  s_add_u32 s4, s4, 4165632
  buffer_load_dwordx4 v11, s[60:63], s4 offen lds
  s_lshl_b32 s5, s3, 12
  s_add_u32 m0, s5, 83968
  s_mul_i32 s4, s3, 147456
  s_add_u32 s4, s4, 4202496
  buffer_load_dwordx4 v11, s[60:63], s4 offen lds
  s_lshl_b32 s5, s3, 12
  s_add_u32 m0, s5, 84992
  s_mul_i32 s4, s3, 147456
  s_add_u32 s4, s4, 4239360
  buffer_load_dwordx4 v11, s[60:63], s4 offen lds
  v_add_u32 v18, 98304, v2
  v_add_u32 v19, 98304, v3
  ds_read_b64_tr_b16 a[96:97], v18 offset:0
  ds_read_b64_tr_b16 a[98:99], v18 offset:1024
  ds_read_b64_tr_b16 a[100:101], v19 offset:0
  ds_read_b64_tr_b16 a[102:103], v19 offset:1024
  ds_read_b64_tr_b16 a[104:105], v18 offset:4096
  ds_read_b64_tr_b16 a[106:107], v18 offset:5120
  ds_read_b64_tr_b16 a[108:109], v19 offset:4096
  ds_read_b64_tr_b16 a[110:111], v19 offset:5120
  ds_read_b64_tr_b16 a[112:113], v18 offset:8192
  ds_read_b64_tr_b16 a[114:115], v18 offset:9216
  ds_read_b64_tr_b16 a[116:117], v19 offset:8192
  ds_read_b64_tr_b16 a[118:119], v19 offset:9216
  ds_read_b64_tr_b16 a[120:121], v18 offset:12288
  ds_read_b64_tr_b16 a[122:123], v18 offset:13312
  ds_read_b64_tr_b16 a[124:125], v19 offset:12288
  ds_read_b64_tr_b16 a[126:127], v19 offset:13312
  s_waitcnt lgkmcnt(0)
  s_waitcnt vmcnt(24)
  s_barrier
  s_lshl_b32 s5, s3, 12
  s_add_u32 m0, s5, 98304
  s_mul_i32 s4, s3, 147456
  s_add_u32 s4, s4, 4718592
  buffer_load_dwordx4 v11, s[56:59], s4 offen lds
  s_lshl_b32 s5, s3, 12
  s_add_u32 m0, s5, 99328
  s_mul_i32 s4, s3, 147456
  s_add_u32 s4, s4, 4755456
  buffer_load_dwordx4 v11, s[56:59], s4 offen lds
  s_lshl_b32 s5, s3, 12
  s_add_u32 m0, s5, 100352
  s_mul_i32 s4, s3, 147456
  s_add_u32 s4, s4, 4792320
  buffer_load_dwordx4 v11, s[56:59], s4 offen lds
  s_lshl_b32 s5, s3, 12
  s_add_u32 m0, s5, 101376
  s_mul_i32 s4, s3, 147456
  s_add_u32 s4, s4, 4829184
  buffer_load_dwordx4 v11, s[56:59], s4 offen lds
  s_lshl_b32 s5, s3, 12
  s_add_u32 m0, s5, 114688
  s_mul_i32 s4, s3, 147456
  s_add_u32 s4, s4, 4718592
  buffer_load_dwordx4 v11, s[60:63], s4 offen lds
  s_lshl_b32 s5, s3, 12
  s_add_u32 m0, s5, 115712
  s_mul_i32 s4, s3, 147456
  s_add_u32 s4, s4, 4755456
  buffer_load_dwordx4 v11, s[60:63], s4 offen lds
  s_lshl_b32 s5, s3, 12
  s_add_u32 m0, s5, 116736
  s_mul_i32 s4, s3, 147456
  s_add_u32 s4, s4, 4792320
  buffer_load_dwordx4 v11, s[60:63], s4 offen lds
  s_lshl_b32 s5, s3, 12
  s_add_u32 m0, s5, 117760
  s_mul_i32 s4, s3, 147456
  s_add_u32 s4, s4, 4829184
  buffer_load_dwordx4 v11, s[60:63], s4 offen lds
  v_add_u32 v18, 131072, v2
  v_add_u32 v19, 131072, v3
  ds_read_b64_tr_b16 a[128:129], v18 offset:0
  ds_read_b64_tr_b16 a[130:131], v18 offset:1024
  ds_read_b64_tr_b16 a[132:133], v19 offset:0
  ds_read_b64_tr_b16 a[134:135], v19 offset:1024
  ds_read_b64_tr_b16 a[136:137], v18 offset:4096
  ds_read_b64_tr_b16 a[138:139], v18 offset:5120
  ds_read_b64_tr_b16 a[140:141], v19 offset:4096
  ds_read_b64_tr_b16 a[142:143], v19 offset:5120
  ds_read_b64_tr_b16 a[144:145], v18 offset:8192
  ds_read_b64_tr_b16 a[146:147], v18 offset:9216
  ds_read_b64_tr_b16 a[148:149], v19 offset:8192
  ds_read_b64_tr_b16 a[150:151], v19 offset:9216
  ds_read_b64_tr_b16 a[152:153], v18 offset:12288
  ds_read_b64_tr_b16 a[154:155], v18 offset:13312
  ds_read_b64_tr_b16 a[156:157], v19 offset:12288
  ds_read_b64_tr_b16 a[158:159], v19 offset:13312
  s_waitcnt lgkmcnt(0)
  s_waitcnt vmcnt(24)
  s_barrier
  v_add_u32 v18, 0, v2
  v_add_u32 v19, 0, v3
  ds_read_b64_tr_b16 a[160:161], v18 offset:0
  ds_read_b64_tr_b16 a[162:163], v18 offset:1024
  ds_read_b64_tr_b16 a[164:165], v19 offset:0
  ds_read_b64_tr_b16 a[166:167], v19 offset:1024
  ds_read_b64_tr_b16 a[168:169], v18 offset:4096
  ds_read_b64_tr_b16 a[170:171], v18 offset:5120
  ds_read_b64_tr_b16 a[172:173], v19 offset:4096
  ds_read_b64_tr_b16 a[174:175], v19 offset:5120
  ds_read_b64_tr_b16 a[176:177], v18 offset:8192
  ds_read_b64_tr_b16 a[178:179], v18 offset:9216
  ds_read_b64_tr_b16 a[180:181], v19 offset:8192
  ds_read_b64_tr_b16 a[182:183], v19 offset:9216
  ds_read_b64_tr_b16 a[184:185], v18 offset:12288
  ds_read_b64_tr_b16 a[186:187], v18 offset:13312
  ds_read_b64_tr_b16 a[188:189], v19 offset:12288
  ds_read_b64_tr_b16 a[190:191], v19 offset:13312
  s_waitcnt lgkmcnt(0)
  s_waitcnt vmcnt(16)
  s_barrier
  v_add_u32 v18, 32768, v2
  v_add_u32 v19, 32768, v3
  ds_read_b64_tr_b16 a[192:193], v18 offset:0
  ds_read_b64_tr_b16 a[194:195], v18 offset:1024
  ds_read_b64_tr_b16 a[196:197], v19 offset:0
  ds_read_b64_tr_b16 a[198:199], v19 offset:1024
  ds_read_b64_tr_b16 a[200:201], v18 offset:4096
  ds_read_b64_tr_b16 a[202:203], v18 offset:5120
  ds_read_b64_tr_b16 a[204:205], v19 offset:4096
  ds_read_b64_tr_b16 a[206:207], v19 offset:5120
  ds_read_b64_tr_b16 a[208:209], v18 offset:8192
  ds_read_b64_tr_b16 a[210:211], v18 offset:9216
  ds_read_b64_tr_b16 a[212:213], v19 offset:8192
  ds_read_b64_tr_b16 a[214:215], v19 offset:9216
  ds_read_b64_tr_b16 a[216:217], v18 offset:12288
  ds_read_b64_tr_b16 a[218:219], v18 offset:13312
  ds_read_b64_tr_b16 a[220:221], v19 offset:12288
  ds_read_b64_tr_b16 a[222:223], v19 offset:13312
  s_waitcnt lgkmcnt(0)
  s_waitcnt vmcnt(8)
  s_barrier
  v_add_u32 v18, 65536, v2
  v_add_u32 v19, 65536, v3
  ds_read_b64_tr_b16 a[224:225], v18 offset:0
  ds_read_b64_tr_b16 a[226:227], v18 offset:1024
  ds_read_b64_tr_b16 a[228:229], v19 offset:0
  ds_read_b64_tr_b16 a[230:231], v19 offset:1024
  ds_read_b64_tr_b16 a[232:233], v18 offset:4096
  ds_read_b64_tr_b16 a[234:235], v18 offset:5120
  ds_read_b64_tr_b16 a[236:237], v19 offset:4096
  ds_read_b64_tr_b16 a[238:239], v19 offset:5120
  ds_read_b64_tr_b16 a[240:241], v18 offset:8192
  ds_read_b64_tr_b16 a[242:243], v18 offset:9216
  ds_read_b64_tr_b16 a[244:245], v19 offset:8192
  ds_read_b64_tr_b16 a[246:247], v19 offset:9216
  ds_read_b64_tr_b16 a[248:249], v18 offset:12288
  ds_read_b64_tr_b16 a[250:251], v18 offset:13312
  ds_read_b64_tr_b16 a[252:253], v19 offset:12288
  ds_read_b64_tr_b16 a[254:255], v19 offset:13312
  s_waitcnt lgkmcnt(0)
  s_waitcnt vmcnt(0)
  s_barrier
  v_add_u32 v18, 98304, v2
  v_add_u32 v19, 98304, v3
  ds_read_b64_tr_b16 v[224:225], v18 offset:0
  ds_read_b64_tr_b16 v[226:227], v18 offset:1024
  ds_read_b64_tr_b16 v[228:229], v19 offset:0
  ds_read_b64_tr_b16 v[230:231], v19 offset:1024
  ds_read_b64_tr_b16 v[232:233], v18 offset:4096
  ds_read_b64_tr_b16 v[234:235], v18 offset:5120
  ds_read_b64_tr_b16 v[236:237], v19 offset:4096
  ds_read_b64_tr_b16 v[238:239], v19 offset:5120
  ds_read_b64_tr_b16 v[240:241], v18 offset:8192
  ds_read_b64_tr_b16 v[242:243], v18 offset:9216
  ds_read_b64_tr_b16 v[244:245], v19 offset:8192
  ds_read_b64_tr_b16 v[246:247], v19 offset:9216
  ds_read_b64_tr_b16 v[248:249], v18 offset:12288
  ds_read_b64_tr_b16 v[250:251], v18 offset:13312
  ds_read_b64_tr_b16 v[252:253], v19 offset:12288
  ds_read_b64_tr_b16 v[254:255], v19 offset:13312
  s_waitcnt lgkmcnt(0)
  s_barrier
  v_lshrrev_b32 v12, 5, v0
  v_lshlrev_b32 v12, 8, v12
  v_and_b32 v13, 15, v0
  v_lshlrev_b32 v13, 4, v13
  v_add_u32 v12, v12, v13
  v_bfe_u32 v13, v0, 4, 1
  v_mul_u32_u24 v13, 1024, v13
  v_add_u32 v10, v12, v13
  v_lshrrev_b32 v12, 3, v0
  s_movk_i32 s4, 1152
  v_mul_lo_u32 v12, v12, s4
  v_and_b32 v13, 7, v0
  v_lshrrev_b32 v14, 4, v0
  v_xor_b32 v15, v13, v14
  v_lshlrev_b32 v15, 4, v15
  v_add_u32 v4, v12, v15
  v_add_u32 v14, 4, v14
  v_xor_b32 v15, v13, v14
  v_lshlrev_b32 v15, 4, v15
  v_add_u32 v5, v12, v15
  v_and_b32 v12, 31, v0
  v_lshrrev_b32 v13, 5, v0
  v_bfe_u32 v14, v0, 1, 3
  v_lshlrev_b32 v12, 7, v12
  v_add_u32 v15, 0, v13
  v_xor_b32 v15, v15, v14
  v_lshlrev_b32 v15, 4, v15
  v_add_u32 v6, v12, v15
  v_add_u32 v15, 2, v13
  v_xor_b32 v15, v15, v14
  v_lshlrev_b32 v15, 4, v15
  v_add_u32 v7, v12, v15
  v_add_u32 v15, 4, v13
  v_xor_b32 v15, v15, v14
  v_lshlrev_b32 v15, 4, v15
  v_add_u32 v8, v12, v15
  v_add_u32 v15, 6, v13
  v_xor_b32 v15, v15, v14
  v_lshlrev_b32 v15, 4, v15
  v_add_u32 v9, v12, v15
  s_mov_b32 s71, 0
  s_lshl_b32 s4, s3, 11
  s_add_u32 s71, s71, s4
  s_mul_i32 s72, s68, 73728
  s_mul_i32 s5, s3, 18432
  s_add_u32 s72, s72, s5
  s_add_u32 m0, s71, 0
  s_add_u32 s73, s72, 0
  buffer_load_dwordx4 v4, s[52:55], s73 offen lds
  s_add_u32 m0, s71, 1024
  s_add_u32 s73, s72, 9216
  buffer_load_dwordx4 v5, s[52:55], s73 offen lds
  s_add_u32 m0, s71, 8192
  s_add_u32 s73, s72, 128
  buffer_load_dwordx4 v4, s[52:55], s73 offen lds
  s_add_u32 m0, s71, 9216
  s_add_u32 s73, s72, 9344
  buffer_load_dwordx4 v5, s[52:55], s73 offen lds
  s_add_u32 m0, s71, 16384
  s_add_u32 s73, s72, 256
  buffer_load_dwordx4 v4, s[52:55], s73 offen lds
  s_add_u32 m0, s71, 17408
  s_add_u32 s73, s72, 9472
  buffer_load_dwordx4 v5, s[52:55], s73 offen lds
  s_add_u32 m0, s71, 24576
  s_add_u32 s73, s72, 384
  buffer_load_dwordx4 v4, s[52:55], s73 offen lds
  s_add_u32 m0, s71, 25600
  s_add_u32 s73, s72, 9600
  buffer_load_dwordx4 v5, s[52:55], s73 offen lds
  s_add_u32 m0, s71, 32768
  s_add_u32 s73, s72, 512
  buffer_load_dwordx4 v4, s[52:55], s73 offen lds
  s_add_u32 m0, s71, 33792
  s_add_u32 s73, s72, 9728
  buffer_load_dwordx4 v5, s[52:55], s73 offen lds
  s_add_u32 m0, s71, 40960
  s_add_u32 s73, s72, 640
  buffer_load_dwordx4 v4, s[52:55], s73 offen lds
  s_add_u32 m0, s71, 41984
  s_add_u32 s73, s72, 9856
  buffer_load_dwordx4 v5, s[52:55], s73 offen lds
  s_add_u32 m0, s71, 49152
  s_add_u32 s73, s72, 768
  buffer_load_dwordx4 v4, s[52:55], s73 offen lds
  s_add_u32 m0, s71, 50176
  s_add_u32 s73, s72, 9984
  buffer_load_dwordx4 v5, s[52:55], s73 offen lds
  s_add_u32 m0, s71, 57344
  s_add_u32 s73, s72, 896
  buffer_load_dwordx4 v4, s[52:55], s73 offen lds
  s_add_u32 m0, s71, 58368
  s_add_u32 s73, s72, 10112
  buffer_load_dwordx4 v5, s[52:55], s73 offen lds
  s_add_u32 m0, s71, 65536
  s_add_u32 s73, s72, 1024
  buffer_load_dwordx4 v4, s[52:55], s73 offen lds
  s_add_u32 m0, s71, 66560
  s_add_u32 s73, s72, 10240
  buffer_load_dwordx4 v5, s[52:55], s73 offen lds
  s_mov_b32 s70, 0
  s_mov_b32 s77, -1
  s_waitcnt vmcnt(0)
  s_barrier
L_w1loop_23:
  s_add_u32 s10, s68, s75
  s_xor_b32 s71, s70, 73728
  s_lshl_b32 s4, s3, 11
  s_mul_i32 s72, s10, 73728
  s_mul_i32 s5, s3, 18432
  s_add_u32 s72, s72, s5
  s_mov_b32 s11, s71
  s_add_u32 s71, s71, s4
  v_add_u32 v120, s70, v6
  v_add_u32 v121, s70, v7
  v_add_u32 v122, s70, v8
  v_add_u32 v123, s70, v9
  ds_read_b128 v[96:99], v120 offset:0
  ds_read_b128 v[100:103], v120 offset:4096
  ds_read_b128 v[104:107], v121 offset:0
  ds_read_b128 v[108:111], v121 offset:4096
  ds_read_b128 v[112:115], v122 offset:0
  ds_read_b128 v[116:119], v122 offset:4096
  s_waitcnt lgkmcnt(4)
  v_mfma_f32_32x32x16_bf16 v[32:47], a[0:3], v[96:99], 0
  v_mfma_f32_32x32x16_bf16 v[48:63], a[4:7], v[96:99], 0
  s_add_u32 m0, s71, 0
  s_add_u32 s73, s72, 0
  buffer_load_dwordx4 v4, s[52:55], s73 offen lds
  v_mfma_f32_32x32x16_bf16 v[64:79], a[0:3], v[100:103], 0
  v_mfma_f32_32x32x16_bf16 v[80:95], a[4:7], v[100:103], 0
  ds_read_b128 v[96:99], v123 offset:0
  ds_read_b128 v[100:103], v123 offset:4096
  s_waitcnt lgkmcnt(4)
  v_mfma_f32_32x32x16_bf16 v[32:47], a[8:11], v[104:107], v[32:47]
  v_mfma_f32_32x32x16_bf16 v[48:63], a[12:15], v[104:107], v[48:63]
  v_mfma_f32_32x32x16_bf16 v[64:79], a[8:11], v[108:111], v[64:79]
  v_mfma_f32_32x32x16_bf16 v[80:95], a[12:15], v[108:111], v[80:95]
  ds_read_b128 v[104:107], v120 offset:8192
  ds_read_b128 v[108:111], v120 offset:12288
  s_waitcnt lgkmcnt(4)
  v_mfma_f32_32x32x16_bf16 v[32:47], a[16:19], v[112:115], v[32:47]
  v_mfma_f32_32x32x16_bf16 v[48:63], a[20:23], v[112:115], v[48:63]
  s_add_u32 m0, s71, 1024
  s_add_u32 s73, s72, 9216
  buffer_load_dwordx4 v5, s[52:55], s73 offen lds
  v_mfma_f32_32x32x16_bf16 v[64:79], a[16:19], v[116:119], v[64:79]
  v_mfma_f32_32x32x16_bf16 v[80:95], a[20:23], v[116:119], v[80:95]
  ds_read_b128 v[112:115], v121 offset:8192
  ds_read_b128 v[116:119], v121 offset:12288
  s_waitcnt lgkmcnt(4)
  v_mfma_f32_32x32x16_bf16 v[32:47], a[24:27], v[96:99], v[32:47]
  v_mfma_f32_32x32x16_bf16 v[48:63], a[28:31], v[96:99], v[48:63]
  v_mfma_f32_32x32x16_bf16 v[64:79], a[24:27], v[100:103], v[64:79]
  v_mfma_f32_32x32x16_bf16 v[80:95], a[28:31], v[100:103], v[80:95]
  ds_read_b128 v[96:99], v122 offset:8192
  ds_read_b128 v[100:103], v122 offset:12288
  s_waitcnt lgkmcnt(4)
  v_mfma_f32_32x32x16_bf16 v[32:47], a[32:35], v[104:107], v[32:47]
  v_mfma_f32_32x32x16_bf16 v[48:63], a[36:39], v[104:107], v[48:63]
  s_add_u32 m0, s71, 8192
  s_add_u32 s73, s72, 128
  buffer_load_dwordx4 v4, s[52:55], s73 offen lds
  v_mfma_f32_32x32x16_bf16 v[64:79], a[32:35], v[108:111], v[64:79]
  v_mfma_f32_32x32x16_bf16 v[80:95], a[36:39], v[108:111], v[80:95]
  ds_read_b128 v[104:107], v123 offset:8192
  ds_read_b128 v[108:111], v123 offset:12288
  s_waitcnt lgkmcnt(4)
  v_mfma_f32_32x32x16_bf16 v[32:47], a[40:43], v[112:115], v[32:47]
  v_mfma_f32_32x32x16_bf16 v[48:63], a[44:47], v[112:115], v[48:63]
  v_mfma_f32_32x32x16_bf16 v[64:79], a[40:43], v[116:119], v[64:79]
  v_mfma_f32_32x32x16_bf16 v[80:95], a[44:47], v[116:119], v[80:95]
  ds_read_b128 v[112:115], v120 offset:16384
  ds_read_b128 v[116:119], v120 offset:20480
  s_waitcnt lgkmcnt(4)
  v_mfma_f32_32x32x16_bf16 v[32:47], a[48:51], v[96:99], v[32:47]
  v_mfma_f32_32x32x16_bf16 v[48:63], a[52:55], v[96:99], v[48:63]
  s_add_u32 m0, s71, 9216
  s_add_u32 s73, s72, 9344
  buffer_load_dwordx4 v5, s[52:55], s73 offen lds
  v_mfma_f32_32x32x16_bf16 v[64:79], a[48:51], v[100:103], v[64:79]
  v_mfma_f32_32x32x16_bf16 v[80:95], a[52:55], v[100:103], v[80:95]
  ds_read_b128 v[96:99], v121 offset:16384
  ds_read_b128 v[100:103], v121 offset:20480
  s_waitcnt lgkmcnt(4)
  v_mfma_f32_32x32x16_bf16 v[32:47], a[56:59], v[104:107], v[32:47]
  v_mfma_f32_32x32x16_bf16 v[48:63], a[60:63], v[104:107], v[48:63]
  v_mfma_f32_32x32x16_bf16 v[64:79], a[56:59], v[108:111], v[64:79]
  v_mfma_f32_32x32x16_bf16 v[80:95], a[60:63], v[108:111], v[80:95]
  ds_read_b128 v[104:107], v122 offset:16384
  ds_read_b128 v[108:111], v122 offset:20480
  s_waitcnt lgkmcnt(4)
  v_mfma_f32_32x32x16_bf16 v[32:47], a[64:67], v[112:115], v[32:47]
  v_mfma_f32_32x32x16_bf16 v[48:63], a[68:71], v[112:115], v[48:63]
  s_add_u32 m0, s71, 16384
  s_add_u32 s73, s72, 256
  buffer_load_dwordx4 v4, s[52:55], s73 offen lds
  v_mfma_f32_32x32x16_bf16 v[64:79], a[64:67], v[116:119], v[64:79]
  v_mfma_f32_32x32x16_bf16 v[80:95], a[68:71], v[116:119], v[80:95]
  ds_read_b128 v[112:115], v123 offset:16384
  ds_read_b128 v[116:119], v123 offset:20480
  s_waitcnt lgkmcnt(4)
  v_mfma_f32_32x32x16_bf16 v[32:47], a[72:75], v[96:99], v[32:47]
  v_mfma_f32_32x32x16_bf16 v[48:63], a[76:79], v[96:99], v[48:63]
  v_mfma_f32_32x32x16_bf16 v[64:79], a[72:75], v[100:103], v[64:79]
  v_mfma_f32_32x32x16_bf16 v[80:95], a[76:79], v[100:103], v[80:95]
  ds_read_b128 v[96:99], v120 offset:24576
  ds_read_b128 v[100:103], v120 offset:28672
  s_waitcnt lgkmcnt(4)
  v_mfma_f32_32x32x16_bf16 v[32:47], a[80:83], v[104:107], v[32:47]
  v_mfma_f32_32x32x16_bf16 v[48:63], a[84:87], v[104:107], v[48:63]
  s_add_u32 m0, s71, 17408
  s_add_u32 s73, s72, 9472
  buffer_load_dwordx4 v5, s[52:55], s73 offen lds
  v_mfma_f32_32x32x16_bf16 v[64:79], a[80:83], v[108:111], v[64:79]
  v_mfma_f32_32x32x16_bf16 v[80:95], a[84:87], v[108:111], v[80:95]
  ds_read_b128 v[104:107], v121 offset:24576
  ds_read_b128 v[108:111], v121 offset:28672
  s_waitcnt lgkmcnt(4)
  v_mfma_f32_32x32x16_bf16 v[32:47], a[88:91], v[112:115], v[32:47]
  v_mfma_f32_32x32x16_bf16 v[48:63], a[92:95], v[112:115], v[48:63]
  v_mfma_f32_32x32x16_bf16 v[64:79], a[88:91], v[116:119], v[64:79]
  v_mfma_f32_32x32x16_bf16 v[80:95], a[92:95], v[116:119], v[80:95]
  ds_read_b128 v[112:115], v122 offset:24576
  ds_read_b128 v[116:119], v122 offset:28672
  s_waitcnt lgkmcnt(4)
  v_mfma_f32_32x32x16_bf16 v[32:47], a[96:99], v[96:99], v[32:47]
  v_mfma_f32_32x32x16_bf16 v[48:63], a[100:103], v[96:99], v[48:63]
  s_add_u32 m0, s71, 24576
  s_add_u32 s73, s72, 384
  buffer_load_dwordx4 v4, s[52:55], s73 offen lds
  v_mfma_f32_32x32x16_bf16 v[64:79], a[96:99], v[100:103], v[64:79]
  v_mfma_f32_32x32x16_bf16 v[80:95], a[100:103], v[100:103], v[80:95]
  ds_read_b128 v[96:99], v123 offset:24576
  ds_read_b128 v[100:103], v123 offset:28672
  s_waitcnt lgkmcnt(4)
  v_mfma_f32_32x32x16_bf16 v[32:47], a[104:107], v[104:107], v[32:47]
  v_mfma_f32_32x32x16_bf16 v[48:63], a[108:111], v[104:107], v[48:63]
  v_mfma_f32_32x32x16_bf16 v[64:79], a[104:107], v[108:111], v[64:79]
  v_mfma_f32_32x32x16_bf16 v[80:95], a[108:111], v[108:111], v[80:95]
  v_add_u32 v120, 0x8000, v120
  v_add_u32 v121, 0x8000, v121
  v_add_u32 v122, 0x8000, v122
  v_add_u32 v123, 0x8000, v123
  ds_read_b128 v[104:107], v120 offset:0
  ds_read_b128 v[108:111], v120 offset:4096
  s_waitcnt lgkmcnt(4)
  v_mfma_f32_32x32x16_bf16 v[32:47], a[112:115], v[112:115], v[32:47]
  v_mfma_f32_32x32x16_bf16 v[48:63], a[116:119], v[112:115], v[48:63]
  s_add_u32 m0, s71, 25600
  s_add_u32 s73, s72, 9600
  buffer_load_dwordx4 v5, s[52:55], s73 offen lds
  v_mfma_f32_32x32x16_bf16 v[64:79], a[112:115], v[116:119], v[64:79]
  v_mfma_f32_32x32x16_bf16 v[80:95], a[116:119], v[116:119], v[80:95]
  ds_read_b128 v[112:115], v121 offset:0
  ds_read_b128 v[116:119], v121 offset:4096
  s_waitcnt lgkmcnt(4)
  v_mfma_f32_32x32x16_bf16 v[32:47], a[120:123], v[96:99], v[32:47]
  v_mfma_f32_32x32x16_bf16 v[48:63], a[124:127], v[96:99], v[48:63]
  v_mfma_f32_32x32x16_bf16 v[64:79], a[120:123], v[100:103], v[64:79]
  v_mfma_f32_32x32x16_bf16 v[80:95], a[124:127], v[100:103], v[80:95]
  ds_read_b128 v[96:99], v122 offset:0
  ds_read_b128 v[100:103], v122 offset:4096
  s_waitcnt lgkmcnt(4)
  v_mfma_f32_32x32x16_bf16 v[32:47], a[128:131], v[104:107], v[32:47]
  v_mfma_f32_32x32x16_bf16 v[48:63], a[132:135], v[104:107], v[48:63]
  s_add_u32 m0, s71, 32768
  s_add_u32 s73, s72, 512
  buffer_load_dwordx4 v4, s[52:55], s73 offen lds
  v_mfma_f32_32x32x16_bf16 v[64:79], a[128:131], v[108:111], v[64:79]
  v_mfma_f32_32x32x16_bf16 v[80:95], a[132:135], v[108:111], v[80:95]
  ds_read_b128 v[104:107], v123 offset:0
  ds_read_b128 v[108:111], v123 offset:4096
  s_waitcnt lgkmcnt(4)
  v_mfma_f32_32x32x16_bf16 v[32:47], a[136:139], v[112:115], v[32:47]
  v_mfma_f32_32x32x16_bf16 v[48:63], a[140:143], v[112:115], v[48:63]
  v_mfma_f32_32x32x16_bf16 v[64:79], a[136:139], v[116:119], v[64:79]
  v_mfma_f32_32x32x16_bf16 v[80:95], a[140:143], v[116:119], v[80:95]
  ds_read_b128 v[112:115], v120 offset:8192
  ds_read_b128 v[116:119], v120 offset:12288
  s_waitcnt lgkmcnt(4)
  v_mfma_f32_32x32x16_bf16 v[32:47], a[144:147], v[96:99], v[32:47]
  v_mfma_f32_32x32x16_bf16 v[48:63], a[148:151], v[96:99], v[48:63]
  s_add_u32 m0, s71, 33792
  s_add_u32 s73, s72, 9728
  buffer_load_dwordx4 v5, s[52:55], s73 offen lds
  v_mfma_f32_32x32x16_bf16 v[64:79], a[144:147], v[100:103], v[64:79]
  v_mfma_f32_32x32x16_bf16 v[80:95], a[148:151], v[100:103], v[80:95]
  ds_read_b128 v[96:99], v121 offset:8192
  ds_read_b128 v[100:103], v121 offset:12288
  s_waitcnt lgkmcnt(4)
  v_mfma_f32_32x32x16_bf16 v[32:47], a[152:155], v[104:107], v[32:47]
  v_mfma_f32_32x32x16_bf16 v[48:63], a[156:159], v[104:107], v[48:63]
  v_mfma_f32_32x32x16_bf16 v[64:79], a[152:155], v[108:111], v[64:79]
  v_mfma_f32_32x32x16_bf16 v[80:95], a[156:159], v[108:111], v[80:95]
  ds_read_b128 v[104:107], v122 offset:8192
  ds_read_b128 v[108:111], v122 offset:12288
  s_waitcnt lgkmcnt(4)
  v_mfma_f32_32x32x16_bf16 v[32:47], a[160:163], v[112:115], v[32:47]
  v_mfma_f32_32x32x16_bf16 v[48:63], a[164:167], v[112:115], v[48:63]
  s_add_u32 m0, s71, 40960
  s_add_u32 s73, s72, 640
  buffer_load_dwordx4 v4, s[52:55], s73 offen lds
  v_mfma_f32_32x32x16_bf16 v[64:79], a[160:163], v[116:119], v[64:79]
  v_mfma_f32_32x32x16_bf16 v[80:95], a[164:167], v[116:119], v[80:95]
  ds_read_b128 v[112:115], v123 offset:8192
  ds_read_b128 v[116:119], v123 offset:12288
  s_waitcnt lgkmcnt(4)
  v_mfma_f32_32x32x16_bf16 v[32:47], a[168:171], v[96:99], v[32:47]
  v_mfma_f32_32x32x16_bf16 v[48:63], a[172:175], v[96:99], v[48:63]
  v_mfma_f32_32x32x16_bf16 v[64:79], a[168:171], v[100:103], v[64:79]
  v_mfma_f32_32x32x16_bf16 v[80:95], a[172:175], v[100:103], v[80:95]
  ds_read_b128 v[96:99], v120 offset:16384
  ds_read_b128 v[100:103], v120 offset:20480
  s_waitcnt lgkmcnt(4)
  v_mfma_f32_32x32x16_bf16 v[32:47], a[176:179], v[104:107], v[32:47]
  v_mfma_f32_32x32x16_bf16 v[48:63], a[180:183], v[104:107], v[48:63]
  s_add_u32 m0, s71, 41984
  s_add_u32 s73, s72, 9856
  buffer_load_dwordx4 v5, s[52:55], s73 offen lds
  v_mfma_f32_32x32x16_bf16 v[64:79], a[176:179], v[108:111], v[64:79]
  v_mfma_f32_32x32x16_bf16 v[80:95], a[180:183], v[108:111], v[80:95]
  ds_read_b128 v[104:107], v121 offset:16384
  ds_read_b128 v[108:111], v121 offset:20480
  s_waitcnt lgkmcnt(4)
  v_mfma_f32_32x32x16_bf16 v[32:47], a[184:187], v[112:115], v[32:47]
  v_mfma_f32_32x32x16_bf16 v[48:63], a[188:191], v[112:115], v[48:63]
  v_mfma_f32_32x32x16_bf16 v[64:79], a[184:187], v[116:119], v[64:79]
  v_mfma_f32_32x32x16_bf16 v[80:95], a[188:191], v[116:119], v[80:95]
  ds_read_b128 v[112:115], v122 offset:16384
  ds_read_b128 v[116:119], v122 offset:20480
  s_waitcnt lgkmcnt(4)
  v_mfma_f32_32x32x16_bf16 v[32:47], a[192:195], v[96:99], v[32:47]
  v_mfma_f32_32x32x16_bf16 v[48:63], a[196:199], v[96:99], v[48:63]
  s_add_u32 m0, s71, 49152
  s_add_u32 s73, s72, 768
  buffer_load_dwordx4 v4, s[52:55], s73 offen lds
  v_mfma_f32_32x32x16_bf16 v[64:79], a[192:195], v[100:103], v[64:79]
  v_mfma_f32_32x32x16_bf16 v[80:95], a[196:199], v[100:103], v[80:95]
  ds_read_b128 v[96:99], v123 offset:16384
  ds_read_b128 v[100:103], v123 offset:20480
  s_waitcnt lgkmcnt(4)
  v_mfma_f32_32x32x16_bf16 v[32:47], a[200:203], v[104:107], v[32:47]
  v_mfma_f32_32x32x16_bf16 v[48:63], a[204:207], v[104:107], v[48:63]
  v_mfma_f32_32x32x16_bf16 v[64:79], a[200:203], v[108:111], v[64:79]
  v_mfma_f32_32x32x16_bf16 v[80:95], a[204:207], v[108:111], v[80:95]
  ds_read_b128 v[104:107], v120 offset:24576
  ds_read_b128 v[108:111], v120 offset:28672
  s_waitcnt lgkmcnt(4)
  v_mfma_f32_32x32x16_bf16 v[32:47], a[208:211], v[112:115], v[32:47]
  v_mfma_f32_32x32x16_bf16 v[48:63], a[212:215], v[112:115], v[48:63]
  s_add_u32 m0, s71, 50176
  s_add_u32 s73, s72, 9984
  buffer_load_dwordx4 v5, s[52:55], s73 offen lds
  v_mfma_f32_32x32x16_bf16 v[64:79], a[208:211], v[116:119], v[64:79]
  v_mfma_f32_32x32x16_bf16 v[80:95], a[212:215], v[116:119], v[80:95]
  ds_read_b128 v[112:115], v121 offset:24576
  ds_read_b128 v[116:119], v121 offset:28672
  s_waitcnt lgkmcnt(4)
  v_mfma_f32_32x32x16_bf16 v[32:47], a[216:219], v[96:99], v[32:47]
  v_mfma_f32_32x32x16_bf16 v[48:63], a[220:223], v[96:99], v[48:63]
  v_mfma_f32_32x32x16_bf16 v[64:79], a[216:219], v[100:103], v[64:79]
  v_mfma_f32_32x32x16_bf16 v[80:95], a[220:223], v[100:103], v[80:95]
  ds_read_b128 v[96:99], v122 offset:24576
  ds_read_b128 v[100:103], v122 offset:28672
  s_waitcnt lgkmcnt(4)
  v_mfma_f32_32x32x16_bf16 v[32:47], a[224:227], v[104:107], v[32:47]
  v_mfma_f32_32x32x16_bf16 v[48:63], a[228:231], v[104:107], v[48:63]
  s_add_u32 m0, s71, 57344
  s_add_u32 s73, s72, 896
  buffer_load_dwordx4 v4, s[52:55], s73 offen lds
  v_mfma_f32_32x32x16_bf16 v[64:79], a[224:227], v[108:111], v[64:79]
  v_mfma_f32_32x32x16_bf16 v[80:95], a[228:231], v[108:111], v[80:95]
  ds_read_b128 v[104:107], v123 offset:24576
  ds_read_b128 v[108:111], v123 offset:28672
  s_waitcnt lgkmcnt(4)
  v_mfma_f32_32x32x16_bf16 v[32:47], a[232:235], v[112:115], v[32:47]
  v_mfma_f32_32x32x16_bf16 v[48:63], a[236:239], v[112:115], v[48:63]
  v_mfma_f32_32x32x16_bf16 v[64:79], a[232:235], v[116:119], v[64:79]
  v_mfma_f32_32x32x16_bf16 v[80:95], a[236:239], v[116:119], v[80:95]
  ds_read_b128 v[112:115], v120 offset:32768
  ds_read_b128 v[116:119], v120 offset:36864
  s_waitcnt lgkmcnt(4)
  v_mfma_f32_32x32x16_bf16 v[32:47], a[240:243], v[96:99], v[32:47]
  v_mfma_f32_32x32x16_bf16 v[48:63], a[244:247], v[96:99], v[48:63]
  s_add_u32 m0, s71, 58368
  s_add_u32 s73, s72, 10112
  buffer_load_dwordx4 v5, s[52:55], s73 offen lds
  v_mfma_f32_32x32x16_bf16 v[64:79], a[240:243], v[100:103], v[64:79]
  v_mfma_f32_32x32x16_bf16 v[80:95], a[244:247], v[100:103], v[80:95]
  ds_read_b128 v[96:99], v121 offset:32768
  ds_read_b128 v[100:103], v121 offset:36864
  s_waitcnt lgkmcnt(4)
  v_mfma_f32_32x32x16_bf16 v[32:47], a[248:251], v[104:107], v[32:47]
  v_mfma_f32_32x32x16_bf16 v[48:63], a[252:255], v[104:107], v[48:63]
  v_mfma_f32_32x32x16_bf16 v[64:79], a[248:251], v[108:111], v[64:79]
  v_mfma_f32_32x32x16_bf16 v[80:95], a[252:255], v[108:111], v[80:95]
  ds_read_b128 v[104:107], v122 offset:32768
  ds_read_b128 v[108:111], v122 offset:36864
  s_waitcnt lgkmcnt(4)
  v_mfma_f32_32x32x16_bf16 v[32:47], v[224:227], v[112:115], v[32:47]
  v_mfma_f32_32x32x16_bf16 v[48:63], v[228:231], v[112:115], v[48:63]
  s_add_u32 m0, s71, 65536
  s_add_u32 s73, s72, 1024
  buffer_load_dwordx4 v4, s[52:55], s73 offen lds
  v_mfma_f32_32x32x16_bf16 v[64:79], v[224:227], v[116:119], v[64:79]
  v_mfma_f32_32x32x16_bf16 v[80:95], v[228:231], v[116:119], v[80:95]
  ds_read_b128 v[112:115], v123 offset:32768
  ds_read_b128 v[116:119], v123 offset:36864
  s_waitcnt lgkmcnt(4)
  v_mfma_f32_32x32x16_bf16 v[32:47], v[232:235], v[96:99], v[32:47]
  v_mfma_f32_32x32x16_bf16 v[48:63], v[236:239], v[96:99], v[48:63]
  v_mfma_f32_32x32x16_bf16 v[64:79], v[232:235], v[100:103], v[64:79]
  v_mfma_f32_32x32x16_bf16 v[80:95], v[236:239], v[100:103], v[80:95]
  s_waitcnt lgkmcnt(2)
  v_mfma_f32_32x32x16_bf16 v[32:47], v[240:243], v[104:107], v[32:47]
  v_mfma_f32_32x32x16_bf16 v[48:63], v[244:247], v[104:107], v[48:63]
  s_add_u32 m0, s71, 66560
  s_add_u32 s73, s72, 10240
  buffer_load_dwordx4 v5, s[52:55], s73 offen lds
  v_mfma_f32_32x32x16_bf16 v[64:79], v[240:243], v[108:111], v[64:79]
  v_mfma_f32_32x32x16_bf16 v[80:95], v[244:247], v[108:111], v[80:95]
  s_waitcnt lgkmcnt(0)
  v_mfma_f32_32x32x16_bf16 v[32:47], v[248:251], v[112:115], v[32:47]
  v_mfma_f32_32x32x16_bf16 v[48:63], v[252:255], v[112:115], v[48:63]
  v_mfma_f32_32x32x16_bf16 v[64:79], v[248:251], v[116:119], v[64:79]
  v_mfma_f32_32x32x16_bf16 v[80:95], v[252:255], v[116:119], v[80:95]
  s_mul_i32 s4, s68, 288
  s_lshl_b32 s5, s12, 2
  s_add_u32 s4, s4, s5
  s_add_u32 s4, s4, s3
  s_lshl_b32 s4, s4, 11
  s_add_u32 s76, s4, 84934656
  s_mov_b32 s82, 294912
  s_waitcnt vmcnt(0)
  s_nop 11
  s_mov_b32 s6, 0xbdd2d3e8
  s_mov_b32 s7, 0xc0135761
  v_mov_b32 v136, s7
  s_mov_b32 s74, s76
  v_mul_f32 v140, v32, v32
  v_mul_f32 v141, v33, v33
  v_mul_f32 v142, v34, v34
  v_mul_f32 v143, v35, v35
  v_fma_f32 v140, v140, s6, v136
  v_fma_f32 v141, v141, s6, v136
  v_fma_f32 v142, v142, s6, v136
  v_fma_f32 v143, v143, s6, v136
  v_mul_f32 v140, v140, v32
  v_mul_f32 v141, v141, v33
  v_mul_f32 v142, v142, v34
  v_mul_f32 v143, v143, v35
  v_exp_f32 v140, v140
  v_exp_f32 v141, v141
  v_exp_f32 v142, v142
  v_exp_f32 v143, v143
  v_mul_f32 v32, v32, v48
  v_mul_f32 v33, v33, v49
  v_mul_f32 v34, v34, v50
  v_mul_f32 v35, v35, v51
  v_add_f32 v140, 1.0, v140
  v_add_f32 v141, 1.0, v141
  v_add_f32 v142, 1.0, v142
  v_add_f32 v143, 1.0, v143
  v_rcp_f32 v140, v140
  v_rcp_f32 v141, v141
  v_rcp_f32 v142, v142
  v_rcp_f32 v143, v143
  s_nop 0
  v_mul_f32 v32, v32, v140
  v_mul_f32 v33, v33, v141
  v_mul_f32 v34, v34, v142
  v_mul_f32 v35, v35, v143
  v_mul_f32 v140, v36, v36
  v_mul_f32 v141, v37, v37
  v_mul_f32 v142, v38, v38
  v_mul_f32 v143, v39, v39
  v_fma_f32 v140, v140, s6, v136
  v_fma_f32 v141, v141, s6, v136
  v_fma_f32 v142, v142, s6, v136
  v_fma_f32 v143, v143, s6, v136
  v_mul_f32 v140, v140, v36
  v_mul_f32 v141, v141, v37
  v_mul_f32 v142, v142, v38
  v_mul_f32 v143, v143, v39
  v_exp_f32 v140, v140
  v_exp_f32 v141, v141
  v_exp_f32 v142, v142
  v_exp_f32 v143, v143
  v_mul_f32 v36, v36, v52
  v_mul_f32 v37, v37, v53
  v_mul_f32 v38, v38, v54
  v_mul_f32 v39, v39, v55
  v_add_f32 v140, 1.0, v140
  v_add_f32 v141, 1.0, v141
  v_add_f32 v142, 1.0, v142
  v_add_f32 v143, 1.0, v143
  v_rcp_f32 v140, v140
  v_rcp_f32 v141, v141
  v_rcp_f32 v142, v142
  v_rcp_f32 v143, v143
  s_nop 0
  v_mul_f32 v36, v36, v140
  v_mul_f32 v37, v37, v141
  v_mul_f32 v38, v38, v142
  v_mul_f32 v39, v39, v143
  v_mul_f32 v140, v40, v40
  v_mul_f32 v141, v41, v41
  v_mul_f32 v142, v42, v42
  v_mul_f32 v143, v43, v43
  v_fma_f32 v140, v140, s6, v136
  v_fma_f32 v141, v141, s6, v136
  v_fma_f32 v142, v142, s6, v136
  v_fma_f32 v143, v143, s6, v136
  v_mul_f32 v140, v140, v40
  v_mul_f32 v141, v141, v41
  v_mul_f32 v142, v142, v42
  v_mul_f32 v143, v143, v43
  v_exp_f32 v140, v140
  v_exp_f32 v141, v141
  v_exp_f32 v142, v142
  v_exp_f32 v143, v143
  v_mul_f32 v40, v40, v56
  v_mul_f32 v41, v41, v57
  v_mul_f32 v42, v42, v58
  v_mul_f32 v43, v43, v59
  v_add_f32 v140, 1.0, v140
  v_add_f32 v141, 1.0, v141
  v_add_f32 v142, 1.0, v142
  v_add_f32 v143, 1.0, v143
  v_rcp_f32 v140, v140
  v_rcp_f32 v141, v141
  v_rcp_f32 v142, v142
  v_rcp_f32 v143, v143
  s_nop 0
  v_mul_f32 v40, v40, v140
  v_mul_f32 v41, v41, v141
  v_mul_f32 v42, v42, v142
  v_mul_f32 v43, v43, v143
  v_mul_f32 v140, v44, v44
  v_mul_f32 v141, v45, v45
  v_mul_f32 v142, v46, v46
  v_mul_f32 v143, v47, v47
  v_fma_f32 v140, v140, s6, v136
  v_fma_f32 v141, v141, s6, v136
  v_fma_f32 v142, v142, s6, v136
  v_fma_f32 v143, v143, s6, v136
  v_mul_f32 v140, v140, v44
  v_mul_f32 v141, v141, v45
  v_mul_f32 v142, v142, v46
  v_mul_f32 v143, v143, v47
  v_exp_f32 v140, v140
  v_exp_f32 v141, v141
  v_exp_f32 v142, v142
  v_exp_f32 v143, v143
  v_mul_f32 v44, v44, v60
  v_mul_f32 v45, v45, v61
  v_mul_f32 v46, v46, v62
  v_mul_f32 v47, v47, v63
  v_add_f32 v140, 1.0, v140
  v_add_f32 v141, 1.0, v141
  v_add_f32 v142, 1.0, v142
  v_add_f32 v143, 1.0, v143
  v_rcp_f32 v140, v140
  v_rcp_f32 v141, v141
  v_rcp_f32 v142, v142
  v_rcp_f32 v143, v143
  s_nop 0
  v_mul_f32 v44, v44, v140
  v_mul_f32 v45, v45, v141
  v_mul_f32 v46, v46, v142
  v_mul_f32 v47, v47, v143
  v_cvt_pk_bf16_f32 v120, v32, v33
  v_cvt_pk_bf16_f32 v121, v34, v35
  v_cvt_pk_bf16_f32 v122, v40, v41
  v_cvt_pk_bf16_f32 v123, v42, v43
  buffer_store_dwordx4 v[120:123], v10, s[48:51], s74 offen offset:0 sc1
  v_cvt_pk_bf16_f32 v124, v36, v37
  v_cvt_pk_bf16_f32 v125, v38, v39
  v_cvt_pk_bf16_f32 v126, v44, v45
  v_cvt_pk_bf16_f32 v127, v46, v47
  buffer_store_dwordx4 v[124:127], v10, s[48:51], s74 offen offset:512 sc1
  s_mov_b32 s74, s76
  s_add_u32 s74, s74, s82
  v_mul_f32 v140, v64, v64
  v_mul_f32 v141, v65, v65
  v_mul_f32 v142, v66, v66
  v_mul_f32 v143, v67, v67
  v_fma_f32 v140, v140, s6, v136
  v_fma_f32 v141, v141, s6, v136
  v_fma_f32 v142, v142, s6, v136
  v_fma_f32 v143, v143, s6, v136
  v_mul_f32 v140, v140, v64
  v_mul_f32 v141, v141, v65
  v_mul_f32 v142, v142, v66
  v_mul_f32 v143, v143, v67
  v_exp_f32 v140, v140
  v_exp_f32 v141, v141
  v_exp_f32 v142, v142
  v_exp_f32 v143, v143
  v_mul_f32 v64, v64, v80
  v_mul_f32 v65, v65, v81
  v_mul_f32 v66, v66, v82
  v_mul_f32 v67, v67, v83
  v_add_f32 v140, 1.0, v140
  v_add_f32 v141, 1.0, v141
  v_add_f32 v142, 1.0, v142
  v_add_f32 v143, 1.0, v143
  v_rcp_f32 v140, v140
  v_rcp_f32 v141, v141
  v_rcp_f32 v142, v142
  v_rcp_f32 v143, v143
  s_nop 0
  v_mul_f32 v64, v64, v140
  v_mul_f32 v65, v65, v141
  v_mul_f32 v66, v66, v142
  v_mul_f32 v67, v67, v143
  v_mul_f32 v140, v68, v68
  v_mul_f32 v141, v69, v69
  v_mul_f32 v142, v70, v70
  v_mul_f32 v143, v71, v71
  v_fma_f32 v140, v140, s6, v136
  v_fma_f32 v141, v141, s6, v136
  v_fma_f32 v142, v142, s6, v136
  v_fma_f32 v143, v143, s6, v136
  v_mul_f32 v140, v140, v68
  v_mul_f32 v141, v141, v69
  v_mul_f32 v142, v142, v70
  v_mul_f32 v143, v143, v71
  v_exp_f32 v140, v140
  v_exp_f32 v141, v141
  v_exp_f32 v142, v142
  v_exp_f32 v143, v143
  v_mul_f32 v68, v68, v84
  v_mul_f32 v69, v69, v85
  v_mul_f32 v70, v70, v86
  v_mul_f32 v71, v71, v87
  v_add_f32 v140, 1.0, v140
  v_add_f32 v141, 1.0, v141
  v_add_f32 v142, 1.0, v142
  v_add_f32 v143, 1.0, v143
  v_rcp_f32 v140, v140
  v_rcp_f32 v141, v141
  v_rcp_f32 v142, v142
  v_rcp_f32 v143, v143
  s_nop 0
  v_mul_f32 v68, v68, v140
  v_mul_f32 v69, v69, v141
  v_mul_f32 v70, v70, v142
  v_mul_f32 v71, v71, v143
  v_mul_f32 v140, v72, v72
  v_mul_f32 v141, v73, v73
  v_mul_f32 v142, v74, v74
  v_mul_f32 v143, v75, v75
  v_fma_f32 v140, v140, s6, v136
  v_fma_f32 v141, v141, s6, v136
  v_fma_f32 v142, v142, s6, v136
  v_fma_f32 v143, v143, s6, v136
  v_mul_f32 v140, v140, v72
  v_mul_f32 v141, v141, v73
  v_mul_f32 v142, v142, v74
  v_mul_f32 v143, v143, v75
  v_exp_f32 v140, v140
  v_exp_f32 v141, v141
  v_exp_f32 v142, v142
  v_exp_f32 v143, v143
  v_mul_f32 v72, v72, v88
  v_mul_f32 v73, v73, v89
  v_mul_f32 v74, v74, v90
  v_mul_f32 v75, v75, v91
  v_add_f32 v140, 1.0, v140
  v_add_f32 v141, 1.0, v141
  v_add_f32 v142, 1.0, v142
  v_add_f32 v143, 1.0, v143
  v_rcp_f32 v140, v140
  v_rcp_f32 v141, v141
  v_rcp_f32 v142, v142
  v_rcp_f32 v143, v143
  s_nop 0
  v_mul_f32 v72, v72, v140
  v_mul_f32 v73, v73, v141
  v_mul_f32 v74, v74, v142
  v_mul_f32 v75, v75, v143
  v_mul_f32 v140, v76, v76
  v_mul_f32 v141, v77, v77
  v_mul_f32 v142, v78, v78
  v_mul_f32 v143, v79, v79
  v_fma_f32 v140, v140, s6, v136
  v_fma_f32 v141, v141, s6, v136
  v_fma_f32 v142, v142, s6, v136
  v_fma_f32 v143, v143, s6, v136
  v_mul_f32 v140, v140, v76
  v_mul_f32 v141, v141, v77
  v_mul_f32 v142, v142, v78
  v_mul_f32 v143, v143, v79
  v_exp_f32 v140, v140
  v_exp_f32 v141, v141
  v_exp_f32 v142, v142
  v_exp_f32 v143, v143
  v_mul_f32 v76, v76, v92
  v_mul_f32 v77, v77, v93
  v_mul_f32 v78, v78, v94
  v_mul_f32 v79, v79, v95
  v_add_f32 v140, 1.0, v140
  v_add_f32 v141, 1.0, v141
  v_add_f32 v142, 1.0, v142
  v_add_f32 v143, 1.0, v143
  v_rcp_f32 v140, v140
  v_rcp_f32 v141, v141
  v_rcp_f32 v142, v142
  v_rcp_f32 v143, v143
  s_nop 0
  v_mul_f32 v76, v76, v140
  v_mul_f32 v77, v77, v141
  v_mul_f32 v78, v78, v142
  v_mul_f32 v79, v79, v143
  v_cvt_pk_bf16_f32 v128, v64, v65
  v_cvt_pk_bf16_f32 v129, v66, v67
  v_cvt_pk_bf16_f32 v130, v72, v73
  v_cvt_pk_bf16_f32 v131, v74, v75
  buffer_store_dwordx4 v[128:131], v10, s[48:51], s74 offen offset:0 sc1
  v_cvt_pk_bf16_f32 v132, v68, v69
  v_cvt_pk_bf16_f32 v133, v70, v71
  v_cvt_pk_bf16_f32 v134, v76, v77
  v_cvt_pk_bf16_f32 v135, v78, v79
  buffer_store_dwordx4 v[132:135], v10, s[48:51], s74 offen offset:512 sc1
  s_barrier
  s_cmp_eq_u32 s77, -1
  s_cbranch_scc1 L_ns_26
  s_cmp_lg_u32 s79, 0
  s_cbranch_scc1 L_iwskip_27
  s_cmp_lg_u32 s3, 0
  s_cbranch_scc1 L_iwd_29
  v_mov_b32 v28, 0
L_iw_28:
  global_load_dword v29, v28, s[42:43] offset:16 sc1
  s_waitcnt vmcnt(0)
  v_readfirstlane_b32 s4, v29
  s_nop 1
  s_cmp_ge_u32 s4, 32
  s_cbranch_scc1 L_iwd_29
  s_sleep 4
  s_add_u32 s47, s47, 1
  s_cmp_gt_u32 s47, 131072
  s_cbranch_scc1 L_exit
  s_branch L_iw_28
L_iwd_29:
  s_mov_b32 s79, 1
L_iwskip_27:
  s_lshl_b32 s78, s77, 7
  s_add_u32 s78, s78, s83
  s_cmp_lg_u32 s3, 0
  s_cbranch_scc1 L_sig_30
  s_mov_b64 s[8:9], exec
  s_mov_b64 exec, 1
  v_mov_b32 v28, 0
  v_mov_b32 v29, 1
  buffer_atomic_add v29, v28, s[48:51], s78 offen
  s_mov_b64 exec, s[8:9]
L_sig_30:
L_ns_26:
  s_mov_b32 s77, s68
  s_mov_b32 s68, s10
  s_mov_b32 s70, s11
  s_cmp_lt_u32 s68, s69
  s_cbranch_scc1 L_w1loop_23
  s_waitcnt vmcnt(0)
  s_barrier
  s_lshl_b32 s78, s77, 7
  s_add_u32 s78, s78, s83
  s_cmp_lg_u32 s3, 0
  s_cbranch_scc1 L_iwd_32
  v_mov_b32 v28, 0
L_iw_31:
  global_load_dword v29, v28, s[42:43] offset:16 sc1
  s_waitcnt vmcnt(0)
  v_readfirstlane_b32 s4, v29
  s_nop 1
  s_cmp_ge_u32 s4, 32
  s_cbranch_scc1 L_iwd_32
  s_sleep 4
  s_add_u32 s47, s47, 1
  s_cmp_gt_u32 s47, 131072
  s_cbranch_scc1 L_exit
  s_branch L_iw_31
L_iwd_32:
  s_cmp_lg_u32 s3, 0
  s_cbranch_scc1 L_sig_33
  s_mov_b64 s[8:9], exec
  s_mov_b64 exec, 1
  v_mov_b32 v28, 0
  v_mov_b32 v29, 1
  buffer_atomic_add v29, v28, s[48:51], s78 offen
  s_mov_b64 exec, s[8:9]
L_sig_33:
  s_waitcnt vmcnt(0)
L_w1_next:
  s_barrier
  s_cmp_eq_u32 s86, -1
  s_cbranch_scc1 L_w1_done
  s_mov_b32 s85, s86
  s_mov_b32 s68, s87
  s_mov_b32 s69, s88
  s_mov_b32 s75, 4
  s_mov_b32 s86, -1
  s_branch L_w1_disp
L_w1_done:
  s_cmp_ge_u32 s14, 216
  s_cbranch_scc1 L_gate
  s_mul_hi_u32 s68, s14, 0x15555556
  s_mul_i32 s4, s68, 12
  s_sub_u32 s69, s14, s4
  v_lshlrev_b32 v2, 4, v0
  v_lshrrev_b32 v12, 3, v0
  v_and_b32 v13, 7, v0
  v_bfe_u32 v14, v0, 4, 2
  v_lshlrev_b32 v14, 1, v14
  v_xor_b32 v13, v13, v14
  v_lshlrev_b32 v13, 4, v13
  s_movk_i32 s4, 1152
  v_mul_lo_u32 v12, v12, s4
  v_add_u32 v6, v12, v13
  v_lshrrev_b32 v12, 2, v0
  v_bfe_u32 v13, v12, 1, 2
  v_lshlrev_b32 v13, 1, v13
  v_lshlrev_b32 v12, 7, v12
  v_and_b32 v14, 1, v0
  v_lshlrev_b32 v14, 3, v14
  v_add_u32 v12, v12, v14
  s_mul_i32 s4, s3, 40960
  v_add_u32 v12, s4, v12
  v_bfe_u32 v14, v0, 1, 1
  v_add_u32 v15, 0, v14
  v_xor_b32 v15, v15, v13
  v_lshlrev_b32 v15, 4, v15
  v_add_u32 v3, v12, v15
  v_add_u32 v15, 2, v14
  v_xor_b32 v15, v15, v13
  v_lshlrev_b32 v15, 4, v15
  v_add_u32 v4, v12, v15
  v_add_u32 v15, 4, v14
  v_xor_b32 v15, v15, v13
  v_lshlrev_b32 v15, 4, v15
  v_add_u32 v5, v12, v15
  s_mul_i32 s13, s69, 96
  s_add_u32 s56, s36, s13
  s_addc_u32 s57, s37, 0
  s_mov_b32 s58, 5308416
  s_mov_b32 s59, 0x20000
  s_sub_u32 s58, s58, s13
  s_mul_i32 s12, s3, 1327104
  s_mul_i32 s11, s3, 40960
  s_add_u32 m0, s11, 0
  s_add_u32 s4, s12, 0
  buffer_load_dwordx4 v6, s[56:59], s4 offen lds
  s_add_u32 m0, s11, 1024
  s_add_u32 s4, s12, 9216
  buffer_load_dwordx4 v6, s[56:59], s4 offen lds
  s_add_u32 m0, s11, 2048
  s_add_u32 s4, s12, 18432
  buffer_load_dwordx4 v6, s[56:59], s4 offen lds
  s_add_u32 m0, s11, 3072
  s_add_u32 s4, s12, 27648
  buffer_load_dwordx4 v6, s[56:59], s4 offen lds
  s_add_u32 m0, s11, 4096
  s_add_u32 s4, s12, 36864
  buffer_load_dwordx4 v6, s[56:59], s4 offen lds
  s_add_u32 m0, s11, 5120
  s_add_u32 s4, s12, 46080
  buffer_load_dwordx4 v6, s[56:59], s4 offen lds
  s_add_u32 m0, s11, 6144
  s_add_u32 s4, s12, 55296
  buffer_load_dwordx4 v6, s[56:59], s4 offen lds
  s_add_u32 m0, s11, 7168
  s_add_u32 s4, s12, 64512
  buffer_load_dwordx4 v6, s[56:59], s4 offen lds
  s_add_u32 m0, s11, 8192
  s_add_u32 s4, s12, 73728
  buffer_load_dwordx4 v6, s[56:59], s4 offen lds
  s_add_u32 m0, s11, 9216
  s_add_u32 s4, s12, 82944
  buffer_load_dwordx4 v6, s[56:59], s4 offen lds
  s_add_u32 m0, s11, 10240
  s_add_u32 s4, s12, 92160
  buffer_load_dwordx4 v6, s[56:59], s4 offen lds
  s_add_u32 m0, s11, 11264
  s_add_u32 s4, s12, 101376
  buffer_load_dwordx4 v6, s[56:59], s4 offen lds
  s_add_u32 m0, s11, 12288
  s_add_u32 s4, s12, 110592
  buffer_load_dwordx4 v6, s[56:59], s4 offen lds
  s_add_u32 m0, s11, 13312
  s_add_u32 s4, s12, 119808
  buffer_load_dwordx4 v6, s[56:59], s4 offen lds
  s_add_u32 m0, s11, 14336
  s_add_u32 s4, s12, 129024
  buffer_load_dwordx4 v6, s[56:59], s4 offen lds
  s_add_u32 m0, s11, 15360
  s_add_u32 s4, s12, 138240
  buffer_load_dwordx4 v6, s[56:59], s4 offen lds
  s_add_u32 m0, s11, 16384
  s_add_u32 s4, s12, 147456
  buffer_load_dwordx4 v6, s[56:59], s4 offen lds
  s_add_u32 m0, s11, 17408
  s_add_u32 s4, s12, 156672
  buffer_load_dwordx4 v6, s[56:59], s4 offen lds
  s_add_u32 m0, s11, 18432
  s_add_u32 s4, s12, 165888
  buffer_load_dwordx4 v6, s[56:59], s4 offen lds
  s_add_u32 m0, s11, 19456
  s_add_u32 s4, s12, 175104
  buffer_load_dwordx4 v6, s[56:59], s4 offen lds
  s_add_u32 m0, s11, 20480
  s_add_u32 s4, s12, 184320
  buffer_load_dwordx4 v6, s[56:59], s4 offen lds
  s_add_u32 m0, s11, 21504
  s_add_u32 s4, s12, 193536
  buffer_load_dwordx4 v6, s[56:59], s4 offen lds
  s_add_u32 m0, s11, 22528
  s_add_u32 s4, s12, 202752
  buffer_load_dwordx4 v6, s[56:59], s4 offen lds
  s_add_u32 m0, s11, 23552
  s_add_u32 s4, s12, 211968
  buffer_load_dwordx4 v6, s[56:59], s4 offen lds
  s_add_u32 m0, s11, 24576
  s_add_u32 s4, s12, 221184
  buffer_load_dwordx4 v6, s[56:59], s4 offen lds
  s_add_u32 m0, s11, 25600
  s_add_u32 s4, s12, 230400
  buffer_load_dwordx4 v6, s[56:59], s4 offen lds
  s_add_u32 m0, s11, 26624
  s_add_u32 s4, s12, 239616
  buffer_load_dwordx4 v6, s[56:59], s4 offen lds
  s_add_u32 m0, s11, 27648
  s_add_u32 s4, s12, 248832
  buffer_load_dwordx4 v6, s[56:59], s4 offen lds
  s_add_u32 m0, s11, 28672
  s_add_u32 s4, s12, 258048
  buffer_load_dwordx4 v6, s[56:59], s4 offen lds
  s_add_u32 m0, s11, 29696
  s_add_u32 s4, s12, 267264
  buffer_load_dwordx4 v6, s[56:59], s4 offen lds
  s_add_u32 m0, s11, 30720
  s_add_u32 s4, s12, 276480
  buffer_load_dwordx4 v6, s[56:59], s4 offen lds
  s_add_u32 m0, s11, 31744
  s_add_u32 s4, s12, 285696
  buffer_load_dwordx4 v6, s[56:59], s4 offen lds
  s_add_u32 m0, s11, 32768
  s_add_u32 s4, s12, 294912
  buffer_load_dwordx4 v6, s[56:59], s4 offen lds
  s_add_u32 m0, s11, 33792
  s_add_u32 s4, s12, 304128
  buffer_load_dwordx4 v6, s[56:59], s4 offen lds
  s_add_u32 m0, s11, 34816
  s_add_u32 s4, s12, 313344
  buffer_load_dwordx4 v6, s[56:59], s4 offen lds
  s_add_u32 m0, s11, 35840
  s_add_u32 s4, s12, 322560
  buffer_load_dwordx4 v6, s[56:59], s4 offen lds
  s_add_u32 m0, s11, 36864
  s_add_u32 s4, s12, 331776
  buffer_load_dwordx4 v6, s[56:59], s4 offen lds
  s_add_u32 m0, s11, 37888
  s_add_u32 s4, s12, 340992
  buffer_load_dwordx4 v6, s[56:59], s4 offen lds
  s_add_u32 m0, s11, 38912
  s_add_u32 s4, s12, 350208
  buffer_load_dwordx4 v6, s[56:59], s4 offen lds
  s_add_u32 m0, s11, 39936
  s_add_u32 s4, s12, 359424
  buffer_load_dwordx4 v6, s[56:59], s4 offen lds
  s_waitcnt vmcnt(32)
  ds_read_b64_tr_b16 a[0:1], v3 offset:0
  ds_read_b64_tr_b16 a[2:3], v3 offset:2048
  ds_read_b64_tr_b16 a[4:5], v4 offset:0
  ds_read_b64_tr_b16 a[6:7], v4 offset:2048
  ds_read_b64_tr_b16 a[8:9], v5 offset:0
  ds_read_b64_tr_b16 a[10:11], v5 offset:2048
  ds_read_b64_tr_b16 a[12:13], v3 offset:4096
  ds_read_b64_tr_b16 a[14:15], v3 offset:6144
  ds_read_b64_tr_b16 a[16:17], v4 offset:4096
  ds_read_b64_tr_b16 a[18:19], v4 offset:6144
  ds_read_b64_tr_b16 a[20:21], v5 offset:4096
  ds_read_b64_tr_b16 a[22:23], v5 offset:6144
  s_waitcnt lgkmcnt(0)
  s_add_u32 m0, s11, 0
  s_add_u32 s4, s12, 368640
  buffer_load_dwordx4 v6, s[56:59], s4 offen lds
  s_add_u32 m0, s11, 1024
  s_add_u32 s4, s12, 377856
  buffer_load_dwordx4 v6, s[56:59], s4 offen lds
  s_add_u32 m0, s11, 2048
  s_add_u32 s4, s12, 387072
  buffer_load_dwordx4 v6, s[56:59], s4 offen lds
  s_add_u32 m0, s11, 3072
  s_add_u32 s4, s12, 396288
  buffer_load_dwordx4 v6, s[56:59], s4 offen lds
  s_add_u32 m0, s11, 4096
  s_add_u32 s4, s12, 405504
  buffer_load_dwordx4 v6, s[56:59], s4 offen lds
  s_add_u32 m0, s11, 5120
  s_add_u32 s4, s12, 414720
  buffer_load_dwordx4 v6, s[56:59], s4 offen lds
  s_add_u32 m0, s11, 6144
  s_add_u32 s4, s12, 423936
  buffer_load_dwordx4 v6, s[56:59], s4 offen lds
  s_add_u32 m0, s11, 7168
  s_add_u32 s4, s12, 433152
  buffer_load_dwordx4 v6, s[56:59], s4 offen lds
  s_waitcnt vmcnt(32)
  ds_read_b64_tr_b16 a[24:25], v3 offset:8192
  ds_read_b64_tr_b16 a[26:27], v3 offset:10240
  ds_read_b64_tr_b16 a[28:29], v4 offset:8192
  ds_read_b64_tr_b16 a[30:31], v4 offset:10240
  ds_read_b64_tr_b16 a[32:33], v5 offset:8192
  ds_read_b64_tr_b16 a[34:35], v5 offset:10240
  ds_read_b64_tr_b16 a[36:37], v3 offset:12288
  ds_read_b64_tr_b16 a[38:39], v3 offset:14336
  ds_read_b64_tr_b16 a[40:41], v4 offset:12288
  ds_read_b64_tr_b16 a[42:43], v4 offset:14336
  ds_read_b64_tr_b16 a[44:45], v5 offset:12288
  ds_read_b64_tr_b16 a[46:47], v5 offset:14336
  s_waitcnt lgkmcnt(0)
  s_add_u32 m0, s11, 8192
  s_add_u32 s4, s12, 442368
  buffer_load_dwordx4 v6, s[56:59], s4 offen lds
  s_add_u32 m0, s11, 9216
  s_add_u32 s4, s12, 451584
  buffer_load_dwordx4 v6, s[56:59], s4 offen lds
  s_add_u32 m0, s11, 10240
  s_add_u32 s4, s12, 460800
  buffer_load_dwordx4 v6, s[56:59], s4 offen lds
  s_add_u32 m0, s11, 11264
  s_add_u32 s4, s12, 470016
  buffer_load_dwordx4 v6, s[56:59], s4 offen lds
  s_add_u32 m0, s11, 12288
  s_add_u32 s4, s12, 479232
  buffer_load_dwordx4 v6, s[56:59], s4 offen lds
  s_add_u32 m0, s11, 13312
  s_add_u32 s4, s12, 488448
  buffer_load_dwordx4 v6, s[56:59], s4 offen lds
  s_add_u32 m0, s11, 14336
  s_add_u32 s4, s12, 497664
  buffer_load_dwordx4 v6, s[56:59], s4 offen lds
  s_add_u32 m0, s11, 15360
  s_add_u32 s4, s12, 506880
  buffer_load_dwordx4 v6, s[56:59], s4 offen lds
  s_waitcnt vmcnt(32)
  ds_read_b64_tr_b16 a[48:49], v3 offset:16384
  ds_read_b64_tr_b16 a[50:51], v3 offset:18432
  ds_read_b64_tr_b16 a[52:53], v4 offset:16384
  ds_read_b64_tr_b16 a[54:55], v4 offset:18432
  ds_read_b64_tr_b16 a[56:57], v5 offset:16384
  ds_read_b64_tr_b16 a[58:59], v5 offset:18432
  ds_read_b64_tr_b16 a[60:61], v3 offset:20480
  ds_read_b64_tr_b16 a[62:63], v3 offset:22528
  ds_read_b64_tr_b16 a[64:65], v4 offset:20480
  ds_read_b64_tr_b16 a[66:67], v4 offset:22528
  ds_read_b64_tr_b16 a[68:69], v5 offset:20480
  ds_read_b64_tr_b16 a[70:71], v5 offset:22528
  s_waitcnt lgkmcnt(0)
  s_add_u32 m0, s11, 16384
  s_add_u32 s4, s12, 516096
  buffer_load_dwordx4 v6, s[56:59], s4 offen lds
  s_add_u32 m0, s11, 17408
  s_add_u32 s4, s12, 525312
  buffer_load_dwordx4 v6, s[56:59], s4 offen lds
  s_add_u32 m0, s11, 18432
  s_add_u32 s4, s12, 534528
  buffer_load_dwordx4 v6, s[56:59], s4 offen lds
  s_add_u32 m0, s11, 19456
  s_add_u32 s4, s12, 543744
  buffer_load_dwordx4 v6, s[56:59], s4 offen lds
  s_add_u32 m0, s11, 20480
  s_add_u32 s4, s12, 552960
  buffer_load_dwordx4 v6, s[56:59], s4 offen lds
  s_add_u32 m0, s11, 21504
  s_add_u32 s4, s12, 562176
  buffer_load_dwordx4 v6, s[56:59], s4 offen lds
  s_add_u32 m0, s11, 22528
  s_add_u32 s4, s12, 571392
  buffer_load_dwordx4 v6, s[56:59], s4 offen lds
  s_add_u32 m0, s11, 23552
  s_add_u32 s4, s12, 580608
  buffer_load_dwordx4 v6, s[56:59], s4 offen lds
  s_waitcnt vmcnt(32)
  ds_read_b64_tr_b16 a[72:73], v3 offset:24576
  ds_read_b64_tr_b16 a[74:75], v3 offset:26624
  ds_read_b64_tr_b16 a[76:77], v4 offset:24576
  ds_read_b64_tr_b16 a[78:79], v4 offset:26624
  ds_read_b64_tr_b16 a[80:81], v5 offset:24576
  ds_read_b64_tr_b16 a[82:83], v5 offset:26624
  ds_read_b64_tr_b16 a[84:85], v3 offset:28672
  ds_read_b64_tr_b16 a[86:87], v3 offset:30720
  ds_read_b64_tr_b16 a[88:89], v4 offset:28672
  ds_read_b64_tr_b16 a[90:91], v4 offset:30720
  ds_read_b64_tr_b16 a[92:93], v5 offset:28672
  ds_read_b64_tr_b16 a[94:95], v5 offset:30720
  s_waitcnt lgkmcnt(0)
  s_add_u32 m0, s11, 24576
  s_add_u32 s4, s12, 589824
  buffer_load_dwordx4 v6, s[56:59], s4 offen lds
  s_add_u32 m0, s11, 25600
  s_add_u32 s4, s12, 599040
  buffer_load_dwordx4 v6, s[56:59], s4 offen lds
  s_add_u32 m0, s11, 26624
  s_add_u32 s4, s12, 608256
  buffer_load_dwordx4 v6, s[56:59], s4 offen lds
  s_add_u32 m0, s11, 27648
  s_add_u32 s4, s12, 617472
  buffer_load_dwordx4 v6, s[56:59], s4 offen lds
  s_add_u32 m0, s11, 28672
  s_add_u32 s4, s12, 626688
  buffer_load_dwordx4 v6, s[56:59], s4 offen lds
  s_add_u32 m0, s11, 29696
  s_add_u32 s4, s12, 635904
  buffer_load_dwordx4 v6, s[56:59], s4 offen lds
  s_add_u32 m0, s11, 30720
  s_add_u32 s4, s12, 645120
  buffer_load_dwordx4 v6, s[56:59], s4 offen lds
  s_add_u32 m0, s11, 31744
  s_add_u32 s4, s12, 654336
  buffer_load_dwordx4 v6, s[56:59], s4 offen lds
  s_waitcnt vmcnt(32)
  ds_read_b64_tr_b16 a[96:97], v3 offset:32768
  ds_read_b64_tr_b16 a[98:99], v3 offset:34816
  ds_read_b64_tr_b16 a[100:101], v4 offset:32768
  ds_read_b64_tr_b16 a[102:103], v4 offset:34816
  ds_read_b64_tr_b16 a[104:105], v5 offset:32768
  ds_read_b64_tr_b16 a[106:107], v5 offset:34816
  ds_read_b64_tr_b16 a[108:109], v3 offset:36864
  ds_read_b64_tr_b16 a[110:111], v3 offset:38912
  ds_read_b64_tr_b16 a[112:113], v4 offset:36864
  ds_read_b64_tr_b16 a[114:115], v4 offset:38912
  ds_read_b64_tr_b16 a[116:117], v5 offset:36864
  ds_read_b64_tr_b16 a[118:119], v5 offset:38912
  s_waitcnt lgkmcnt(0)
  s_add_u32 m0, s11, 32768
  s_add_u32 s4, s12, 663552
  buffer_load_dwordx4 v6, s[56:59], s4 offen lds
  s_add_u32 m0, s11, 33792
  s_add_u32 s4, s12, 672768
  buffer_load_dwordx4 v6, s[56:59], s4 offen lds
  s_add_u32 m0, s11, 34816
  s_add_u32 s4, s12, 681984
  buffer_load_dwordx4 v6, s[56:59], s4 offen lds
  s_add_u32 m0, s11, 35840
  s_add_u32 s4, s12, 691200
  buffer_load_dwordx4 v6, s[56:59], s4 offen lds
  s_add_u32 m0, s11, 36864
  s_add_u32 s4, s12, 700416
  buffer_load_dwordx4 v6, s[56:59], s4 offen lds
  s_add_u32 m0, s11, 37888
  s_add_u32 s4, s12, 709632
  buffer_load_dwordx4 v6, s[56:59], s4 offen lds
  s_add_u32 m0, s11, 38912
  s_add_u32 s4, s12, 718848
  buffer_load_dwordx4 v6, s[56:59], s4 offen lds
  s_add_u32 m0, s11, 39936
  s_add_u32 s4, s12, 728064
  buffer_load_dwordx4 v6, s[56:59], s4 offen lds
  s_waitcnt vmcnt(32)
  ds_read_b64_tr_b16 a[120:121], v3 offset:0
  ds_read_b64_tr_b16 a[122:123], v3 offset:2048
  ds_read_b64_tr_b16 a[124:125], v4 offset:0
  ds_read_b64_tr_b16 a[126:127], v4 offset:2048
  ds_read_b64_tr_b16 a[128:129], v5 offset:0
  ds_read_b64_tr_b16 a[130:131], v5 offset:2048
  ds_read_b64_tr_b16 a[132:133], v3 offset:4096
  ds_read_b64_tr_b16 a[134:135], v3 offset:6144
  ds_read_b64_tr_b16 a[136:137], v4 offset:4096
  ds_read_b64_tr_b16 a[138:139], v4 offset:6144
  ds_read_b64_tr_b16 a[140:141], v5 offset:4096
  ds_read_b64_tr_b16 a[142:143], v5 offset:6144
  s_waitcnt lgkmcnt(0)
  s_add_u32 m0, s11, 0
  s_add_u32 s4, s12, 737280
  buffer_load_dwordx4 v6, s[56:59], s4 offen lds
  s_add_u32 m0, s11, 1024
  s_add_u32 s4, s12, 746496
  buffer_load_dwordx4 v6, s[56:59], s4 offen lds
  s_add_u32 m0, s11, 2048
  s_add_u32 s4, s12, 755712
  buffer_load_dwordx4 v6, s[56:59], s4 offen lds
  s_add_u32 m0, s11, 3072
  s_add_u32 s4, s12, 764928
  buffer_load_dwordx4 v6, s[56:59], s4 offen lds
  s_add_u32 m0, s11, 4096
  s_add_u32 s4, s12, 774144
  buffer_load_dwordx4 v6, s[56:59], s4 offen lds
  s_add_u32 m0, s11, 5120
  s_add_u32 s4, s12, 783360
  buffer_load_dwordx4 v6, s[56:59], s4 offen lds
  s_add_u32 m0, s11, 6144
  s_add_u32 s4, s12, 792576
  buffer_load_dwordx4 v6, s[56:59], s4 offen lds
  s_add_u32 m0, s11, 7168
  s_add_u32 s4, s12, 801792
  buffer_load_dwordx4 v6, s[56:59], s4 offen lds
  s_waitcnt vmcnt(32)
  ds_read_b64_tr_b16 a[144:145], v3 offset:8192
  ds_read_b64_tr_b16 a[146:147], v3 offset:10240
  ds_read_b64_tr_b16 a[148:149], v4 offset:8192
  ds_read_b64_tr_b16 a[150:151], v4 offset:10240
  ds_read_b64_tr_b16 a[152:153], v5 offset:8192
  ds_read_b64_tr_b16 a[154:155], v5 offset:10240
  ds_read_b64_tr_b16 a[156:157], v3 offset:12288
  ds_read_b64_tr_b16 a[158:159], v3 offset:14336
  ds_read_b64_tr_b16 a[160:161], v4 offset:12288
  ds_read_b64_tr_b16 a[162:163], v4 offset:14336
  ds_read_b64_tr_b16 a[164:165], v5 offset:12288
  ds_read_b64_tr_b16 a[166:167], v5 offset:14336
  s_waitcnt lgkmcnt(0)
  s_add_u32 m0, s11, 8192
  s_add_u32 s4, s12, 811008
  buffer_load_dwordx4 v6, s[56:59], s4 offen lds
  s_add_u32 m0, s11, 9216
  s_add_u32 s4, s12, 820224
  buffer_load_dwordx4 v6, s[56:59], s4 offen lds
  s_add_u32 m0, s11, 10240
  s_add_u32 s4, s12, 829440
  buffer_load_dwordx4 v6, s[56:59], s4 offen lds
  s_add_u32 m0, s11, 11264
  s_add_u32 s4, s12, 838656
  buffer_load_dwordx4 v6, s[56:59], s4 offen lds
  s_add_u32 m0, s11, 12288
  s_add_u32 s4, s12, 847872
  buffer_load_dwordx4 v6, s[56:59], s4 offen lds
  s_add_u32 m0, s11, 13312
  s_add_u32 s4, s12, 857088
  buffer_load_dwordx4 v6, s[56:59], s4 offen lds
  s_add_u32 m0, s11, 14336
  s_add_u32 s4, s12, 866304
  buffer_load_dwordx4 v6, s[56:59], s4 offen lds
  s_add_u32 m0, s11, 15360
  s_add_u32 s4, s12, 875520
  buffer_load_dwordx4 v6, s[56:59], s4 offen lds
  s_waitcnt vmcnt(32)
  ds_read_b64_tr_b16 a[168:169], v3 offset:16384
  ds_read_b64_tr_b16 a[170:171], v3 offset:18432
  ds_read_b64_tr_b16 a[172:173], v4 offset:16384
  ds_read_b64_tr_b16 a[174:175], v4 offset:18432
  ds_read_b64_tr_b16 a[176:177], v5 offset:16384
  ds_read_b64_tr_b16 a[178:179], v5 offset:18432
  ds_read_b64_tr_b16 a[180:181], v3 offset:20480
  ds_read_b64_tr_b16 a[182:183], v3 offset:22528
  ds_read_b64_tr_b16 a[184:185], v4 offset:20480
  ds_read_b64_tr_b16 a[186:187], v4 offset:22528
  ds_read_b64_tr_b16 a[188:189], v5 offset:20480
  ds_read_b64_tr_b16 a[190:191], v5 offset:22528
  s_waitcnt lgkmcnt(0)
  s_add_u32 m0, s11, 16384
  s_add_u32 s4, s12, 884736
  buffer_load_dwordx4 v6, s[56:59], s4 offen lds
  s_add_u32 m0, s11, 17408
  s_add_u32 s4, s12, 893952
  buffer_load_dwordx4 v6, s[56:59], s4 offen lds
  s_add_u32 m0, s11, 18432
  s_add_u32 s4, s12, 903168
  buffer_load_dwordx4 v6, s[56:59], s4 offen lds
  s_add_u32 m0, s11, 19456
  s_add_u32 s4, s12, 912384
  buffer_load_dwordx4 v6, s[56:59], s4 offen lds
  s_add_u32 m0, s11, 20480
  s_add_u32 s4, s12, 921600
  buffer_load_dwordx4 v6, s[56:59], s4 offen lds
  s_add_u32 m0, s11, 21504
  s_add_u32 s4, s12, 930816
  buffer_load_dwordx4 v6, s[56:59], s4 offen lds
  s_add_u32 m0, s11, 22528
  s_add_u32 s4, s12, 940032
  buffer_load_dwordx4 v6, s[56:59], s4 offen lds
  s_add_u32 m0, s11, 23552
  s_add_u32 s4, s12, 949248
  buffer_load_dwordx4 v6, s[56:59], s4 offen lds
  s_waitcnt vmcnt(32)
  ds_read_b64_tr_b16 a[192:193], v3 offset:24576
  ds_read_b64_tr_b16 a[194:195], v3 offset:26624
  ds_read_b64_tr_b16 a[196:197], v4 offset:24576
  ds_read_b64_tr_b16 a[198:199], v4 offset:26624
  ds_read_b64_tr_b16 a[200:201], v5 offset:24576
  ds_read_b64_tr_b16 a[202:203], v5 offset:26624
  ds_read_b64_tr_b16 a[204:205], v3 offset:28672
  ds_read_b64_tr_b16 a[206:207], v3 offset:30720
  ds_read_b64_tr_b16 a[208:209], v4 offset:28672
  ds_read_b64_tr_b16 a[210:211], v4 offset:30720
  ds_read_b64_tr_b16 a[212:213], v5 offset:28672
  ds_read_b64_tr_b16 a[214:215], v5 offset:30720
  s_waitcnt lgkmcnt(0)
  s_add_u32 m0, s11, 24576
  s_add_u32 s4, s12, 958464
  buffer_load_dwordx4 v6, s[56:59], s4 offen lds
  s_add_u32 m0, s11, 25600
  s_add_u32 s4, s12, 967680
  buffer_load_dwordx4 v6, s[56:59], s4 offen lds
  s_add_u32 m0, s11, 26624
  s_add_u32 s4, s12, 976896
  buffer_load_dwordx4 v6, s[56:59], s4 offen lds
  s_add_u32 m0, s11, 27648
  s_add_u32 s4, s12, 986112
  buffer_load_dwordx4 v6, s[56:59], s4 offen lds
  s_add_u32 m0, s11, 28672
  s_add_u32 s4, s12, 995328
  buffer_load_dwordx4 v6, s[56:59], s4 offen lds
  s_add_u32 m0, s11, 29696
  s_add_u32 s4, s12, 1004544
  buffer_load_dwordx4 v6, s[56:59], s4 offen lds
  s_add_u32 m0, s11, 30720
  s_add_u32 s4, s12, 1013760
  buffer_load_dwordx4 v6, s[56:59], s4 offen lds
  s_add_u32 m0, s11, 31744
  s_add_u32 s4, s12, 1022976
  buffer_load_dwordx4 v6, s[56:59], s4 offen lds
  s_waitcnt vmcnt(32)
  ds_read_b64_tr_b16 a[216:217], v3 offset:32768
  ds_read_b64_tr_b16 a[218:219], v3 offset:34816
  ds_read_b64_tr_b16 a[220:221], v4 offset:32768
  ds_read_b64_tr_b16 a[222:223], v4 offset:34816
  ds_read_b64_tr_b16 a[224:225], v5 offset:32768
  ds_read_b64_tr_b16 a[226:227], v5 offset:34816
  ds_read_b64_tr_b16 a[228:229], v3 offset:36864
  ds_read_b64_tr_b16 a[230:231], v3 offset:38912
  ds_read_b64_tr_b16 a[232:233], v4 offset:36864
  ds_read_b64_tr_b16 a[234:235], v4 offset:38912
  ds_read_b64_tr_b16 a[236:237], v5 offset:36864
  ds_read_b64_tr_b16 a[238:239], v5 offset:38912
  s_waitcnt lgkmcnt(0)
  s_add_u32 m0, s11, 32768
  s_add_u32 s4, s12, 1032192
  buffer_load_dwordx4 v6, s[56:59], s4 offen lds
  s_add_u32 m0, s11, 33792
  s_add_u32 s4, s12, 1041408
  buffer_load_dwordx4 v6, s[56:59], s4 offen lds
  s_add_u32 m0, s11, 34816
  s_add_u32 s4, s12, 1050624
  buffer_load_dwordx4 v6, s[56:59], s4 offen lds
  s_add_u32 m0, s11, 35840
  s_add_u32 s4, s12, 1059840
  buffer_load_dwordx4 v6, s[56:59], s4 offen lds
  s_add_u32 m0, s11, 36864
  s_add_u32 s4, s12, 1069056
  buffer_load_dwordx4 v6, s[56:59], s4 offen lds
  s_add_u32 m0, s11, 37888
  s_add_u32 s4, s12, 1078272
  buffer_load_dwordx4 v6, s[56:59], s4 offen lds
  s_add_u32 m0, s11, 38912
  s_add_u32 s4, s12, 1087488
  buffer_load_dwordx4 v6, s[56:59], s4 offen lds
  s_add_u32 m0, s11, 39936
  s_add_u32 s4, s12, 1096704
  buffer_load_dwordx4 v6, s[56:59], s4 offen lds
  s_waitcnt vmcnt(32)
  ds_read_b64_tr_b16 a[240:241], v3 offset:0
  ds_read_b64_tr_b16 a[242:243], v3 offset:2048
  ds_read_b64_tr_b16 a[244:245], v4 offset:0
  ds_read_b64_tr_b16 a[246:247], v4 offset:2048
  ds_read_b64_tr_b16 a[248:249], v5 offset:0
  ds_read_b64_tr_b16 a[250:251], v5 offset:2048
  ds_read_b64_tr_b16 a[252:253], v3 offset:4096
  ds_read_b64_tr_b16 a[254:255], v3 offset:6144
  ds_read_b64_tr_b16 v[80:81], v4 offset:4096
  ds_read_b64_tr_b16 v[82:83], v4 offset:6144
  ds_read_b64_tr_b16 v[84:85], v5 offset:4096
  ds_read_b64_tr_b16 v[86:87], v5 offset:6144
  s_waitcnt lgkmcnt(0)
  s_add_u32 m0, s11, 0
  s_add_u32 s4, s12, 1105920
  buffer_load_dwordx4 v6, s[56:59], s4 offen lds
  s_add_u32 m0, s11, 1024
  s_add_u32 s4, s12, 1115136
  buffer_load_dwordx4 v6, s[56:59], s4 offen lds
  s_add_u32 m0, s11, 2048
  s_add_u32 s4, s12, 1124352
  buffer_load_dwordx4 v6, s[56:59], s4 offen lds
  s_add_u32 m0, s11, 3072
  s_add_u32 s4, s12, 1133568
  buffer_load_dwordx4 v6, s[56:59], s4 offen lds
  s_add_u32 m0, s11, 4096
  s_add_u32 s4, s12, 1142784
  buffer_load_dwordx4 v6, s[56:59], s4 offen lds
  s_add_u32 m0, s11, 5120
  s_add_u32 s4, s12, 1152000
  buffer_load_dwordx4 v6, s[56:59], s4 offen lds
  s_add_u32 m0, s11, 6144
  s_add_u32 s4, s12, 1161216
  buffer_load_dwordx4 v6, s[56:59], s4 offen lds
  s_add_u32 m0, s11, 7168
  s_add_u32 s4, s12, 1170432
  buffer_load_dwordx4 v6, s[56:59], s4 offen lds
  s_waitcnt vmcnt(32)
  ds_read_b64_tr_b16 v[88:89], v3 offset:8192
  ds_read_b64_tr_b16 v[90:91], v3 offset:10240
  ds_read_b64_tr_b16 v[92:93], v4 offset:8192
  ds_read_b64_tr_b16 v[94:95], v4 offset:10240
  ds_read_b64_tr_b16 v[96:97], v5 offset:8192
  ds_read_b64_tr_b16 v[98:99], v5 offset:10240
  ds_read_b64_tr_b16 v[100:101], v3 offset:12288
  ds_read_b64_tr_b16 v[102:103], v3 offset:14336
  ds_read_b64_tr_b16 v[104:105], v4 offset:12288
  ds_read_b64_tr_b16 v[106:107], v4 offset:14336
  ds_read_b64_tr_b16 v[108:109], v5 offset:12288
  ds_read_b64_tr_b16 v[110:111], v5 offset:14336
  s_waitcnt lgkmcnt(0)
  s_add_u32 m0, s11, 8192
  s_add_u32 s4, s12, 1179648
  buffer_load_dwordx4 v6, s[56:59], s4 offen lds
  s_add_u32 m0, s11, 9216
  s_add_u32 s4, s12, 1188864
  buffer_load_dwordx4 v6, s[56:59], s4 offen lds
  s_add_u32 m0, s11, 10240
  s_add_u32 s4, s12, 1198080
  buffer_load_dwordx4 v6, s[56:59], s4 offen lds
  s_add_u32 m0, s11, 11264
  s_add_u32 s4, s12, 1207296
  buffer_load_dwordx4 v6, s[56:59], s4 offen lds
  s_add_u32 m0, s11, 12288
  s_add_u32 s4, s12, 1216512
  buffer_load_dwordx4 v6, s[56:59], s4 offen lds
  s_add_u32 m0, s11, 13312
  s_add_u32 s4, s12, 1225728
  buffer_load_dwordx4 v6, s[56:59], s4 offen lds
  s_add_u32 m0, s11, 14336
  s_add_u32 s4, s12, 1234944
  buffer_load_dwordx4 v6, s[56:59], s4 offen lds
  s_add_u32 m0, s11, 15360
  s_add_u32 s4, s12, 1244160
  buffer_load_dwordx4 v6, s[56:59], s4 offen lds
  s_waitcnt vmcnt(32)
  ds_read_b64_tr_b16 v[112:113], v3 offset:16384
  ds_read_b64_tr_b16 v[114:115], v3 offset:18432
  ds_read_b64_tr_b16 v[116:117], v4 offset:16384
  ds_read_b64_tr_b16 v[118:119], v4 offset:18432
  ds_read_b64_tr_b16 v[120:121], v5 offset:16384
  ds_read_b64_tr_b16 v[122:123], v5 offset:18432
  ds_read_b64_tr_b16 v[124:125], v3 offset:20480
  ds_read_b64_tr_b16 v[126:127], v3 offset:22528
  ds_read_b64_tr_b16 v[128:129], v4 offset:20480
  ds_read_b64_tr_b16 v[130:131], v4 offset:22528
  ds_read_b64_tr_b16 v[132:133], v5 offset:20480
  ds_read_b64_tr_b16 v[134:135], v5 offset:22528
  s_waitcnt lgkmcnt(0)
  s_add_u32 m0, s11, 16384
  s_add_u32 s4, s12, 1253376
  buffer_load_dwordx4 v6, s[56:59], s4 offen lds
  s_add_u32 m0, s11, 17408
  s_add_u32 s4, s12, 1262592
  buffer_load_dwordx4 v6, s[56:59], s4 offen lds
  s_add_u32 m0, s11, 18432
  s_add_u32 s4, s12, 1271808
  buffer_load_dwordx4 v6, s[56:59], s4 offen lds
  s_add_u32 m0, s11, 19456
  s_add_u32 s4, s12, 1281024
  buffer_load_dwordx4 v6, s[56:59], s4 offen lds
  s_add_u32 m0, s11, 20480
  s_add_u32 s4, s12, 1290240
  buffer_load_dwordx4 v6, s[56:59], s4 offen lds
  s_add_u32 m0, s11, 21504
  s_add_u32 s4, s12, 1299456
  buffer_load_dwordx4 v6, s[56:59], s4 offen lds
  s_add_u32 m0, s11, 22528
  s_add_u32 s4, s12, 1308672
  buffer_load_dwordx4 v6, s[56:59], s4 offen lds
  s_add_u32 m0, s11, 23552
  s_add_u32 s4, s12, 1317888
  buffer_load_dwordx4 v6, s[56:59], s4 offen lds
  s_waitcnt vmcnt(32)
  ds_read_b64_tr_b16 v[136:137], v3 offset:24576
  ds_read_b64_tr_b16 v[138:139], v3 offset:26624
  ds_read_b64_tr_b16 v[140:141], v4 offset:24576
  ds_read_b64_tr_b16 v[142:143], v4 offset:26624
  ds_read_b64_tr_b16 v[144:145], v5 offset:24576
  ds_read_b64_tr_b16 v[146:147], v5 offset:26624
  ds_read_b64_tr_b16 v[148:149], v3 offset:28672
  ds_read_b64_tr_b16 v[150:151], v3 offset:30720
  ds_read_b64_tr_b16 v[152:153], v4 offset:28672
  ds_read_b64_tr_b16 v[154:155], v4 offset:30720
  ds_read_b64_tr_b16 v[156:157], v5 offset:28672
  ds_read_b64_tr_b16 v[158:159], v5 offset:30720
  s_waitcnt lgkmcnt(0)
  s_waitcnt vmcnt(24)
  ds_read_b64_tr_b16 v[160:161], v3 offset:32768
  ds_read_b64_tr_b16 v[162:163], v3 offset:34816
  ds_read_b64_tr_b16 v[164:165], v4 offset:32768
  ds_read_b64_tr_b16 v[166:167], v4 offset:34816
  ds_read_b64_tr_b16 v[168:169], v5 offset:32768
  ds_read_b64_tr_b16 v[170:171], v5 offset:34816
  ds_read_b64_tr_b16 v[172:173], v3 offset:36864
  ds_read_b64_tr_b16 v[174:175], v3 offset:38912
  ds_read_b64_tr_b16 v[176:177], v4 offset:36864
  ds_read_b64_tr_b16 v[178:179], v4 offset:38912
  ds_read_b64_tr_b16 v[180:181], v5 offset:36864
  ds_read_b64_tr_b16 v[182:183], v5 offset:38912
  s_waitcnt lgkmcnt(0)
  s_waitcnt vmcnt(16)
  ds_read_b64_tr_b16 v[184:185], v3 offset:0
  ds_read_b64_tr_b16 v[186:187], v3 offset:2048
  ds_read_b64_tr_b16 v[188:189], v4 offset:0
  ds_read_b64_tr_b16 v[190:191], v4 offset:2048
  ds_read_b64_tr_b16 v[192:193], v5 offset:0
  ds_read_b64_tr_b16 v[194:195], v5 offset:2048
  ds_read_b64_tr_b16 v[196:197], v3 offset:4096
  ds_read_b64_tr_b16 v[198:199], v3 offset:6144
  ds_read_b64_tr_b16 v[200:201], v4 offset:4096
  ds_read_b64_tr_b16 v[202:203], v4 offset:6144
  ds_read_b64_tr_b16 v[204:205], v5 offset:4096
  ds_read_b64_tr_b16 v[206:207], v5 offset:6144
  s_waitcnt lgkmcnt(0)
  s_waitcnt vmcnt(8)
  ds_read_b64_tr_b16 v[208:209], v3 offset:8192
  ds_read_b64_tr_b16 v[210:211], v3 offset:10240
  ds_read_b64_tr_b16 v[212:213], v4 offset:8192
  ds_read_b64_tr_b16 v[214:215], v4 offset:10240
  ds_read_b64_tr_b16 v[216:217], v5 offset:8192
  ds_read_b64_tr_b16 v[218:219], v5 offset:10240
  ds_read_b64_tr_b16 v[220:221], v3 offset:12288
  ds_read_b64_tr_b16 v[222:223], v3 offset:14336
  ds_read_b64_tr_b16 v[224:225], v4 offset:12288
  ds_read_b64_tr_b16 v[226:227], v4 offset:14336
  ds_read_b64_tr_b16 v[228:229], v5 offset:12288
  ds_read_b64_tr_b16 v[230:231], v5 offset:14336
  s_waitcnt lgkmcnt(0)
  s_waitcnt vmcnt(0)
  ds_read_b64_tr_b16 v[232:233], v3 offset:16384
  ds_read_b64_tr_b16 v[234:235], v3 offset:18432
  ds_read_b64_tr_b16 v[236:237], v4 offset:16384
  ds_read_b64_tr_b16 v[238:239], v4 offset:18432
  ds_read_b64_tr_b16 v[240:241], v5 offset:16384
  ds_read_b64_tr_b16 v[242:243], v5 offset:18432
  ds_read_b64_tr_b16 v[244:245], v3 offset:20480
  ds_read_b64_tr_b16 v[246:247], v3 offset:22528
  ds_read_b64_tr_b16 v[248:249], v4 offset:20480
  ds_read_b64_tr_b16 v[250:251], v4 offset:22528
  ds_read_b64_tr_b16 v[252:253], v5 offset:20480
  ds_read_b64_tr_b16 v[254:255], v5 offset:22528
  s_waitcnt lgkmcnt(0)
  s_add_u32 s77, s68, 5
  s_cmp_ge_u32 s77, 18
  s_cbranch_scc0 L_ffn2_g1
  s_sub_u32 s77, s77, 18
L_ffn2_g1:
  s_mov_b32 s76, 0
L_ffn2_loop:
  s_and_b32 s4, s76, 1
  s_cmp_lt_u32 s68, 13
  s_cselect_b32 s5, 0, 1
  s_xor_b32 s75, s4, s5
  s_lshr_b32 s4, s76, 1
  s_mul_i32 s4, s4, 18
  s_cmp_eq_u32 s75, 0
  s_cselect_b32 s5, s68, s77
  s_add_u32 s70, s4, s5
  s_cmp_ge_u32 s70, 64
  s_cbranch_scc1 L_ffn2_next
  s_lshr_b32 s5, s70, 1
  s_lshl_b32 s5, s5, 7
  s_add_u32 s73, s5, 8192
  s_cmp_lg_u32 s3, 0
  s_cbranch_scc1 L_wg_34
  v_mov_b32 v28, 0
L_wf_35:
  buffer_load_dword v29, v28, s[48:51], s73 offen sc1
  s_waitcnt vmcnt(0)
  v_readfirstlane_b32 s4, v29
  s_nop 1
  s_cmp_ge_u32 s4, 36
  s_cbranch_scc1 L_wfd_36
  s_sleep 3
  s_add_u32 s47, s47, 1
  s_cmp_gt_u32 s47, 131072
  s_cbranch_scc1 L_exit
  s_branch L_wf_35
L_wfd_36:
L_wg_34:
  s_barrier
  s_mul_i32 s71, s70, 294912
  s_mul_i32 s4, s3, 73728
  s_add_u32 s71, s71, s4
  s_lshl_b32 s4, s75, 10
  s_add_u32 s71, s71, s4
  s_add_u32 s71, s71, 84934656
  s_add_u32 s72, s71, 0
  buffer_load_dwordx4 v[36:39], v2, s[48:51], s72 offen offset:0 sc1
  buffer_load_dwordx4 v[40:43], v2, s[48:51], s72 offen offset:2048 sc1
  s_add_u32 s72, s71, 4096
  buffer_load_dwordx4 v[44:47], v2, s[48:51], s72 offen offset:0 sc1
  buffer_load_dwordx4 v[48:51], v2, s[48:51], s72 offen offset:2048 sc1
  s_add_u32 s72, s71, 8192
  buffer_load_dwordx4 v[52:55], v2, s[48:51], s72 offen offset:0 sc1
  buffer_load_dwordx4 v[56:59], v2, s[48:51], s72 offen offset:2048 sc1
  s_add_u32 s72, s71, 12288
  buffer_load_dwordx4 v[60:63], v2, s[48:51], s72 offen offset:0 sc1
  buffer_load_dwordx4 v[64:67], v2, s[48:51], s72 offen offset:2048 sc1
  s_add_u32 s72, s71, 16384
  buffer_load_dwordx4 v[68:71], v2, s[48:51], s72 offen offset:0 sc1
  buffer_load_dwordx4 v[72:75], v2, s[48:51], s72 offen offset:2048 sc1
  s_waitcnt vmcnt(9)
  v_mfma_f32_16x16x32_bf16 v[12:15], a[0:3], v[36:39], 0
  v_mfma_f32_16x16x32_bf16 v[16:19], a[4:7], v[36:39], 0
  v_mfma_f32_16x16x32_bf16 v[20:23], a[8:11], v[36:39], 0
  s_add_u32 s72, s71, 20480
  buffer_load_dwordx4 v[36:39], v2, s[48:51], s72 offen offset:0 sc1
  s_waitcnt vmcnt(9)
  v_mfma_f32_16x16x32_bf16 v[12:15], a[12:15], v[40:43], v[12:15]
  v_mfma_f32_16x16x32_bf16 v[16:19], a[16:19], v[40:43], v[16:19]
  v_mfma_f32_16x16x32_bf16 v[20:23], a[20:23], v[40:43], v[20:23]
  buffer_load_dwordx4 v[40:43], v2, s[48:51], s72 offen offset:2048 sc1
  s_waitcnt vmcnt(9)
  v_mfma_f32_16x16x32_bf16 v[12:15], a[24:27], v[44:47], v[12:15]
  v_mfma_f32_16x16x32_bf16 v[16:19], a[28:31], v[44:47], v[16:19]
  v_mfma_f32_16x16x32_bf16 v[20:23], a[32:35], v[44:47], v[20:23]
  s_add_u32 s72, s71, 24576
  buffer_load_dwordx4 v[44:47], v2, s[48:51], s72 offen offset:0 sc1
  s_waitcnt vmcnt(9)
  v_mfma_f32_16x16x32_bf16 v[12:15], a[36:39], v[48:51], v[12:15]
  v_mfma_f32_16x16x32_bf16 v[16:19], a[40:43], v[48:51], v[16:19]
  v_mfma_f32_16x16x32_bf16 v[20:23], a[44:47], v[48:51], v[20:23]
  buffer_load_dwordx4 v[48:51], v2, s[48:51], s72 offen offset:2048 sc1
  s_waitcnt vmcnt(9)
  v_mfma_f32_16x16x32_bf16 v[12:15], a[48:51], v[52:55], v[12:15]
  v_mfma_f32_16x16x32_bf16 v[16:19], a[52:55], v[52:55], v[16:19]
  v_mfma_f32_16x16x32_bf16 v[20:23], a[56:59], v[52:55], v[20:23]
  s_add_u32 s72, s71, 28672
  buffer_load_dwordx4 v[52:55], v2, s[48:51], s72 offen offset:0 sc1
  s_waitcnt vmcnt(9)
  v_mfma_f32_16x16x32_bf16 v[12:15], a[60:63], v[56:59], v[12:15]
  v_mfma_f32_16x16x32_bf16 v[16:19], a[64:67], v[56:59], v[16:19]
  v_mfma_f32_16x16x32_bf16 v[20:23], a[68:71], v[56:59], v[20:23]
  buffer_load_dwordx4 v[56:59], v2, s[48:51], s72 offen offset:2048 sc1
  s_waitcnt vmcnt(9)
  v_mfma_f32_16x16x32_bf16 v[12:15], a[72:75], v[60:63], v[12:15]
  v_mfma_f32_16x16x32_bf16 v[16:19], a[76:79], v[60:63], v[16:19]
  v_mfma_f32_16x16x32_bf16 v[20:23], a[80:83], v[60:63], v[20:23]
  s_add_u32 s72, s71, 32768
  buffer_load_dwordx4 v[60:63], v2, s[48:51], s72 offen offset:0 sc1
  s_waitcnt vmcnt(9)
  v_mfma_f32_16x16x32_bf16 v[12:15], a[84:87], v[64:67], v[12:15]
  v_mfma_f32_16x16x32_bf16 v[16:19], a[88:91], v[64:67], v[16:19]
  v_mfma_f32_16x16x32_bf16 v[20:23], a[92:95], v[64:67], v[20:23]
  buffer_load_dwordx4 v[64:67], v2, s[48:51], s72 offen offset:2048 sc1
  s_waitcnt vmcnt(9)
  v_mfma_f32_16x16x32_bf16 v[12:15], a[96:99], v[68:71], v[12:15]
  v_mfma_f32_16x16x32_bf16 v[16:19], a[100:103], v[68:71], v[16:19]
  v_mfma_f32_16x16x32_bf16 v[20:23], a[104:107], v[68:71], v[20:23]
  s_add_u32 s72, s71, 36864
  buffer_load_dwordx4 v[68:71], v2, s[48:51], s72 offen offset:0 sc1
  s_waitcnt vmcnt(9)
  v_mfma_f32_16x16x32_bf16 v[12:15], a[108:111], v[72:75], v[12:15]
  v_mfma_f32_16x16x32_bf16 v[16:19], a[112:115], v[72:75], v[16:19]
  v_mfma_f32_16x16x32_bf16 v[20:23], a[116:119], v[72:75], v[20:23]
  buffer_load_dwordx4 v[72:75], v2, s[48:51], s72 offen offset:2048 sc1
  s_waitcnt vmcnt(9)
  v_mfma_f32_16x16x32_bf16 v[12:15], a[120:123], v[36:39], v[12:15]
  v_mfma_f32_16x16x32_bf16 v[16:19], a[124:127], v[36:39], v[16:19]
  v_mfma_f32_16x16x32_bf16 v[20:23], a[128:131], v[36:39], v[20:23]
  s_add_u32 s72, s71, 40960
  buffer_load_dwordx4 v[36:39], v2, s[48:51], s72 offen offset:0 sc1
  s_waitcnt vmcnt(9)
  v_mfma_f32_16x16x32_bf16 v[12:15], a[132:135], v[40:43], v[12:15]
  v_mfma_f32_16x16x32_bf16 v[16:19], a[136:139], v[40:43], v[16:19]
  v_mfma_f32_16x16x32_bf16 v[20:23], a[140:143], v[40:43], v[20:23]
  buffer_load_dwordx4 v[40:43], v2, s[48:51], s72 offen offset:2048 sc1
  s_waitcnt vmcnt(9)
  v_mfma_f32_16x16x32_bf16 v[12:15], a[144:147], v[44:47], v[12:15]
  v_mfma_f32_16x16x32_bf16 v[16:19], a[148:151], v[44:47], v[16:19]
  v_mfma_f32_16x16x32_bf16 v[20:23], a[152:155], v[44:47], v[20:23]
  s_add_u32 s72, s71, 45056
  buffer_load_dwordx4 v[44:47], v2, s[48:51], s72 offen offset:0 sc1
  s_waitcnt vmcnt(9)
  v_mfma_f32_16x16x32_bf16 v[12:15], a[156:159], v[48:51], v[12:15]
  v_mfma_f32_16x16x32_bf16 v[16:19], a[160:163], v[48:51], v[16:19]
  v_mfma_f32_16x16x32_bf16 v[20:23], a[164:167], v[48:51], v[20:23]
  buffer_load_dwordx4 v[48:51], v2, s[48:51], s72 offen offset:2048 sc1
  s_waitcnt vmcnt(9)
  v_mfma_f32_16x16x32_bf16 v[12:15], a[168:171], v[52:55], v[12:15]
  v_mfma_f32_16x16x32_bf16 v[16:19], a[172:175], v[52:55], v[16:19]
  v_mfma_f32_16x16x32_bf16 v[20:23], a[176:179], v[52:55], v[20:23]
  s_add_u32 s72, s71, 49152
  buffer_load_dwordx4 v[52:55], v2, s[48:51], s72 offen offset:0 sc1
  s_waitcnt vmcnt(9)
  v_mfma_f32_16x16x32_bf16 v[12:15], a[180:183], v[56:59], v[12:15]
  v_mfma_f32_16x16x32_bf16 v[16:19], a[184:187], v[56:59], v[16:19]
  v_mfma_f32_16x16x32_bf16 v[20:23], a[188:191], v[56:59], v[20:23]
  buffer_load_dwordx4 v[56:59], v2, s[48:51], s72 offen offset:2048 sc1
  s_waitcnt vmcnt(9)
  v_mfma_f32_16x16x32_bf16 v[12:15], a[192:195], v[60:63], v[12:15]
  v_mfma_f32_16x16x32_bf16 v[16:19], a[196:199], v[60:63], v[16:19]
  v_mfma_f32_16x16x32_bf16 v[20:23], a[200:203], v[60:63], v[20:23]
  s_add_u32 s72, s71, 53248
  buffer_load_dwordx4 v[60:63], v2, s[48:51], s72 offen offset:0 sc1
  s_waitcnt vmcnt(9)
  v_mfma_f32_16x16x32_bf16 v[12:15], a[204:207], v[64:67], v[12:15]
  v_mfma_f32_16x16x32_bf16 v[16:19], a[208:211], v[64:67], v[16:19]
  v_mfma_f32_16x16x32_bf16 v[20:23], a[212:215], v[64:67], v[20:23]
  buffer_load_dwordx4 v[64:67], v2, s[48:51], s72 offen offset:2048 sc1
  s_waitcnt vmcnt(9)
  v_mfma_f32_16x16x32_bf16 v[12:15], a[216:219], v[68:71], v[12:15]
  v_mfma_f32_16x16x32_bf16 v[16:19], a[220:223], v[68:71], v[16:19]
  v_mfma_f32_16x16x32_bf16 v[20:23], a[224:227], v[68:71], v[20:23]
  s_add_u32 s72, s71, 57344
  buffer_load_dwordx4 v[68:71], v2, s[48:51], s72 offen offset:0 sc1
  s_waitcnt vmcnt(9)
  v_mfma_f32_16x16x32_bf16 v[12:15], a[228:231], v[72:75], v[12:15]
  v_mfma_f32_16x16x32_bf16 v[16:19], a[232:235], v[72:75], v[16:19]
  v_mfma_f32_16x16x32_bf16 v[20:23], a[236:239], v[72:75], v[20:23]
  buffer_load_dwordx4 v[72:75], v2, s[48:51], s72 offen offset:2048 sc1
  s_waitcnt vmcnt(9)
  v_mfma_f32_16x16x32_bf16 v[12:15], a[240:243], v[36:39], v[12:15]
  v_mfma_f32_16x16x32_bf16 v[16:19], a[244:247], v[36:39], v[16:19]
  v_mfma_f32_16x16x32_bf16 v[20:23], a[248:251], v[36:39], v[20:23]
  s_add_u32 s72, s71, 61440
  buffer_load_dwordx4 v[36:39], v2, s[48:51], s72 offen offset:0 sc1
  s_waitcnt vmcnt(9)
  v_mfma_f32_16x16x32_bf16 v[12:15], a[252:255], v[40:43], v[12:15]
  v_mfma_f32_16x16x32_bf16 v[16:19], v[80:83], v[40:43], v[16:19]
  v_mfma_f32_16x16x32_bf16 v[20:23], v[84:87], v[40:43], v[20:23]
  buffer_load_dwordx4 v[40:43], v2, s[48:51], s72 offen offset:2048 sc1
  s_waitcnt vmcnt(9)
  v_mfma_f32_16x16x32_bf16 v[12:15], v[88:91], v[44:47], v[12:15]
  v_mfma_f32_16x16x32_bf16 v[16:19], v[92:95], v[44:47], v[16:19]
  v_mfma_f32_16x16x32_bf16 v[20:23], v[96:99], v[44:47], v[20:23]
  s_add_u32 s72, s71, 65536
  buffer_load_dwordx4 v[44:47], v2, s[48:51], s72 offen offset:0 sc1
  s_waitcnt vmcnt(9)
  v_mfma_f32_16x16x32_bf16 v[12:15], v[100:103], v[48:51], v[12:15]
  v_mfma_f32_16x16x32_bf16 v[16:19], v[104:107], v[48:51], v[16:19]
  v_mfma_f32_16x16x32_bf16 v[20:23], v[108:111], v[48:51], v[20:23]
  buffer_load_dwordx4 v[48:51], v2, s[48:51], s72 offen offset:2048 sc1
  s_waitcnt vmcnt(9)
  v_mfma_f32_16x16x32_bf16 v[12:15], v[112:115], v[52:55], v[12:15]
  v_mfma_f32_16x16x32_bf16 v[16:19], v[116:119], v[52:55], v[16:19]
  v_mfma_f32_16x16x32_bf16 v[20:23], v[120:123], v[52:55], v[20:23]
  s_add_u32 s72, s71, 69632
  buffer_load_dwordx4 v[52:55], v2, s[48:51], s72 offen offset:0 sc1
  s_waitcnt vmcnt(9)
  v_mfma_f32_16x16x32_bf16 v[12:15], v[124:127], v[56:59], v[12:15]
  v_mfma_f32_16x16x32_bf16 v[16:19], v[128:131], v[56:59], v[16:19]
  v_mfma_f32_16x16x32_bf16 v[20:23], v[132:135], v[56:59], v[20:23]
  buffer_load_dwordx4 v[56:59], v2, s[48:51], s72 offen offset:2048 sc1
  s_waitcnt vmcnt(9)
  v_mfma_f32_16x16x32_bf16 v[12:15], v[136:139], v[60:63], v[12:15]
  v_mfma_f32_16x16x32_bf16 v[16:19], v[140:143], v[60:63], v[16:19]
  v_mfma_f32_16x16x32_bf16 v[20:23], v[144:147], v[60:63], v[20:23]
  s_waitcnt vmcnt(8)
  v_mfma_f32_16x16x32_bf16 v[12:15], v[148:151], v[64:67], v[12:15]
  v_mfma_f32_16x16x32_bf16 v[16:19], v[152:155], v[64:67], v[16:19]
  v_mfma_f32_16x16x32_bf16 v[20:23], v[156:159], v[64:67], v[20:23]
  s_waitcnt vmcnt(7)
  v_mfma_f32_16x16x32_bf16 v[12:15], v[160:163], v[68:71], v[12:15]
  v_mfma_f32_16x16x32_bf16 v[16:19], v[164:167], v[68:71], v[16:19]
  v_mfma_f32_16x16x32_bf16 v[20:23], v[168:171], v[68:71], v[20:23]
  s_waitcnt vmcnt(6)
  v_mfma_f32_16x16x32_bf16 v[12:15], v[172:175], v[72:75], v[12:15]
  v_mfma_f32_16x16x32_bf16 v[16:19], v[176:179], v[72:75], v[16:19]
  v_mfma_f32_16x16x32_bf16 v[20:23], v[180:183], v[72:75], v[20:23]
  s_waitcnt vmcnt(5)
  v_mfma_f32_16x16x32_bf16 v[12:15], v[184:187], v[36:39], v[12:15]
  v_mfma_f32_16x16x32_bf16 v[16:19], v[188:191], v[36:39], v[16:19]
  v_mfma_f32_16x16x32_bf16 v[20:23], v[192:195], v[36:39], v[20:23]
  s_waitcnt vmcnt(4)
  v_mfma_f32_16x16x32_bf16 v[12:15], v[196:199], v[40:43], v[12:15]
  v_mfma_f32_16x16x32_bf16 v[16:19], v[200:203], v[40:43], v[16:19]
  v_mfma_f32_16x16x32_bf16 v[20:23], v[204:207], v[40:43], v[20:23]
  s_waitcnt vmcnt(3)
  v_mfma_f32_16x16x32_bf16 v[12:15], v[208:211], v[44:47], v[12:15]
  v_mfma_f32_16x16x32_bf16 v[16:19], v[212:215], v[44:47], v[16:19]
  v_mfma_f32_16x16x32_bf16 v[20:23], v[216:219], v[44:47], v[20:23]
  s_waitcnt vmcnt(2)
  v_mfma_f32_16x16x32_bf16 v[12:15], v[220:223], v[48:51], v[12:15]
  v_mfma_f32_16x16x32_bf16 v[16:19], v[224:227], v[48:51], v[16:19]
  v_mfma_f32_16x16x32_bf16 v[20:23], v[228:231], v[48:51], v[20:23]
  s_waitcnt vmcnt(1)
  v_mfma_f32_16x16x32_bf16 v[12:15], v[232:235], v[52:55], v[12:15]
  v_mfma_f32_16x16x32_bf16 v[16:19], v[236:239], v[52:55], v[16:19]
  v_mfma_f32_16x16x32_bf16 v[20:23], v[240:243], v[52:55], v[20:23]
  s_waitcnt vmcnt(0)
  v_mfma_f32_16x16x32_bf16 v[12:15], v[244:247], v[56:59], v[12:15]
  v_mfma_f32_16x16x32_bf16 v[16:19], v[248:251], v[56:59], v[16:19]
  v_mfma_f32_16x16x32_bf16 v[20:23], v[252:255], v[56:59], v[20:23]
  s_mul_i32 s4, s3, 3072
  v_add_u32 v7, s4, v2
  s_nop 7
  ds_write_b128 v7, v[12:15] offset:0
  ds_write_b128 v7, v[16:19] offset:1024
  ds_write_b128 v7, v[20:23] offset:2048
  s_waitcnt lgkmcnt(0)
  s_barrier
  s_lshl_b32 s4, s3, 10
  v_add_u32 v7, s4, v2
  ds_read_b128 v[36:39], v7 offset:0
  ds_read_b128 v[40:43], v7 offset:3072
  ds_read_b128 v[44:47], v7 offset:6144
  ds_read_b128 v[48:51], v7 offset:9216
  s_waitcnt lgkmcnt(0)
  v_add_f32 v36, v36, v40
  v_add_f32 v44, v44, v48
  v_add_f32 v37, v37, v41
  v_add_f32 v45, v45, v49
  v_add_f32 v38, v38, v42
  v_add_f32 v46, v46, v50
  v_add_f32 v39, v39, v43
  v_add_f32 v47, v47, v51
  v_add_f32 v12, v36, v44
  v_add_f32 v13, v37, v45
  v_add_f32 v14, v38, v46
  v_add_f32 v15, v39, v47
  s_barrier
  s_lshl_b32 s4, s70, 1
  s_add_u32 s4, s4, s75
  s_mul_i32 s4, s4, 12
  s_add_u32 s4, s4, s69
  s_mul_i32 s4, s4, 3072
  s_lshl_b32 s5, s3, 10
  s_add_u32 s4, s4, s5
  s_add_u32 s73, s4, 103809024
  s_cmp_ge_u32 s3, 3
  s_cbranch_scc1 L_ffn2_ns_37
  buffer_store_dwordx4 v[12:15], v2, s[48:51], s73 offen sc1
L_ffn2_ns_37:
L_ffn2_next:
  s_add_u32 s76, s76, 1
  s_cmp_lt_u32 s76, 8
  s_cbranch_scc1 L_ffn2_loop
  s_waitcnt vmcnt(0)
  s_barrier
  v_lshlrev_b32 v2, 4, v0
  v_lshrrev_b32 v12, 3, v0
  v_and_b32 v13, 7, v0
  v_bfe_u32 v14, v0, 4, 2
  v_lshlrev_b32 v14, 1, v14
  v_xor_b32 v13, v13, v14
  v_lshlrev_b32 v13, 4, v13
  s_movk_i32 s4, 1152
  v_mul_lo_u32 v12, v12, s4
  v_add_u32 v6, v12, v13
  v_lshrrev_b32 v12, 2, v0
  v_bfe_u32 v13, v12, 1, 2
  v_lshlrev_b32 v13, 1, v13
  v_lshlrev_b32 v12, 7, v12
  v_and_b32 v14, 1, v0
  v_lshlrev_b32 v14, 3, v14
  v_add_u32 v12, v12, v14
  s_mul_i32 s4, s3, 40960
  v_add_u32 v12, s4, v12
  v_bfe_u32 v14, v0, 1, 1
  v_add_u32 v15, 0, v14
  v_xor_b32 v15, v15, v13
  v_lshlrev_b32 v15, 4, v15
  v_add_u32 v3, v12, v15
  v_add_u32 v15, 2, v14
  v_xor_b32 v15, v15, v13
  v_lshlrev_b32 v15, 4, v15
  v_add_u32 v4, v12, v15
  v_add_u32 v15, 4, v14
  v_xor_b32 v15, v15, v13
  v_lshlrev_b32 v15, 4, v15
  v_add_u32 v5, v12, v15
  s_mul_i32 s13, s69, 96
  s_add_u32 s56, s26, s13
  s_addc_u32 s57, s27, 0
  s_mov_b32 s58, 4718592
  s_mov_b32 s59, 0x20000
  s_sub_u32 s58, s58, s13
  s_mul_i32 s12, s3, 1179648
  s_mul_i32 s11, s3, 40960
  s_add_u32 m0, s11, 0
  s_add_u32 s4, s12, 0
  buffer_load_dwordx4 v6, s[56:59], s4 offen lds
  s_add_u32 m0, s11, 1024
  s_add_u32 s4, s12, 9216
  buffer_load_dwordx4 v6, s[56:59], s4 offen lds
  s_add_u32 m0, s11, 2048
  s_add_u32 s4, s12, 18432
  buffer_load_dwordx4 v6, s[56:59], s4 offen lds
  s_add_u32 m0, s11, 3072
  s_add_u32 s4, s12, 27648
  buffer_load_dwordx4 v6, s[56:59], s4 offen lds
  s_add_u32 m0, s11, 4096
  s_add_u32 s4, s12, 36864
  buffer_load_dwordx4 v6, s[56:59], s4 offen lds
  s_add_u32 m0, s11, 5120
  s_add_u32 s4, s12, 46080
  buffer_load_dwordx4 v6, s[56:59], s4 offen lds
  s_add_u32 m0, s11, 6144
  s_add_u32 s4, s12, 55296
  buffer_load_dwordx4 v6, s[56:59], s4 offen lds
  s_add_u32 m0, s11, 7168
  s_add_u32 s4, s12, 64512
  buffer_load_dwordx4 v6, s[56:59], s4 offen lds
  s_add_u32 m0, s11, 8192
  s_add_u32 s4, s12, 73728
  buffer_load_dwordx4 v6, s[56:59], s4 offen lds
  s_add_u32 m0, s11, 9216
  s_add_u32 s4, s12, 82944
  buffer_load_dwordx4 v6, s[56:59], s4 offen lds
  s_add_u32 m0, s11, 10240
  s_add_u32 s4, s12, 92160
  buffer_load_dwordx4 v6, s[56:59], s4 offen lds
  s_add_u32 m0, s11, 11264
  s_add_u32 s4, s12, 101376
  buffer_load_dwordx4 v6, s[56:59], s4 offen lds
  s_add_u32 m0, s11, 12288
  s_add_u32 s4, s12, 110592
  buffer_load_dwordx4 v6, s[56:59], s4 offen lds
  s_add_u32 m0, s11, 13312
  s_add_u32 s4, s12, 119808
  buffer_load_dwordx4 v6, s[56:59], s4 offen lds
  s_add_u32 m0, s11, 14336
  s_add_u32 s4, s12, 129024
  buffer_load_dwordx4 v6, s[56:59], s4 offen lds
  s_add_u32 m0, s11, 15360
  s_add_u32 s4, s12, 138240
  buffer_load_dwordx4 v6, s[56:59], s4 offen lds
  s_add_u32 m0, s11, 16384
  s_add_u32 s4, s12, 147456
  buffer_load_dwordx4 v6, s[56:59], s4 offen lds
  s_add_u32 m0, s11, 17408
  s_add_u32 s4, s12, 156672
  buffer_load_dwordx4 v6, s[56:59], s4 offen lds
  s_add_u32 m0, s11, 18432
  s_add_u32 s4, s12, 165888
  buffer_load_dwordx4 v6, s[56:59], s4 offen lds
  s_add_u32 m0, s11, 19456
  s_add_u32 s4, s12, 175104
  buffer_load_dwordx4 v6, s[56:59], s4 offen lds
  s_add_u32 m0, s11, 20480
  s_add_u32 s4, s12, 184320
  buffer_load_dwordx4 v6, s[56:59], s4 offen lds
  s_add_u32 m0, s11, 21504
  s_add_u32 s4, s12, 193536
  buffer_load_dwordx4 v6, s[56:59], s4 offen lds
  s_add_u32 m0, s11, 22528
  s_add_u32 s4, s12, 202752
  buffer_load_dwordx4 v6, s[56:59], s4 offen lds
  s_add_u32 m0, s11, 23552
  s_add_u32 s4, s12, 211968
  buffer_load_dwordx4 v6, s[56:59], s4 offen lds
  s_add_u32 m0, s11, 24576
  s_add_u32 s4, s12, 221184
  buffer_load_dwordx4 v6, s[56:59], s4 offen lds
  s_add_u32 m0, s11, 25600
  s_add_u32 s4, s12, 230400
  buffer_load_dwordx4 v6, s[56:59], s4 offen lds
  s_add_u32 m0, s11, 26624
  s_add_u32 s4, s12, 239616
  buffer_load_dwordx4 v6, s[56:59], s4 offen lds
  s_add_u32 m0, s11, 27648
  s_add_u32 s4, s12, 248832
  buffer_load_dwordx4 v6, s[56:59], s4 offen lds
  s_add_u32 m0, s11, 28672
  s_add_u32 s4, s12, 258048
  buffer_load_dwordx4 v6, s[56:59], s4 offen lds
  s_add_u32 m0, s11, 29696
  s_add_u32 s4, s12, 267264
  buffer_load_dwordx4 v6, s[56:59], s4 offen lds
  s_add_u32 m0, s11, 30720
  s_add_u32 s4, s12, 276480
  buffer_load_dwordx4 v6, s[56:59], s4 offen lds
  s_add_u32 m0, s11, 31744
  s_add_u32 s4, s12, 285696
  buffer_load_dwordx4 v6, s[56:59], s4 offen lds
  s_add_u32 m0, s11, 32768
  s_add_u32 s4, s12, 294912
  buffer_load_dwordx4 v6, s[56:59], s4 offen lds
  s_add_u32 m0, s11, 33792
  s_add_u32 s4, s12, 304128
  buffer_load_dwordx4 v6, s[56:59], s4 offen lds
  s_add_u32 m0, s11, 34816
  s_add_u32 s4, s12, 313344
  buffer_load_dwordx4 v6, s[56:59], s4 offen lds
  s_add_u32 m0, s11, 35840
  s_add_u32 s4, s12, 322560
  buffer_load_dwordx4 v6, s[56:59], s4 offen lds
  s_add_u32 m0, s11, 36864
  s_add_u32 s4, s12, 331776
  buffer_load_dwordx4 v6, s[56:59], s4 offen lds
  s_add_u32 m0, s11, 37888
  s_add_u32 s4, s12, 340992
  buffer_load_dwordx4 v6, s[56:59], s4 offen lds
  s_add_u32 m0, s11, 38912
  s_add_u32 s4, s12, 350208
  buffer_load_dwordx4 v6, s[56:59], s4 offen lds
  s_add_u32 m0, s11, 39936
  s_add_u32 s4, s12, 359424
  buffer_load_dwordx4 v6, s[56:59], s4 offen lds
  s_waitcnt vmcnt(32)
  ds_read_b64_tr_b16 a[0:1], v3 offset:0
  ds_read_b64_tr_b16 a[2:3], v3 offset:2048
  ds_read_b64_tr_b16 a[4:5], v4 offset:0
  ds_read_b64_tr_b16 a[6:7], v4 offset:2048
  ds_read_b64_tr_b16 a[8:9], v5 offset:0
  ds_read_b64_tr_b16 a[10:11], v5 offset:2048
  ds_read_b64_tr_b16 a[12:13], v3 offset:4096
  ds_read_b64_tr_b16 a[14:15], v3 offset:6144
  ds_read_b64_tr_b16 a[16:17], v4 offset:4096
  ds_read_b64_tr_b16 a[18:19], v4 offset:6144
  ds_read_b64_tr_b16 a[20:21], v5 offset:4096
  ds_read_b64_tr_b16 a[22:23], v5 offset:6144
  s_waitcnt lgkmcnt(0)
  s_add_u32 m0, s11, 0
  s_add_u32 s4, s12, 368640
  buffer_load_dwordx4 v6, s[56:59], s4 offen lds
  s_add_u32 m0, s11, 1024
  s_add_u32 s4, s12, 377856
  buffer_load_dwordx4 v6, s[56:59], s4 offen lds
  s_add_u32 m0, s11, 2048
  s_add_u32 s4, s12, 387072
  buffer_load_dwordx4 v6, s[56:59], s4 offen lds
  s_add_u32 m0, s11, 3072
  s_add_u32 s4, s12, 396288
  buffer_load_dwordx4 v6, s[56:59], s4 offen lds
  s_add_u32 m0, s11, 4096
  s_add_u32 s4, s12, 405504
  buffer_load_dwordx4 v6, s[56:59], s4 offen lds
  s_add_u32 m0, s11, 5120
  s_add_u32 s4, s12, 414720
  buffer_load_dwordx4 v6, s[56:59], s4 offen lds
  s_add_u32 m0, s11, 6144
  s_add_u32 s4, s12, 423936
  buffer_load_dwordx4 v6, s[56:59], s4 offen lds
  s_add_u32 m0, s11, 7168
  s_add_u32 s4, s12, 433152
  buffer_load_dwordx4 v6, s[56:59], s4 offen lds
  s_waitcnt vmcnt(32)
  ds_read_b64_tr_b16 a[24:25], v3 offset:8192
  ds_read_b64_tr_b16 a[26:27], v3 offset:10240
  ds_read_b64_tr_b16 a[28:29], v4 offset:8192
  ds_read_b64_tr_b16 a[30:31], v4 offset:10240
  ds_read_b64_tr_b16 a[32:33], v5 offset:8192
  ds_read_b64_tr_b16 a[34:35], v5 offset:10240
  ds_read_b64_tr_b16 a[36:37], v3 offset:12288
  ds_read_b64_tr_b16 a[38:39], v3 offset:14336
  ds_read_b64_tr_b16 a[40:41], v4 offset:12288
  ds_read_b64_tr_b16 a[42:43], v4 offset:14336
  ds_read_b64_tr_b16 a[44:45], v5 offset:12288
  ds_read_b64_tr_b16 a[46:47], v5 offset:14336
  s_waitcnt lgkmcnt(0)
  s_add_u32 m0, s11, 8192
  s_add_u32 s4, s12, 442368
  buffer_load_dwordx4 v6, s[56:59], s4 offen lds
  s_add_u32 m0, s11, 9216
  s_add_u32 s4, s12, 451584
  buffer_load_dwordx4 v6, s[56:59], s4 offen lds
  s_add_u32 m0, s11, 10240
  s_add_u32 s4, s12, 460800
  buffer_load_dwordx4 v6, s[56:59], s4 offen lds
  s_add_u32 m0, s11, 11264
  s_add_u32 s4, s12, 470016
  buffer_load_dwordx4 v6, s[56:59], s4 offen lds
  s_add_u32 m0, s11, 12288
  s_add_u32 s4, s12, 479232
  buffer_load_dwordx4 v6, s[56:59], s4 offen lds
  s_add_u32 m0, s11, 13312
  s_add_u32 s4, s12, 488448
  buffer_load_dwordx4 v6, s[56:59], s4 offen lds
  s_add_u32 m0, s11, 14336
  s_add_u32 s4, s12, 497664
  buffer_load_dwordx4 v6, s[56:59], s4 offen lds
  s_add_u32 m0, s11, 15360
  s_add_u32 s4, s12, 506880
  buffer_load_dwordx4 v6, s[56:59], s4 offen lds
  s_waitcnt vmcnt(32)
  ds_read_b64_tr_b16 a[48:49], v3 offset:16384
  ds_read_b64_tr_b16 a[50:51], v3 offset:18432
  ds_read_b64_tr_b16 a[52:53], v4 offset:16384
  ds_read_b64_tr_b16 a[54:55], v4 offset:18432
  ds_read_b64_tr_b16 a[56:57], v5 offset:16384
  ds_read_b64_tr_b16 a[58:59], v5 offset:18432
  ds_read_b64_tr_b16 a[60:61], v3 offset:20480
  ds_read_b64_tr_b16 a[62:63], v3 offset:22528
  ds_read_b64_tr_b16 a[64:65], v4 offset:20480
  ds_read_b64_tr_b16 a[66:67], v4 offset:22528
  ds_read_b64_tr_b16 a[68:69], v5 offset:20480
  ds_read_b64_tr_b16 a[70:71], v5 offset:22528
  s_waitcnt lgkmcnt(0)
  s_add_u32 m0, s11, 16384
  s_add_u32 s4, s12, 516096
  buffer_load_dwordx4 v6, s[56:59], s4 offen lds
  s_add_u32 m0, s11, 17408
  s_add_u32 s4, s12, 525312
  buffer_load_dwordx4 v6, s[56:59], s4 offen lds
  s_add_u32 m0, s11, 18432
  s_add_u32 s4, s12, 534528
  buffer_load_dwordx4 v6, s[56:59], s4 offen lds
  s_add_u32 m0, s11, 19456
  s_add_u32 s4, s12, 543744
  buffer_load_dwordx4 v6, s[56:59], s4 offen lds
  s_add_u32 m0, s11, 20480
  s_add_u32 s4, s12, 552960
  buffer_load_dwordx4 v6, s[56:59], s4 offen lds
  s_add_u32 m0, s11, 21504
  s_add_u32 s4, s12, 562176
  buffer_load_dwordx4 v6, s[56:59], s4 offen lds
  s_add_u32 m0, s11, 22528
  s_add_u32 s4, s12, 571392
  buffer_load_dwordx4 v6, s[56:59], s4 offen lds
  s_add_u32 m0, s11, 23552
  s_add_u32 s4, s12, 580608
  buffer_load_dwordx4 v6, s[56:59], s4 offen lds
  s_waitcnt vmcnt(32)
  ds_read_b64_tr_b16 a[72:73], v3 offset:24576
  ds_read_b64_tr_b16 a[74:75], v3 offset:26624
  ds_read_b64_tr_b16 a[76:77], v4 offset:24576
  ds_read_b64_tr_b16 a[78:79], v4 offset:26624
  ds_read_b64_tr_b16 a[80:81], v5 offset:24576
  ds_read_b64_tr_b16 a[82:83], v5 offset:26624
  ds_read_b64_tr_b16 a[84:85], v3 offset:28672
  ds_read_b64_tr_b16 a[86:87], v3 offset:30720
  ds_read_b64_tr_b16 a[88:89], v4 offset:28672
  ds_read_b64_tr_b16 a[90:91], v4 offset:30720
  ds_read_b64_tr_b16 a[92:93], v5 offset:28672
  ds_read_b64_tr_b16 a[94:95], v5 offset:30720
  s_waitcnt lgkmcnt(0)
  s_add_u32 m0, s11, 24576
  s_add_u32 s4, s12, 589824
  buffer_load_dwordx4 v6, s[56:59], s4 offen lds
  s_add_u32 m0, s11, 25600
  s_add_u32 s4, s12, 599040
  buffer_load_dwordx4 v6, s[56:59], s4 offen lds
  s_add_u32 m0, s11, 26624
  s_add_u32 s4, s12, 608256
  buffer_load_dwordx4 v6, s[56:59], s4 offen lds
  s_add_u32 m0, s11, 27648
  s_add_u32 s4, s12, 617472
  buffer_load_dwordx4 v6, s[56:59], s4 offen lds
  s_add_u32 m0, s11, 28672
  s_add_u32 s4, s12, 626688
  buffer_load_dwordx4 v6, s[56:59], s4 offen lds
  s_add_u32 m0, s11, 29696
  s_add_u32 s4, s12, 635904
  buffer_load_dwordx4 v6, s[56:59], s4 offen lds
  s_add_u32 m0, s11, 30720
  s_add_u32 s4, s12, 645120
  buffer_load_dwordx4 v6, s[56:59], s4 offen lds
  s_add_u32 m0, s11, 31744
  s_add_u32 s4, s12, 654336
  buffer_load_dwordx4 v6, s[56:59], s4 offen lds
  s_waitcnt vmcnt(32)
  ds_read_b64_tr_b16 a[96:97], v3 offset:32768
  ds_read_b64_tr_b16 a[98:99], v3 offset:34816
  ds_read_b64_tr_b16 a[100:101], v4 offset:32768
  ds_read_b64_tr_b16 a[102:103], v4 offset:34816
  ds_read_b64_tr_b16 a[104:105], v5 offset:32768
  ds_read_b64_tr_b16 a[106:107], v5 offset:34816
  ds_read_b64_tr_b16 a[108:109], v3 offset:36864
  ds_read_b64_tr_b16 a[110:111], v3 offset:38912
  ds_read_b64_tr_b16 a[112:113], v4 offset:36864
  ds_read_b64_tr_b16 a[114:115], v4 offset:38912
  ds_read_b64_tr_b16 a[116:117], v5 offset:36864
  ds_read_b64_tr_b16 a[118:119], v5 offset:38912
  s_waitcnt lgkmcnt(0)
  s_add_u32 m0, s11, 32768
  s_add_u32 s4, s12, 663552
  buffer_load_dwordx4 v6, s[56:59], s4 offen lds
  s_add_u32 m0, s11, 33792
  s_add_u32 s4, s12, 672768
  buffer_load_dwordx4 v6, s[56:59], s4 offen lds
  s_add_u32 m0, s11, 34816
  s_add_u32 s4, s12, 681984
  buffer_load_dwordx4 v6, s[56:59], s4 offen lds
  s_add_u32 m0, s11, 35840
  s_add_u32 s4, s12, 691200
  buffer_load_dwordx4 v6, s[56:59], s4 offen lds
  s_add_u32 m0, s11, 36864
  s_add_u32 s4, s12, 700416
  buffer_load_dwordx4 v6, s[56:59], s4 offen lds
  s_add_u32 m0, s11, 37888
  s_add_u32 s4, s12, 709632
  buffer_load_dwordx4 v6, s[56:59], s4 offen lds
  s_add_u32 m0, s11, 38912
  s_add_u32 s4, s12, 718848
  buffer_load_dwordx4 v6, s[56:59], s4 offen lds
  s_add_u32 m0, s11, 39936
  s_add_u32 s4, s12, 728064
  buffer_load_dwordx4 v6, s[56:59], s4 offen lds
  s_waitcnt vmcnt(32)
  ds_read_b64_tr_b16 a[120:121], v3 offset:0
  ds_read_b64_tr_b16 a[122:123], v3 offset:2048
  ds_read_b64_tr_b16 a[124:125], v4 offset:0
  ds_read_b64_tr_b16 a[126:127], v4 offset:2048
  ds_read_b64_tr_b16 a[128:129], v5 offset:0
  ds_read_b64_tr_b16 a[130:131], v5 offset:2048
  ds_read_b64_tr_b16 a[132:133], v3 offset:4096
  ds_read_b64_tr_b16 a[134:135], v3 offset:6144
  ds_read_b64_tr_b16 a[136:137], v4 offset:4096
  ds_read_b64_tr_b16 a[138:139], v4 offset:6144
  ds_read_b64_tr_b16 a[140:141], v5 offset:4096
  ds_read_b64_tr_b16 a[142:143], v5 offset:6144
  s_waitcnt lgkmcnt(0)
  s_add_u32 m0, s11, 0
  s_add_u32 s4, s12, 737280
  buffer_load_dwordx4 v6, s[56:59], s4 offen lds
  s_add_u32 m0, s11, 1024
  s_add_u32 s4, s12, 746496
  buffer_load_dwordx4 v6, s[56:59], s4 offen lds
  s_add_u32 m0, s11, 2048
  s_add_u32 s4, s12, 755712
  buffer_load_dwordx4 v6, s[56:59], s4 offen lds
  s_add_u32 m0, s11, 3072
  s_add_u32 s4, s12, 764928
  buffer_load_dwordx4 v6, s[56:59], s4 offen lds
  s_add_u32 m0, s11, 4096
  s_add_u32 s4, s12, 774144
  buffer_load_dwordx4 v6, s[56:59], s4 offen lds
  s_add_u32 m0, s11, 5120
  s_add_u32 s4, s12, 783360
  buffer_load_dwordx4 v6, s[56:59], s4 offen lds
  s_add_u32 m0, s11, 6144
  s_add_u32 s4, s12, 792576
  buffer_load_dwordx4 v6, s[56:59], s4 offen lds
  s_add_u32 m0, s11, 7168
  s_add_u32 s4, s12, 801792
  buffer_load_dwordx4 v6, s[56:59], s4 offen lds
  s_waitcnt vmcnt(32)
  ds_read_b64_tr_b16 a[144:145], v3 offset:8192
  ds_read_b64_tr_b16 a[146:147], v3 offset:10240
  ds_read_b64_tr_b16 a[148:149], v4 offset:8192
  ds_read_b64_tr_b16 a[150:151], v4 offset:10240
  ds_read_b64_tr_b16 a[152:153], v5 offset:8192
  ds_read_b64_tr_b16 a[154:155], v5 offset:10240
  ds_read_b64_tr_b16 a[156:157], v3 offset:12288
  ds_read_b64_tr_b16 a[158:159], v3 offset:14336
  ds_read_b64_tr_b16 a[160:161], v4 offset:12288
  ds_read_b64_tr_b16 a[162:163], v4 offset:14336
  ds_read_b64_tr_b16 a[164:165], v5 offset:12288
  ds_read_b64_tr_b16 a[166:167], v5 offset:14336
  s_waitcnt lgkmcnt(0)
  s_add_u32 m0, s11, 8192
  s_add_u32 s4, s12, 811008
  buffer_load_dwordx4 v6, s[56:59], s4 offen lds
  s_add_u32 m0, s11, 9216
  s_add_u32 s4, s12, 820224
  buffer_load_dwordx4 v6, s[56:59], s4 offen lds
  s_add_u32 m0, s11, 10240
  s_add_u32 s4, s12, 829440
  buffer_load_dwordx4 v6, s[56:59], s4 offen lds
  s_add_u32 m0, s11, 11264
  s_add_u32 s4, s12, 838656
  buffer_load_dwordx4 v6, s[56:59], s4 offen lds
  s_add_u32 m0, s11, 12288
  s_add_u32 s4, s12, 847872
  buffer_load_dwordx4 v6, s[56:59], s4 offen lds
  s_add_u32 m0, s11, 13312
  s_add_u32 s4, s12, 857088
  buffer_load_dwordx4 v6, s[56:59], s4 offen lds
  s_add_u32 m0, s11, 14336
  s_add_u32 s4, s12, 866304
  buffer_load_dwordx4 v6, s[56:59], s4 offen lds
  s_add_u32 m0, s11, 15360
  s_add_u32 s4, s12, 875520
  buffer_load_dwordx4 v6, s[56:59], s4 offen lds
  s_waitcnt vmcnt(32)
  ds_read_b64_tr_b16 a[168:169], v3 offset:16384
  ds_read_b64_tr_b16 a[170:171], v3 offset:18432
  ds_read_b64_tr_b16 a[172:173], v4 offset:16384
  ds_read_b64_tr_b16 a[174:175], v4 offset:18432
  ds_read_b64_tr_b16 a[176:177], v5 offset:16384
  ds_read_b64_tr_b16 a[178:179], v5 offset:18432
  ds_read_b64_tr_b16 a[180:181], v3 offset:20480
  ds_read_b64_tr_b16 a[182:183], v3 offset:22528
  ds_read_b64_tr_b16 a[184:185], v4 offset:20480
  ds_read_b64_tr_b16 a[186:187], v4 offset:22528
  ds_read_b64_tr_b16 a[188:189], v5 offset:20480
  ds_read_b64_tr_b16 a[190:191], v5 offset:22528
  s_waitcnt lgkmcnt(0)
  s_add_u32 m0, s11, 16384
  s_add_u32 s4, s12, 884736
  buffer_load_dwordx4 v6, s[56:59], s4 offen lds
  s_add_u32 m0, s11, 17408
  s_add_u32 s4, s12, 893952
  buffer_load_dwordx4 v6, s[56:59], s4 offen lds
  s_add_u32 m0, s11, 18432
  s_add_u32 s4, s12, 903168
  buffer_load_dwordx4 v6, s[56:59], s4 offen lds
  s_add_u32 m0, s11, 19456
  s_add_u32 s4, s12, 912384
  buffer_load_dwordx4 v6, s[56:59], s4 offen lds
  s_add_u32 m0, s11, 20480
  s_add_u32 s4, s12, 921600
  buffer_load_dwordx4 v6, s[56:59], s4 offen lds
  s_add_u32 m0, s11, 21504
  s_add_u32 s4, s12, 930816
  buffer_load_dwordx4 v6, s[56:59], s4 offen lds
  s_add_u32 m0, s11, 22528
  s_add_u32 s4, s12, 940032
  buffer_load_dwordx4 v6, s[56:59], s4 offen lds
  s_add_u32 m0, s11, 23552
  s_add_u32 s4, s12, 949248
  buffer_load_dwordx4 v6, s[56:59], s4 offen lds
  s_waitcnt vmcnt(32)
  ds_read_b64_tr_b16 a[192:193], v3 offset:24576
  ds_read_b64_tr_b16 a[194:195], v3 offset:26624
  ds_read_b64_tr_b16 a[196:197], v4 offset:24576
  ds_read_b64_tr_b16 a[198:199], v4 offset:26624
  ds_read_b64_tr_b16 a[200:201], v5 offset:24576
  ds_read_b64_tr_b16 a[202:203], v5 offset:26624
  ds_read_b64_tr_b16 a[204:205], v3 offset:28672
  ds_read_b64_tr_b16 a[206:207], v3 offset:30720
  ds_read_b64_tr_b16 a[208:209], v4 offset:28672
  ds_read_b64_tr_b16 a[210:211], v4 offset:30720
  ds_read_b64_tr_b16 a[212:213], v5 offset:28672
  ds_read_b64_tr_b16 a[214:215], v5 offset:30720
  s_waitcnt lgkmcnt(0)
  s_add_u32 m0, s11, 24576
  s_add_u32 s4, s12, 958464
  buffer_load_dwordx4 v6, s[56:59], s4 offen lds
  s_add_u32 m0, s11, 25600
  s_add_u32 s4, s12, 967680
  buffer_load_dwordx4 v6, s[56:59], s4 offen lds
  s_add_u32 m0, s11, 26624
  s_add_u32 s4, s12, 976896
  buffer_load_dwordx4 v6, s[56:59], s4 offen lds
  s_add_u32 m0, s11, 27648
  s_add_u32 s4, s12, 986112
  buffer_load_dwordx4 v6, s[56:59], s4 offen lds
  s_add_u32 m0, s11, 28672
  s_add_u32 s4, s12, 995328
  buffer_load_dwordx4 v6, s[56:59], s4 offen lds
  s_add_u32 m0, s11, 29696
  s_add_u32 s4, s12, 1004544
  buffer_load_dwordx4 v6, s[56:59], s4 offen lds
  s_add_u32 m0, s11, 30720
  s_add_u32 s4, s12, 1013760
  buffer_load_dwordx4 v6, s[56:59], s4 offen lds
  s_add_u32 m0, s11, 31744
  s_add_u32 s4, s12, 1022976
  buffer_load_dwordx4 v6, s[56:59], s4 offen lds
  s_waitcnt vmcnt(32)
  ds_read_b64_tr_b16 a[216:217], v3 offset:32768
  ds_read_b64_tr_b16 a[218:219], v3 offset:34816
  ds_read_b64_tr_b16 a[220:221], v4 offset:32768
  ds_read_b64_tr_b16 a[222:223], v4 offset:34816
  ds_read_b64_tr_b16 a[224:225], v5 offset:32768
  ds_read_b64_tr_b16 a[226:227], v5 offset:34816
  ds_read_b64_tr_b16 a[228:229], v3 offset:36864
  ds_read_b64_tr_b16 a[230:231], v3 offset:38912
  ds_read_b64_tr_b16 a[232:233], v4 offset:36864
  ds_read_b64_tr_b16 a[234:235], v4 offset:38912
  ds_read_b64_tr_b16 a[236:237], v5 offset:36864
  ds_read_b64_tr_b16 a[238:239], v5 offset:38912
  s_waitcnt lgkmcnt(0)
  s_add_u32 m0, s11, 32768
  s_add_u32 s4, s12, 1032192
  buffer_load_dwordx4 v6, s[56:59], s4 offen lds
  s_add_u32 m0, s11, 33792
  s_add_u32 s4, s12, 1041408
  buffer_load_dwordx4 v6, s[56:59], s4 offen lds
  s_add_u32 m0, s11, 34816
  s_add_u32 s4, s12, 1050624
  buffer_load_dwordx4 v6, s[56:59], s4 offen lds
  s_add_u32 m0, s11, 35840
  s_add_u32 s4, s12, 1059840
  buffer_load_dwordx4 v6, s[56:59], s4 offen lds
  s_add_u32 m0, s11, 36864
  s_add_u32 s4, s12, 1069056
  buffer_load_dwordx4 v6, s[56:59], s4 offen lds
  s_add_u32 m0, s11, 37888
  s_add_u32 s4, s12, 1078272
  buffer_load_dwordx4 v6, s[56:59], s4 offen lds
  s_add_u32 m0, s11, 38912
  s_add_u32 s4, s12, 1087488
  buffer_load_dwordx4 v6, s[56:59], s4 offen lds
  s_add_u32 m0, s11, 39936
  s_add_u32 s4, s12, 1096704
  buffer_load_dwordx4 v6, s[56:59], s4 offen lds
  s_waitcnt vmcnt(32)
  ds_read_b64_tr_b16 a[240:241], v3 offset:0
  ds_read_b64_tr_b16 a[242:243], v3 offset:2048
  ds_read_b64_tr_b16 a[244:245], v4 offset:0
  ds_read_b64_tr_b16 a[246:247], v4 offset:2048
  ds_read_b64_tr_b16 a[248:249], v5 offset:0
  ds_read_b64_tr_b16 a[250:251], v5 offset:2048
  ds_read_b64_tr_b16 a[252:253], v3 offset:4096
  ds_read_b64_tr_b16 a[254:255], v3 offset:6144
  ds_read_b64_tr_b16 v[128:129], v4 offset:4096
  ds_read_b64_tr_b16 v[130:131], v4 offset:6144
  ds_read_b64_tr_b16 v[132:133], v5 offset:4096
  ds_read_b64_tr_b16 v[134:135], v5 offset:6144
  s_waitcnt lgkmcnt(0)
  s_add_u32 m0, s11, 0
  s_add_u32 s4, s12, 1105920
  buffer_load_dwordx4 v6, s[56:59], s4 offen lds
  s_add_u32 m0, s11, 1024
  s_add_u32 s4, s12, 1115136
  buffer_load_dwordx4 v6, s[56:59], s4 offen lds
  s_add_u32 m0, s11, 2048
  s_add_u32 s4, s12, 1124352
  buffer_load_dwordx4 v6, s[56:59], s4 offen lds
  s_add_u32 m0, s11, 3072
  s_add_u32 s4, s12, 1133568
  buffer_load_dwordx4 v6, s[56:59], s4 offen lds
  s_add_u32 m0, s11, 4096
  s_add_u32 s4, s12, 1142784
  buffer_load_dwordx4 v6, s[56:59], s4 offen lds
  s_add_u32 m0, s11, 5120
  s_add_u32 s4, s12, 1152000
  buffer_load_dwordx4 v6, s[56:59], s4 offen lds
  s_add_u32 m0, s11, 6144
  s_add_u32 s4, s12, 1161216
  buffer_load_dwordx4 v6, s[56:59], s4 offen lds
  s_add_u32 m0, s11, 7168
  s_add_u32 s4, s12, 1170432
  buffer_load_dwordx4 v6, s[56:59], s4 offen lds
  s_waitcnt vmcnt(32)
  ds_read_b64_tr_b16 v[136:137], v3 offset:8192
  ds_read_b64_tr_b16 v[138:139], v3 offset:10240
  ds_read_b64_tr_b16 v[140:141], v4 offset:8192
  ds_read_b64_tr_b16 v[142:143], v4 offset:10240
  ds_read_b64_tr_b16 v[144:145], v5 offset:8192
  ds_read_b64_tr_b16 v[146:147], v5 offset:10240
  ds_read_b64_tr_b16 v[148:149], v3 offset:12288
  ds_read_b64_tr_b16 v[150:151], v3 offset:14336
  ds_read_b64_tr_b16 v[152:153], v4 offset:12288
  ds_read_b64_tr_b16 v[154:155], v4 offset:14336
  ds_read_b64_tr_b16 v[156:157], v5 offset:12288
  ds_read_b64_tr_b16 v[158:159], v5 offset:14336
  s_waitcnt lgkmcnt(0)
  s_waitcnt vmcnt(24)
  ds_read_b64_tr_b16 v[160:161], v3 offset:16384
  ds_read_b64_tr_b16 v[162:163], v3 offset:18432
  ds_read_b64_tr_b16 v[164:165], v4 offset:16384
  ds_read_b64_tr_b16 v[166:167], v4 offset:18432
  ds_read_b64_tr_b16 v[168:169], v5 offset:16384
  ds_read_b64_tr_b16 v[170:171], v5 offset:18432
  ds_read_b64_tr_b16 v[172:173], v3 offset:20480
  ds_read_b64_tr_b16 v[174:175], v3 offset:22528
  ds_read_b64_tr_b16 v[176:177], v4 offset:20480
  ds_read_b64_tr_b16 v[178:179], v4 offset:22528
  ds_read_b64_tr_b16 v[180:181], v5 offset:20480
  ds_read_b64_tr_b16 v[182:183], v5 offset:22528
  s_waitcnt lgkmcnt(0)
  s_waitcnt vmcnt(16)
  ds_read_b64_tr_b16 v[184:185], v3 offset:24576
  ds_read_b64_tr_b16 v[186:187], v3 offset:26624
  ds_read_b64_tr_b16 v[188:189], v4 offset:24576
  ds_read_b64_tr_b16 v[190:191], v4 offset:26624
  ds_read_b64_tr_b16 v[192:193], v5 offset:24576
  ds_read_b64_tr_b16 v[194:195], v5 offset:26624
  ds_read_b64_tr_b16 v[196:197], v3 offset:28672
  ds_read_b64_tr_b16 v[198:199], v3 offset:30720
  ds_read_b64_tr_b16 v[200:201], v4 offset:28672
  ds_read_b64_tr_b16 v[202:203], v4 offset:30720
  ds_read_b64_tr_b16 v[204:205], v5 offset:28672
  ds_read_b64_tr_b16 v[206:207], v5 offset:30720
  s_waitcnt lgkmcnt(0)
  s_waitcnt vmcnt(8)
  ds_read_b64_tr_b16 v[208:209], v3 offset:32768
  ds_read_b64_tr_b16 v[210:211], v3 offset:34816
  ds_read_b64_tr_b16 v[212:213], v4 offset:32768
  ds_read_b64_tr_b16 v[214:215], v4 offset:34816
  ds_read_b64_tr_b16 v[216:217], v5 offset:32768
  ds_read_b64_tr_b16 v[218:219], v5 offset:34816
  ds_read_b64_tr_b16 v[220:221], v3 offset:36864
  ds_read_b64_tr_b16 v[222:223], v3 offset:38912
  ds_read_b64_tr_b16 v[224:225], v4 offset:36864
  ds_read_b64_tr_b16 v[226:227], v4 offset:38912
  ds_read_b64_tr_b16 v[228:229], v5 offset:36864
  ds_read_b64_tr_b16 v[230:231], v5 offset:38912
  s_waitcnt lgkmcnt(0)
  s_waitcnt vmcnt(0)
  ds_read_b64_tr_b16 v[232:233], v3 offset:0
  ds_read_b64_tr_b16 v[234:235], v3 offset:2048
  ds_read_b64_tr_b16 v[236:237], v4 offset:0
  ds_read_b64_tr_b16 v[238:239], v4 offset:2048
  ds_read_b64_tr_b16 v[240:241], v5 offset:0
  ds_read_b64_tr_b16 v[242:243], v5 offset:2048
  ds_read_b64_tr_b16 v[244:245], v3 offset:4096
  ds_read_b64_tr_b16 v[246:247], v3 offset:6144
  ds_read_b64_tr_b16 v[248:249], v4 offset:4096
  ds_read_b64_tr_b16 v[250:251], v4 offset:6144
  ds_read_b64_tr_b16 v[252:253], v5 offset:4096
  ds_read_b64_tr_b16 v[254:255], v5 offset:6144
  s_waitcnt lgkmcnt(0)
  s_mov_b32 s64, s40
  s_mov_b32 s65, s41
  s_mov_b32 s66, 2359296
  s_mov_b32 s67, 0x20000
  s_barrier
  s_cmp_lg_u32 s3, 0
  s_cbranch_scc1 L_wg_38
  s_mov_b32 s46, 24576
  v_mov_b32 v28, 0
L_wf_39:
  buffer_load_dword v29, v28, s[48:51], s46 offen sc1
  s_waitcnt vmcnt(0)
  v_readfirstlane_b32 s4, v29
  s_nop 1
  s_cmp_ge_u32 s4, 8
  s_cbranch_scc1 L_wfd_40
  s_sleep 3
  s_add_u32 s47, s47, 1
  s_cmp_gt_u32 s47, 131072
  s_cbranch_scc1 L_exit
  s_branch L_wf_39
L_wfd_40:
L_wg_38:
  s_barrier
  s_add_u32 s77, s68, 5
  s_cmp_ge_u32 s77, 18
  s_cbranch_scc0 L_t5_g1
  s_sub_u32 s77, s77, 18
L_t5_g1:
  s_mov_b32 s76, 0
L_t5_loop:
  s_and_b32 s4, s76, 1
  s_cmp_lt_u32 s68, 13
  s_cselect_b32 s5, 0, 1
  s_xor_b32 s75, s4, s5
  s_lshr_b32 s4, s76, 1
  s_mul_i32 s4, s4, 18
  s_cmp_eq_u32 s75, 0
  s_cselect_b32 s5, s68, s77
  s_add_u32 s70, s4, s5
  s_cmp_ge_u32 s70, 64
  s_cbranch_scc1 L_t5_next
  s_cmp_lg_u32 s75, 0
  s_cbranch_scc1 L_t4_skip
  s_lshl_b32 s15, s69, 2
  s_add_u32 s15, s15, s3
  s_cmp_ge_u32 s15, 32
  s_cbranch_scc1 L_t4_skip
  s_lshr_b32 s5, s70, 1
  s_lshl_b32 s5, s5, 7
  s_add_u32 s73, s5, 0
  v_mov_b32 v124, 0
L_wf_41:
  buffer_load_dword v125, v124, s[48:51], s73 offen sc1
  s_waitcnt vmcnt(0)
  v_readfirstlane_b32 s4, v125
  s_nop 1
  s_cmp_ge_u32 s4, 32
  s_cbranch_scc1 L_wfd_42
  s_sleep 3
  s_add_u32 s47, s47, 1
  s_cmp_gt_u32 s47, 131072
  s_cbranch_scc1 L_exit
  s_branch L_wf_41
L_wfd_42:
  s_add_u32 s73, s5, 4096
  v_mov_b32 v124, 0
L_wf_43:
  buffer_load_dword v125, v124, s[48:51], s73 offen sc1
  s_waitcnt vmcnt(0)
  v_readfirstlane_b32 s4, v125
  s_nop 1
  s_cmp_ge_u32 s4, 16
  s_cbranch_scc1 L_wfd_44
  s_sleep 3
  s_add_u32 s47, s47, 1
  s_cmp_gt_u32 s47, 131072
  s_cbranch_scc1 L_exit
  s_branch L_wf_43
L_wfd_44:
  s_lshl_b32 s4, s70, 5
  s_add_u32 s4, s4, s15
  s_lshl_b32 s72, s4, 13
  s_add_u32 s74, s72, 34603008
  buffer_load_dwordx4 v[12:15], v2, s[48:51], s74 offen offset:0 sc1
  buffer_load_dwordx4 v[16:19], v2, s[48:51], s74 offen offset:1024 sc1
  buffer_load_dwordx4 v[20:23], v2, s[48:51], s74 offen offset:2048 sc1
  buffer_load_dwordx4 v[24:27], v2, s[48:51], s74 offen offset:3072 sc1
  s_add_u32 s74, s74, 4096
  buffer_load_dwordx4 v[28:31], v2, s[48:51], s74 offen offset:0 sc1
  buffer_load_dwordx4 v[32:35], v2, s[48:51], s74 offen offset:1024 sc1
  buffer_load_dwordx4 v[36:39], v2, s[48:51], s74 offen offset:2048 sc1
  buffer_load_dwordx4 v[40:43], v2, s[48:51], s74 offen offset:3072 sc1
  s_add_u32 s74, s72, 1048576
  buffer_load_dwordx4 v[44:47], v2, s[48:51], s74 offen offset:0 sc1
  buffer_load_dwordx4 v[48:51], v2, s[48:51], s74 offen offset:1024 sc1
  buffer_load_dwordx4 v[52:55], v2, s[48:51], s74 offen offset:2048 sc1
  buffer_load_dwordx4 v[56:59], v2, s[48:51], s74 offen offset:3072 sc1
  s_add_u32 s74, s74, 4096
  buffer_load_dwordx4 v[60:63], v2, s[48:51], s74 offen offset:0 sc1
  buffer_load_dwordx4 v[64:67], v2, s[48:51], s74 offen offset:1024 sc1
  buffer_load_dwordx4 v[68:71], v2, s[48:51], s74 offen offset:2048 sc1
  buffer_load_dwordx4 v[72:75], v2, s[48:51], s74 offen offset:3072 sc1
  s_waitcnt vmcnt(0)
  v_mfma_f32_16x16x32_bf16 v[84:87], v[44:47], v[12:15], 0
  v_mfma_f32_16x16x32_bf16 v[84:87], v[48:51], v[16:19], v[84:87]
  v_mfma_f32_16x16x32_bf16 v[84:87], v[52:55], v[20:23], v[84:87]
  v_mfma_f32_16x16x32_bf16 v[84:87], v[56:59], v[24:27], v[84:87]
  v_mfma_f32_16x16x32_bf16 v[88:91], v[44:47], v[28:31], 0
  v_mfma_f32_16x16x32_bf16 v[88:91], v[48:51], v[32:35], v[88:91]
  v_mfma_f32_16x16x32_bf16 v[88:91], v[52:55], v[36:39], v[88:91]
  v_mfma_f32_16x16x32_bf16 v[88:91], v[56:59], v[40:43], v[88:91]
  v_mfma_f32_16x16x32_bf16 v[96:99], v[60:63], v[28:31], 0
  v_mfma_f32_16x16x32_bf16 v[96:99], v[64:67], v[32:35], v[96:99]
  v_mfma_f32_16x16x32_bf16 v[96:99], v[68:71], v[36:39], v[96:99]
  v_mfma_f32_16x16x32_bf16 v[96:99], v[72:75], v[40:43], v[96:99]
  s_nop 7
  s_add_u32 s74, s72, 17825792
  buffer_load_dwordx4 v[44:47], v2, s[48:51], s74 offen offset:0 sc1
  buffer_load_dwordx4 v[48:51], v2, s[48:51], s74 offen offset:1024 sc1
  buffer_load_dwordx4 v[52:55], v2, s[48:51], s74 offen offset:2048 sc1
  buffer_load_dwordx4 v[56:59], v2, s[48:51], s74 offen offset:3072 sc1
  s_add_u32 s74, s74, 4096
  buffer_load_dwordx4 v[60:63], v2, s[48:51], s74 offen offset:0 sc1
  buffer_load_dwordx4 v[64:67], v2, s[48:51], s74 offen offset:1024 sc1
  buffer_load_dwordx4 v[68:71], v2, s[48:51], s74 offen offset:2048 sc1
  buffer_load_dwordx4 v[72:75], v2, s[48:51], s74 offen offset:3072 sc1
  s_lshl_b32 s5, s15, 7
  s_add_u32 s73, s5, 20480
  s_add_u32 s7, s70, 1
  s_min_u32 s7, s7, 63
  v_mov_b32 v124, 0
L_pg_45:
  buffer_load_dword v100, v124, s[48:51], s73 offen sc1
  s_waitcnt vmcnt(0)
  v_readfirstlane_b32 s4, v100
  s_nop 1
  s_cmp_ge_u32 s4, s7
  s_cbranch_scc1 L_pgd_46
  s_add_u32 s47, s47, 1
  s_cmp_gt_u32 s47, 131072
  s_cbranch_scc1 L_exit
  s_sub_u32 s4, s7, s4
  s_cmp_le_u32 s4, 3
  s_cbranch_scc1 L_pgs_47
  s_sleep 32
  s_branch L_pg_45
L_pgs_47:
  s_sleep 1
  s_branch L_pg_45
L_pgd_46:
  s_lshl_b32 s4, s70, 5
  s_add_u32 s4, s4, s15
  s_lshl_b32 s5, s4, 12
  s_add_u32 s74, s5, 51380224
L_km_48:
  buffer_load_dwordx4 v[100:103], v2, s[48:51], s74 offen offset:0 sc1
  buffer_load_dwordx4 v[104:107], v2, s[48:51], s74 offen offset:1024 sc1
  buffer_load_dwordx4 v[108:111], v2, s[48:51], s74 offen offset:2048 sc1
  buffer_load_dwordx4 v[112:115], v2, s[48:51], s74 offen offset:3072 sc1
  s_cmp_lg_u32 s70, 63
  s_cbranch_scc1 L_kmd_49
  s_waitcnt vmcnt(0)
  v_max3_u32 v124, v100, v104, v108
  v_max_u32 v124, v124, v112
  v_cmp_eq_u32 vcc, -1, v124
  s_cbranch_vccz L_kmd_49
  s_add_u32 s47, s47, 1
  s_cmp_gt_u32 s47, 131072
  s_cbranch_scc1 L_exit
  s_branch L_km_48
L_kmd_49:
  s_lshl_b32 s5, s3, 12
  s_add_u32 s5, s5, 32768
  v_and_b32 v124, 15, v0
  v_lshlrev_b32 v124, 5, v124
  v_lshrrev_b32 v125, 4, v0
  v_lshlrev_b32 v125, 3, v125
  v_add3_u32 v124, v124, v125, s5
  v_lshrrev_b32 v125, 2, v0
  v_lshlrev_b32 v125, 5, v125
  v_and_b32 v126, 3, v0
  v_lshlrev_b32 v126, 3, v126
  v_add3_u32 v125, v125, v126, s5
  s_waitcnt vmcnt(0)
  v_mov_b32 v116, v101
  v_mov_b32 v117, v103
  v_mov_b32 v118, v105
  v_mov_b32 v119, v107
  v_mov_b32 v120, v109
  v_mov_b32 v121, v111
  v_mov_b32 v122, v113
  v_mov_b32 v123, v115
  ds_write_b64 v124, v[100:101] offset:0
  ds_write_b64 v124, v[102:103] offset:512
  ds_write_b64 v124, v[104:105] offset:1024
  ds_write_b64 v124, v[106:107] offset:1536
  ds_write_b64 v124, v[108:109] offset:2048
  ds_write_b64 v124, v[110:111] offset:2560
  ds_write_b64 v124, v[112:113] offset:3072
  ds_write_b64 v124, v[114:115] offset:3584
  s_waitcnt lgkmcnt(0)
  ds_read_b64_tr_b16 v[100:101], v125 offset:0
  ds_read_b64_tr_b16 v[102:103], v125 offset:512
  ds_read_b64_tr_b16 v[104:105], v125 offset:1024
  ds_read_b64_tr_b16 v[106:107], v125 offset:1536
  ds_read_b64_tr_b16 v[108:109], v125 offset:2048
  ds_read_b64_tr_b16 v[110:111], v125 offset:2560
  ds_read_b64_tr_b16 v[112:113], v125 offset:3072
  ds_read_b64_tr_b16 v[114:115], v125 offset:3584
  s_waitcnt lgkmcnt(0)
  v_mfma_f32_16x16x32_bf16 v[76:79], v[100:103], v[12:15], 0
  v_mfma_f32_16x16x32_bf16 v[76:79], v[104:107], v[16:19], v[76:79]
  v_mfma_f32_16x16x32_bf16 v[76:79], v[108:111], v[20:23], v[76:79]
  v_mfma_f32_16x16x32_bf16 v[76:79], v[112:115], v[24:27], v[76:79]
  v_mfma_f32_16x16x32_bf16 v[80:83], v[100:103], v[28:31], 0
  v_mfma_f32_16x16x32_bf16 v[80:83], v[104:107], v[32:35], v[80:83]
  v_mfma_f32_16x16x32_bf16 v[80:83], v[108:111], v[36:39], v[80:83]
  v_mfma_f32_16x16x32_bf16 v[80:83], v[112:115], v[40:43], v[80:83]
  s_nop 7
  v_lshrrev_b32 v124, 4, v0
  v_lshlrev_b32 v124, 2, v124
  v_and_b32 v125, 15, v0
  v_sub_u32 v124, v124, v125
  v_mov_b32 v125, 0xff800000
  v_cmp_lt_i32 vcc, 0, v124
  s_nop 1
  v_cndmask_b32 v84, v84, v125, vcc
  v_cmp_lt_i32 vcc, -1, v124
  s_nop 1
  v_cndmask_b32 v85, v85, v125, vcc
  v_cmp_lt_i32 vcc, -2, v124
  s_nop 1
  v_cndmask_b32 v86, v86, v125, vcc
  v_cmp_lt_i32 vcc, -3, v124
  s_nop 1
  v_cndmask_b32 v87, v87, v125, vcc
  v_cmp_lt_i32 vcc, 0, v124
  s_nop 1
  v_cndmask_b32 v96, v96, v125, vcc
  v_cmp_lt_i32 vcc, -1, v124
  s_nop 1
  v_cndmask_b32 v97, v97, v125, vcc
  v_cmp_lt_i32 vcc, -2, v124
  s_nop 1
  v_cndmask_b32 v98, v98, v125, vcc
  v_cmp_lt_i32 vcc, -3, v124
  s_nop 1
  v_cndmask_b32 v99, v99, v125, vcc
  s_mov_b32 s6, 0x3e0293ee
  v_max3_f32 v124, v76, v77, v84
  v_max3_f32 v124, v124, v85, v86
  v_max_f32 v124, v124, v87
  v_mov_b32 v125, v124
  s_nop 1
  v_permlane16_swap_b32 v124, v125
  s_nop 1
  v_max_f32 v124, v124, v125
  v_mov_b32 v125, v124
  s_nop 1
  v_permlane32_swap_b32 v124, v125
  s_nop 1
  v_max_f32 v124, v124, v125
  v_mul_f32 v124, s6, v124
  v_fma_f32 v76, v76, s6, -v124
  v_fma_f32 v77, v77, s6, -v124
  v_fma_f32 v84, v84, s6, -v124
  v_fma_f32 v85, v85, s6, -v124
  v_fma_f32 v86, v86, s6, -v124
  v_fma_f32 v87, v87, s6, -v124
  v_exp_f32 v76, v76
  v_exp_f32 v77, v77
  v_exp_f32 v84, v84
  v_exp_f32 v85, v85
  v_exp_f32 v86, v86
  v_exp_f32 v87, v87
  s_nop 0
  v_cvt_pk_bf16_f32 v12, v76, v77
  v_mov_b32 v13, 0
  v_cvt_pk_bf16_f32 v16, v84, v85
  v_cvt_pk_bf16_f32 v17, v86, v87
  v_mov_b32 v18, 0
  v_mov_b32 v19, 0
  v_max3_f32 v124, v80, v81, v88
  v_max3_f32 v124, v124, v89, v90
  v_max3_f32 v124, v124, v91, v96
  v_max3_f32 v124, v124, v97, v98
  v_max_f32 v124, v124, v99
  v_mov_b32 v125, v124
  s_nop 1
  v_permlane16_swap_b32 v124, v125
  s_nop 1
  v_max_f32 v124, v124, v125
  v_mov_b32 v125, v124
  s_nop 1
  v_permlane32_swap_b32 v124, v125
  s_nop 1
  v_max_f32 v124, v124, v125
  v_mul_f32 v124, s6, v124
  v_fma_f32 v80, v80, s6, -v124
  v_fma_f32 v81, v81, s6, -v124
  v_fma_f32 v88, v88, s6, -v124
  v_fma_f32 v89, v89, s6, -v124
  v_fma_f32 v90, v90, s6, -v124
  v_fma_f32 v91, v91, s6, -v124
  v_fma_f32 v96, v96, s6, -v124
  v_fma_f32 v97, v97, s6, -v124
  v_fma_f32 v98, v98, s6, -v124
  v_fma_f32 v99, v99, s6, -v124
  v_exp_f32 v80, v80
  v_exp_f32 v81, v81
  v_exp_f32 v88, v88
  v_exp_f32 v89, v89
  v_exp_f32 v90, v90
  v_exp_f32 v91, v91
  v_exp_f32 v96, v96
  v_exp_f32 v97, v97
  v_exp_f32 v98, v98
  v_exp_f32 v99, v99
  s_nop 0
  v_cvt_pk_bf16_f32 v20, v80, v81
  v_mov_b32 v21, 0
  v_cvt_pk_bf16_f32 v24, v88, v89
  v_cvt_pk_bf16_f32 v25, v90, v91
  v_cvt_pk_bf16_f32 v26, v96, v97
  v_cvt_pk_bf16_f32 v27, v98, v99
  v_mov_b32 v100, 0x3f803f80
  v_mov_b32 v101, 0x3f803f80
  v_mov_b32 v102, 0x3f803f80
  v_mov_b32 v103, 0x3f803f80
  s_waitcnt vmcnt(0)
  v_mov_b32 v28, v116
  v_mov_b32 v29, 0
  v_mov_b32 v30, v117
  v_mov_b32 v31, 0
  v_mov_b32 v32, v118
  v_mov_b32 v33, 0
  v_mov_b32 v34, v119
  v_mov_b32 v35, 0
  v_mov_b32 v36, v120
  v_mov_b32 v37, 0
  v_mov_b32 v38, v121
  v_mov_b32 v39, 0
  v_mov_b32 v40, v122
  v_mov_b32 v41, 0
  v_mov_b32 v42, v123
  v_mov_b32 v43, 0
  s_nop 1
  s_lshl_b32 s4, s70, 7
  s_lshl_b32 s5, s15, 2
  s_add_u32 s4, s4, s5
  s_lshl_b32 s4, s4, 11
  s_add_u32 s74, s4, 68157440
  v_mfma_f32_16x16x32_bf16 v[104:107], v[100:103], v[16:19], 0
  v_mfma_f32_16x16x32_bf16 v[76:79], v[44:47], v[16:19], 0
  v_mfma_f32_16x16x32_bf16 v[80:83], v[48:51], v[16:19], 0
  v_mfma_f32_16x16x32_bf16 v[84:87], v[52:55], v[16:19], 0
  v_mfma_f32_16x16x32_bf16 v[88:91], v[56:59], v[16:19], 0
  v_mfma_f32_16x16x16_bf16 v[104:107], v[100:101], v[12:13], v[104:107]
  v_mfma_f32_16x16x16_bf16 v[76:79], v[28:29], v[12:13], v[76:79]
  v_mfma_f32_16x16x16_bf16 v[80:83], v[30:31], v[12:13], v[80:83]
  v_mfma_f32_16x16x16_bf16 v[84:87], v[32:33], v[12:13], v[84:87]
  v_mfma_f32_16x16x16_bf16 v[88:91], v[34:35], v[12:13], v[88:91]
  s_nop 7
  v_rcp_f32 v124, v104
  s_nop 0
  v_mul_f32 v76, v76, v124
  v_mul_f32 v77, v77, v124
  v_mul_f32 v78, v78, v124
  v_mul_f32 v79, v79, v124
  v_mul_f32 v80, v80, v124
  v_mul_f32 v81, v81, v124
  v_mul_f32 v82, v82, v124
  v_mul_f32 v83, v83, v124
  v_mul_f32 v84, v84, v124
  v_mul_f32 v85, v85, v124
  v_mul_f32 v86, v86, v124
  v_mul_f32 v87, v87, v124
  v_mul_f32 v88, v88, v124
  v_mul_f32 v89, v89, v124
  v_mul_f32 v90, v90, v124
  v_mul_f32 v91, v91, v124
  v_cvt_pk_bf16_f32 v92, v76, v77
  v_cvt_pk_bf16_f32 v93, v78, v79
  v_cvt_pk_bf16_f32 v94, v80, v81
  v_cvt_pk_bf16_f32 v95, v82, v83
  buffer_store_dwordx4 v[92:95], v2, s[48:51], s74 offen offset:0 sc1
  v_cvt_pk_bf16_f32 v96, v84, v85
  v_cvt_pk_bf16_f32 v97, v86, v87
  v_cvt_pk_bf16_f32 v98, v88, v89
  v_cvt_pk_bf16_f32 v99, v90, v91
  buffer_store_dwordx4 v[96:99], v2, s[48:51], s74 offen offset:2048 sc1
  s_nop 1
  v_mfma_f32_16x16x32_bf16 v[76:79], v[60:63], v[16:19], 0
  v_mfma_f32_16x16x32_bf16 v[80:83], v[64:67], v[16:19], 0
  v_mfma_f32_16x16x32_bf16 v[84:87], v[68:71], v[16:19], 0
  v_mfma_f32_16x16x32_bf16 v[88:91], v[72:75], v[16:19], 0
  v_mfma_f32_16x16x16_bf16 v[76:79], v[36:37], v[12:13], v[76:79]
  v_mfma_f32_16x16x16_bf16 v[80:83], v[38:39], v[12:13], v[80:83]
  v_mfma_f32_16x16x16_bf16 v[84:87], v[40:41], v[12:13], v[84:87]
  v_mfma_f32_16x16x16_bf16 v[88:91], v[42:43], v[12:13], v[88:91]
  s_nop 7
  v_mul_f32 v76, v76, v124
  v_mul_f32 v77, v77, v124
  v_mul_f32 v78, v78, v124
  v_mul_f32 v79, v79, v124
  v_mul_f32 v80, v80, v124
  v_mul_f32 v81, v81, v124
  v_mul_f32 v82, v82, v124
  v_mul_f32 v83, v83, v124
  v_mul_f32 v84, v84, v124
  v_mul_f32 v85, v85, v124
  v_mul_f32 v86, v86, v124
  v_mul_f32 v87, v87, v124
  v_mul_f32 v88, v88, v124
  v_mul_f32 v89, v89, v124
  v_mul_f32 v90, v90, v124
  v_mul_f32 v91, v91, v124
  v_cvt_pk_bf16_f32 v92, v76, v77
  v_cvt_pk_bf16_f32 v93, v78, v79
  v_cvt_pk_bf16_f32 v94, v80, v81
  v_cvt_pk_bf16_f32 v95, v82, v83
  s_add_u32 s73, s74, 4096
  buffer_store_dwordx4 v[92:95], v2, s[48:51], s73 offen offset:0 sc1
  v_cvt_pk_bf16_f32 v96, v84, v85
  v_cvt_pk_bf16_f32 v97, v86, v87
  v_cvt_pk_bf16_f32 v98, v88, v89
  v_cvt_pk_bf16_f32 v99, v90, v91
  s_add_u32 s73, s74, 4096
  buffer_store_dwordx4 v[96:99], v2, s[48:51], s73 offen offset:2048 sc1
  s_nop 1
  v_mfma_f32_16x16x32_bf16 v[104:107], v[100:103], v[24:27], 0
  v_mfma_f32_16x16x32_bf16 v[76:79], v[44:47], v[24:27], 0
  v_mfma_f32_16x16x32_bf16 v[80:83], v[48:51], v[24:27], 0
  v_mfma_f32_16x16x32_bf16 v[84:87], v[52:55], v[24:27], 0
  v_mfma_f32_16x16x32_bf16 v[88:91], v[56:59], v[24:27], 0
  v_mfma_f32_16x16x16_bf16 v[104:107], v[100:101], v[20:21], v[104:107]
  v_mfma_f32_16x16x16_bf16 v[76:79], v[28:29], v[20:21], v[76:79]
  v_mfma_f32_16x16x16_bf16 v[80:83], v[30:31], v[20:21], v[80:83]
  v_mfma_f32_16x16x16_bf16 v[84:87], v[32:33], v[20:21], v[84:87]
  v_mfma_f32_16x16x16_bf16 v[88:91], v[34:35], v[20:21], v[88:91]
  s_nop 7
  v_rcp_f32 v124, v104
  s_nop 0
  v_mul_f32 v76, v76, v124
  v_mul_f32 v77, v77, v124
  v_mul_f32 v78, v78, v124
  v_mul_f32 v79, v79, v124
  v_mul_f32 v80, v80, v124
  v_mul_f32 v81, v81, v124
  v_mul_f32 v82, v82, v124
  v_mul_f32 v83, v83, v124
  v_mul_f32 v84, v84, v124
  v_mul_f32 v85, v85, v124
  v_mul_f32 v86, v86, v124
  v_mul_f32 v87, v87, v124
  v_mul_f32 v88, v88, v124
  v_mul_f32 v89, v89, v124
  v_mul_f32 v90, v90, v124
  v_mul_f32 v91, v91, v124
  v_cvt_pk_bf16_f32 v92, v76, v77
  v_cvt_pk_bf16_f32 v93, v78, v79
  v_cvt_pk_bf16_f32 v94, v80, v81
  v_cvt_pk_bf16_f32 v95, v82, v83
  buffer_store_dwordx4 v[92:95], v2, s[48:51], s74 offen offset:1024 sc1
  v_cvt_pk_bf16_f32 v96, v84, v85
  v_cvt_pk_bf16_f32 v97, v86, v87
  v_cvt_pk_bf16_f32 v98, v88, v89
  v_cvt_pk_bf16_f32 v99, v90, v91
  buffer_store_dwordx4 v[96:99], v2, s[48:51], s74 offen offset:3072 sc1
  s_nop 1
  v_mfma_f32_16x16x32_bf16 v[76:79], v[60:63], v[24:27], 0
  v_mfma_f32_16x16x32_bf16 v[80:83], v[64:67], v[24:27], 0
  v_mfma_f32_16x16x32_bf16 v[84:87], v[68:71], v[24:27], 0
  v_mfma_f32_16x16x32_bf16 v[88:91], v[72:75], v[24:27], 0
  v_mfma_f32_16x16x16_bf16 v[76:79], v[36:37], v[20:21], v[76:79]
  v_mfma_f32_16x16x16_bf16 v[80:83], v[38:39], v[20:21], v[80:83]
  v_mfma_f32_16x16x16_bf16 v[84:87], v[40:41], v[20:21], v[84:87]
  v_mfma_f32_16x16x16_bf16 v[88:91], v[42:43], v[20:21], v[88:91]
  s_nop 7
  v_mul_f32 v76, v76, v124
  v_mul_f32 v77, v77, v124
  v_mul_f32 v78, v78, v124
  v_mul_f32 v79, v79, v124
  v_mul_f32 v80, v80, v124
  v_mul_f32 v81, v81, v124
  v_mul_f32 v82, v82, v124
  v_mul_f32 v83, v83, v124
  v_mul_f32 v84, v84, v124
  v_mul_f32 v85, v85, v124
  v_mul_f32 v86, v86, v124
  v_mul_f32 v87, v87, v124
  v_mul_f32 v88, v88, v124
  v_mul_f32 v89, v89, v124
  v_mul_f32 v90, v90, v124
  v_mul_f32 v91, v91, v124
  v_cvt_pk_bf16_f32 v92, v76, v77
  v_cvt_pk_bf16_f32 v93, v78, v79
  v_cvt_pk_bf16_f32 v94, v80, v81
  v_cvt_pk_bf16_f32 v95, v82, v83
  s_add_u32 s73, s74, 4096
  buffer_store_dwordx4 v[92:95], v2, s[48:51], s73 offen offset:1024 sc1
  v_cvt_pk_bf16_f32 v96, v84, v85
  v_cvt_pk_bf16_f32 v97, v86, v87
  v_cvt_pk_bf16_f32 v98, v88, v89
  v_cvt_pk_bf16_f32 v99, v90, v91
  s_add_u32 s73, s74, 4096
  buffer_store_dwordx4 v[96:99], v2, s[48:51], s73 offen offset:3072 sc1
  s_nop 1
  s_waitcnt vmcnt(0)
  s_lshl_b32 s5, s70, 7
  s_add_u32 s73, s5, 12288
  s_mov_b64 s[8:9], exec
  s_mov_b64 exec, 1
  v_mov_b32 v124, 0
  v_mov_b32 v125, 1
  buffer_atomic_add v125, v124, s[48:51], s73 offen
  s_mov_b64 exec, s[8:9]
L_t4_skip:
  s_cmp_eq_u32 s70, 63
  s_cbranch_scc1 L_t5_last
  s_lshl_b32 s5, s70, 7
  s_add_u32 s73, s5, 12288
  s_cmp_lg_u32 s3, 0
  s_cbranch_scc1 L_wg_50
  v_mov_b32 v76, 0
L_wf_51:
  buffer_load_dword v77, v76, s[48:51], s73 offen sc1
  s_waitcnt vmcnt(0)
  v_readfirstlane_b32 s4, v77
  s_nop 1
  s_cmp_ge_u32 s4, 32
  s_cbranch_scc1 L_wfd_52
  s_sleep 3
  s_add_u32 s47, s47, 1
  s_cmp_gt_u32 s47, 131072
  s_cbranch_scc1 L_exit
  s_branch L_wf_51
L_wfd_52:
L_wg_50:
  s_barrier
  s_mul_i32 s71, s70, 262144
  s_mul_i32 s4, s3, 65536
  s_add_u32 s71, s71, s4
  s_lshl_b32 s4, s75, 10
  s_add_u32 s71, s71, s4
  s_add_u32 s71, s71, 68157440
  s_add_u32 s72, s71, 0
  buffer_load_dwordx4 v[36:39], v2, s[48:51], s72 offen offset:0 sc1
  buffer_load_dwordx4 v[40:43], v2, s[48:51], s72 offen offset:2048 sc1
  s_add_u32 s72, s71, 4096
  buffer_load_dwordx4 v[44:47], v2, s[48:51], s72 offen offset:0 sc1
  buffer_load_dwordx4 v[48:51], v2, s[48:51], s72 offen offset:2048 sc1
  s_add_u32 s72, s71, 8192
  buffer_load_dwordx4 v[52:55], v2, s[48:51], s72 offen offset:0 sc1
  buffer_load_dwordx4 v[56:59], v2, s[48:51], s72 offen offset:2048 sc1
  s_add_u32 s72, s71, 12288
  buffer_load_dwordx4 v[60:63], v2, s[48:51], s72 offen offset:0 sc1
  buffer_load_dwordx4 v[64:67], v2, s[48:51], s72 offen offset:2048 sc1
  s_add_u32 s72, s71, 16384
  buffer_load_dwordx4 v[68:71], v2, s[48:51], s72 offen offset:0 sc1
  buffer_load_dwordx4 v[72:75], v2, s[48:51], s72 offen offset:2048 sc1
  s_add_u32 s72, s71, 20480
  buffer_load_dwordx4 v[76:79], v2, s[48:51], s72 offen offset:0 sc1
  buffer_load_dwordx4 v[80:83], v2, s[48:51], s72 offen offset:2048 sc1
  s_add_u32 s72, s71, 24576
  buffer_load_dwordx4 v[84:87], v2, s[48:51], s72 offen offset:0 sc1
  buffer_load_dwordx4 v[88:91], v2, s[48:51], s72 offen offset:2048 sc1
  s_add_u32 s72, s71, 28672
  buffer_load_dwordx4 v[92:95], v2, s[48:51], s72 offen offset:0 sc1
  buffer_load_dwordx4 v[96:99], v2, s[48:51], s72 offen offset:2048 sc1
  s_add_u32 s72, s71, 32768
  buffer_load_dwordx4 v[100:103], v2, s[48:51], s72 offen offset:0 sc1
  buffer_load_dwordx4 v[104:107], v2, s[48:51], s72 offen offset:2048 sc1
  s_add_u32 s72, s71, 36864
  buffer_load_dwordx4 v[108:111], v2, s[48:51], s72 offen offset:0 sc1
  buffer_load_dwordx4 v[112:115], v2, s[48:51], s72 offen offset:2048 sc1
  s_add_u32 s72, s71, 40960
  buffer_load_dwordx4 v[116:119], v2, s[48:51], s72 offen offset:0 sc1
  buffer_load_dwordx4 v[120:123], v2, s[48:51], s72 offen offset:2048 sc1
  s_waitcnt vmcnt(21)
  v_mfma_f32_16x16x32_bf16 v[12:15], a[0:3], v[36:39], 0
  v_mfma_f32_16x16x32_bf16 v[16:19], a[4:7], v[36:39], 0
  v_mfma_f32_16x16x32_bf16 v[20:23], a[8:11], v[36:39], 0
  s_add_u32 s72, s71, 45056
  buffer_load_dwordx4 v[36:39], v2, s[48:51], s72 offen offset:0 sc1
  s_waitcnt vmcnt(21)
  v_mfma_f32_16x16x32_bf16 v[12:15], a[12:15], v[40:43], v[12:15]
  v_mfma_f32_16x16x32_bf16 v[16:19], a[16:19], v[40:43], v[16:19]
  v_mfma_f32_16x16x32_bf16 v[20:23], a[20:23], v[40:43], v[20:23]
  buffer_load_dwordx4 v[40:43], v2, s[48:51], s72 offen offset:2048 sc1
  s_waitcnt vmcnt(21)
  v_mfma_f32_16x16x32_bf16 v[12:15], a[24:27], v[44:47], v[12:15]
  v_mfma_f32_16x16x32_bf16 v[16:19], a[28:31], v[44:47], v[16:19]
  v_mfma_f32_16x16x32_bf16 v[20:23], a[32:35], v[44:47], v[20:23]
  s_add_u32 s72, s71, 49152
  buffer_load_dwordx4 v[44:47], v2, s[48:51], s72 offen offset:0 sc1
  s_waitcnt vmcnt(21)
  v_mfma_f32_16x16x32_bf16 v[12:15], a[36:39], v[48:51], v[12:15]
  v_mfma_f32_16x16x32_bf16 v[16:19], a[40:43], v[48:51], v[16:19]
  v_mfma_f32_16x16x32_bf16 v[20:23], a[44:47], v[48:51], v[20:23]
  buffer_load_dwordx4 v[48:51], v2, s[48:51], s72 offen offset:2048 sc1
  s_waitcnt vmcnt(21)
  v_mfma_f32_16x16x32_bf16 v[12:15], a[48:51], v[52:55], v[12:15]
  v_mfma_f32_16x16x32_bf16 v[16:19], a[52:55], v[52:55], v[16:19]
  v_mfma_f32_16x16x32_bf16 v[20:23], a[56:59], v[52:55], v[20:23]
  s_add_u32 s72, s71, 53248
  buffer_load_dwordx4 v[52:55], v2, s[48:51], s72 offen offset:0 sc1
  s_waitcnt vmcnt(21)
  v_mfma_f32_16x16x32_bf16 v[12:15], a[60:63], v[56:59], v[12:15]
  v_mfma_f32_16x16x32_bf16 v[16:19], a[64:67], v[56:59], v[16:19]
  v_mfma_f32_16x16x32_bf16 v[20:23], a[68:71], v[56:59], v[20:23]
  buffer_load_dwordx4 v[56:59], v2, s[48:51], s72 offen offset:2048 sc1
  s_waitcnt vmcnt(21)
  v_mfma_f32_16x16x32_bf16 v[12:15], a[72:75], v[60:63], v[12:15]
  v_mfma_f32_16x16x32_bf16 v[16:19], a[76:79], v[60:63], v[16:19]
  v_mfma_f32_16x16x32_bf16 v[20:23], a[80:83], v[60:63], v[20:23]
  s_add_u32 s72, s71, 57344
  buffer_load_dwordx4 v[60:63], v2, s[48:51], s72 offen offset:0 sc1
  s_waitcnt vmcnt(21)
  v_mfma_f32_16x16x32_bf16 v[12:15], a[84:87], v[64:67], v[12:15]
  v_mfma_f32_16x16x32_bf16 v[16:19], a[88:91], v[64:67], v[16:19]
  v_mfma_f32_16x16x32_bf16 v[20:23], a[92:95], v[64:67], v[20:23]
  buffer_load_dwordx4 v[64:67], v2, s[48:51], s72 offen offset:2048 sc1
  s_waitcnt vmcnt(21)
  v_mfma_f32_16x16x32_bf16 v[12:15], a[96:99], v[68:71], v[12:15]
  v_mfma_f32_16x16x32_bf16 v[16:19], a[100:103], v[68:71], v[16:19]
  v_mfma_f32_16x16x32_bf16 v[20:23], a[104:107], v[68:71], v[20:23]
  s_add_u32 s72, s71, 61440
  buffer_load_dwordx4 v[68:71], v2, s[48:51], s72 offen offset:0 sc1
  s_waitcnt vmcnt(21)
  v_mfma_f32_16x16x32_bf16 v[12:15], a[108:111], v[72:75], v[12:15]
  v_mfma_f32_16x16x32_bf16 v[16:19], a[112:115], v[72:75], v[16:19]
  v_mfma_f32_16x16x32_bf16 v[20:23], a[116:119], v[72:75], v[20:23]
  buffer_load_dwordx4 v[72:75], v2, s[48:51], s72 offen offset:2048 sc1
  s_waitcnt vmcnt(21)
  v_mfma_f32_16x16x32_bf16 v[12:15], a[120:123], v[76:79], v[12:15]
  v_mfma_f32_16x16x32_bf16 v[16:19], a[124:127], v[76:79], v[16:19]
  v_mfma_f32_16x16x32_bf16 v[20:23], a[128:131], v[76:79], v[20:23]
  s_waitcnt vmcnt(20)
  v_mfma_f32_16x16x32_bf16 v[12:15], a[132:135], v[80:83], v[12:15]
  v_mfma_f32_16x16x32_bf16 v[16:19], a[136:139], v[80:83], v[16:19]
  v_mfma_f32_16x16x32_bf16 v[20:23], a[140:143], v[80:83], v[20:23]
  s_waitcnt vmcnt(19)
  v_mfma_f32_16x16x32_bf16 v[12:15], a[144:147], v[84:87], v[12:15]
  v_mfma_f32_16x16x32_bf16 v[16:19], a[148:151], v[84:87], v[16:19]
  v_mfma_f32_16x16x32_bf16 v[20:23], a[152:155], v[84:87], v[20:23]
  s_waitcnt vmcnt(18)
  v_mfma_f32_16x16x32_bf16 v[12:15], a[156:159], v[88:91], v[12:15]
  v_mfma_f32_16x16x32_bf16 v[16:19], a[160:163], v[88:91], v[16:19]
  v_mfma_f32_16x16x32_bf16 v[20:23], a[164:167], v[88:91], v[20:23]
  s_waitcnt vmcnt(17)
  v_mfma_f32_16x16x32_bf16 v[12:15], a[168:171], v[92:95], v[12:15]
  v_mfma_f32_16x16x32_bf16 v[16:19], a[172:175], v[92:95], v[16:19]
  v_mfma_f32_16x16x32_bf16 v[20:23], a[176:179], v[92:95], v[20:23]
  s_waitcnt vmcnt(16)
  v_mfma_f32_16x16x32_bf16 v[12:15], a[180:183], v[96:99], v[12:15]
  v_mfma_f32_16x16x32_bf16 v[16:19], a[184:187], v[96:99], v[16:19]
  v_mfma_f32_16x16x32_bf16 v[20:23], a[188:191], v[96:99], v[20:23]
  s_waitcnt vmcnt(15)
  v_mfma_f32_16x16x32_bf16 v[12:15], a[192:195], v[100:103], v[12:15]
  v_mfma_f32_16x16x32_bf16 v[16:19], a[196:199], v[100:103], v[16:19]
  v_mfma_f32_16x16x32_bf16 v[20:23], a[200:203], v[100:103], v[20:23]
  s_waitcnt vmcnt(14)
  v_mfma_f32_16x16x32_bf16 v[12:15], a[204:207], v[104:107], v[12:15]
  v_mfma_f32_16x16x32_bf16 v[16:19], a[208:211], v[104:107], v[16:19]
  v_mfma_f32_16x16x32_bf16 v[20:23], a[212:215], v[104:107], v[20:23]
  s_waitcnt vmcnt(13)
  v_mfma_f32_16x16x32_bf16 v[12:15], a[216:219], v[108:111], v[12:15]
  v_mfma_f32_16x16x32_bf16 v[16:19], a[220:223], v[108:111], v[16:19]
  v_mfma_f32_16x16x32_bf16 v[20:23], a[224:227], v[108:111], v[20:23]
  s_waitcnt vmcnt(12)
  v_mfma_f32_16x16x32_bf16 v[12:15], a[228:231], v[112:115], v[12:15]
  v_mfma_f32_16x16x32_bf16 v[16:19], a[232:235], v[112:115], v[16:19]
  v_mfma_f32_16x16x32_bf16 v[20:23], a[236:239], v[112:115], v[20:23]
  s_waitcnt vmcnt(11)
  v_mfma_f32_16x16x32_bf16 v[12:15], a[240:243], v[116:119], v[12:15]
  v_mfma_f32_16x16x32_bf16 v[16:19], a[244:247], v[116:119], v[16:19]
  v_mfma_f32_16x16x32_bf16 v[20:23], a[248:251], v[116:119], v[20:23]
  s_waitcnt vmcnt(10)
  v_mfma_f32_16x16x32_bf16 v[12:15], a[252:255], v[120:123], v[12:15]
  v_mfma_f32_16x16x32_bf16 v[16:19], v[128:131], v[120:123], v[16:19]
  v_mfma_f32_16x16x32_bf16 v[20:23], v[132:135], v[120:123], v[20:23]
  s_waitcnt vmcnt(9)
  v_mfma_f32_16x16x32_bf16 v[12:15], v[136:139], v[36:39], v[12:15]
  v_mfma_f32_16x16x32_bf16 v[16:19], v[140:143], v[36:39], v[16:19]
  v_mfma_f32_16x16x32_bf16 v[20:23], v[144:147], v[36:39], v[20:23]
  s_waitcnt vmcnt(8)
  v_mfma_f32_16x16x32_bf16 v[12:15], v[148:151], v[40:43], v[12:15]
  v_mfma_f32_16x16x32_bf16 v[16:19], v[152:155], v[40:43], v[16:19]
  v_mfma_f32_16x16x32_bf16 v[20:23], v[156:159], v[40:43], v[20:23]
  s_waitcnt vmcnt(7)
  v_mfma_f32_16x16x32_bf16 v[12:15], v[160:163], v[44:47], v[12:15]
  v_mfma_f32_16x16x32_bf16 v[16:19], v[164:167], v[44:47], v[16:19]
  v_mfma_f32_16x16x32_bf16 v[20:23], v[168:171], v[44:47], v[20:23]
  s_waitcnt vmcnt(6)
  v_mfma_f32_16x16x32_bf16 v[12:15], v[172:175], v[48:51], v[12:15]
  v_mfma_f32_16x16x32_bf16 v[16:19], v[176:179], v[48:51], v[16:19]
  v_mfma_f32_16x16x32_bf16 v[20:23], v[180:183], v[48:51], v[20:23]
  s_waitcnt vmcnt(5)
  v_mfma_f32_16x16x32_bf16 v[12:15], v[184:187], v[52:55], v[12:15]
  v_mfma_f32_16x16x32_bf16 v[16:19], v[188:191], v[52:55], v[16:19]
  v_mfma_f32_16x16x32_bf16 v[20:23], v[192:195], v[52:55], v[20:23]
  s_waitcnt vmcnt(4)
  v_mfma_f32_16x16x32_bf16 v[12:15], v[196:199], v[56:59], v[12:15]
  v_mfma_f32_16x16x32_bf16 v[16:19], v[200:203], v[56:59], v[16:19]
  v_mfma_f32_16x16x32_bf16 v[20:23], v[204:207], v[56:59], v[20:23]
  s_waitcnt vmcnt(3)
  v_mfma_f32_16x16x32_bf16 v[12:15], v[208:211], v[60:63], v[12:15]
  v_mfma_f32_16x16x32_bf16 v[16:19], v[212:215], v[60:63], v[16:19]
  v_mfma_f32_16x16x32_bf16 v[20:23], v[216:219], v[60:63], v[20:23]
  s_waitcnt vmcnt(2)
  v_mfma_f32_16x16x32_bf16 v[12:15], v[220:223], v[64:67], v[12:15]
  v_mfma_f32_16x16x32_bf16 v[16:19], v[224:227], v[64:67], v[16:19]
  v_mfma_f32_16x16x32_bf16 v[20:23], v[228:231], v[64:67], v[20:23]
  s_waitcnt vmcnt(1)
  v_mfma_f32_16x16x32_bf16 v[12:15], v[232:235], v[68:71], v[12:15]
  v_mfma_f32_16x16x32_bf16 v[16:19], v[236:239], v[68:71], v[16:19]
  v_mfma_f32_16x16x32_bf16 v[20:23], v[240:243], v[68:71], v[20:23]
  s_waitcnt vmcnt(0)
  v_mfma_f32_16x16x32_bf16 v[12:15], v[244:247], v[72:75], v[12:15]
  v_mfma_f32_16x16x32_bf16 v[16:19], v[248:251], v[72:75], v[16:19]
  v_mfma_f32_16x16x32_bf16 v[20:23], v[252:255], v[72:75], v[20:23]
  s_mul_i32 s4, s3, 3072
  v_add_u32 v7, s4, v2
  s_nop 7
  ds_write_b128 v7, v[12:15] offset:0
  ds_write_b128 v7, v[16:19] offset:1024
  ds_write_b128 v7, v[20:23] offset:2048
  s_waitcnt lgkmcnt(0)
  s_barrier
  s_lshl_b32 s4, s3, 10
  v_add_u32 v7, s4, v2
  ds_read_b128 v[36:39], v7 offset:0
  ds_read_b128 v[40:43], v7 offset:3072
  ds_read_b128 v[44:47], v7 offset:6144
  ds_read_b128 v[48:51], v7 offset:9216
  s_waitcnt lgkmcnt(0)
  v_add_f32 v36, v36, v40
  v_add_f32 v44, v44, v48
  v_add_f32 v37, v37, v41
  v_add_f32 v45, v45, v49
  v_add_f32 v38, v38, v42
  v_add_f32 v46, v46, v50
  v_add_f32 v39, v39, v43
  v_add_f32 v47, v47, v51
  v_add_f32 v12, v36, v44
  v_add_f32 v13, v37, v45
  v_add_f32 v14, v38, v46
  v_add_f32 v15, v39, v47
  s_barrier
  s_branch L_t5_epi
L_t5_last:
  s_mov_b32 s73, 20480
  s_cmp_lg_u32 s3, 0
  s_cbranch_scc1 L_wg_53
  v_mov_b32 v76, 0
L_wf_54:
  buffer_load_dword v77, v76, s[48:51], s73 offen sc1
  s_waitcnt vmcnt(0)
  v_readfirstlane_b32 s4, v77
  s_nop 1
  s_cmp_ge_u32 s4, 63
  s_cbranch_scc1 L_wfd_55
  s_sleep 24
  s_add_u32 s47, s47, 1
  s_cmp_gt_u32 s47, 131072
  s_cbranch_scc1 L_exit
  s_branch L_wf_54
L_wfd_55:
L_wg_53:
  s_barrier
  s_mul_i32 s71, s70, 262144
  s_mul_i32 s4, s3, 65536
  s_add_u32 s71, s71, s4
  s_lshl_b32 s4, s75, 10
  s_add_u32 s71, s71, s4
  s_add_u32 s71, s71, 68157440
  v_and_b32 v76, 31, v0
  v_lshlrev_b32 v76, 11, v76
  v_add_u32 v76, 1008, v76
L_pr_56:
  buffer_load_dword v77, v76, s[48:51], s71 offen sc1
  s_waitcnt vmcnt(0)
  v_cmp_eq_u32 vcc, -1, v77
  s_cbranch_vccz L_prd_57
  s_add_u32 s47, s47, 1
  s_cmp_gt_u32 s47, 131072
  s_cbranch_scc1 L_exit
  s_branch L_pr_56
L_prd_57:
  s_add_u32 s72, s71, 0
  buffer_load_dwordx4 v[36:39], v2, s[48:51], s72 offen offset:0 sc1
  buffer_load_dwordx4 v[40:43], v2, s[48:51], s72 offen offset:2048 sc1
  s_add_u32 s72, s71, 4096
  buffer_load_dwordx4 v[44:47], v2, s[48:51], s72 offen offset:0 sc1
  buffer_load_dwordx4 v[48:51], v2, s[48:51], s72 offen offset:2048 sc1
  s_add_u32 s72, s71, 8192
  buffer_load_dwordx4 v[52:55], v2, s[48:51], s72 offen offset:0 sc1
  buffer_load_dwordx4 v[56:59], v2, s[48:51], s72 offen offset:2048 sc1
  s_add_u32 s72, s71, 12288
  buffer_load_dwordx4 v[60:63], v2, s[48:51], s72 offen offset:0 sc1
  buffer_load_dwordx4 v[64:67], v2, s[48:51], s72 offen offset:2048 sc1
  s_add_u32 s72, s71, 16384
  buffer_load_dwordx4 v[68:71], v2, s[48:51], s72 offen offset:0 sc1
  buffer_load_dwordx4 v[72:75], v2, s[48:51], s72 offen offset:2048 sc1
  s_add_u32 s72, s71, 20480
  buffer_load_dwordx4 v[76:79], v2, s[48:51], s72 offen offset:0 sc1
  buffer_load_dwordx4 v[80:83], v2, s[48:51], s72 offen offset:2048 sc1
  s_add_u32 s72, s71, 24576
  buffer_load_dwordx4 v[84:87], v2, s[48:51], s72 offen offset:0 sc1
  buffer_load_dwordx4 v[88:91], v2, s[48:51], s72 offen offset:2048 sc1
  s_add_u32 s72, s71, 28672
  buffer_load_dwordx4 v[92:95], v2, s[48:51], s72 offen offset:0 sc1
  buffer_load_dwordx4 v[96:99], v2, s[48:51], s72 offen offset:2048 sc1
  s_add_u32 s72, s71, 32768
  buffer_load_dwordx4 v[100:103], v2, s[48:51], s72 offen offset:0 sc1
  buffer_load_dwordx4 v[104:107], v2, s[48:51], s72 offen offset:2048 sc1
  s_add_u32 s72, s71, 36864
  buffer_load_dwordx4 v[108:111], v2, s[48:51], s72 offen offset:0 sc1
  buffer_load_dwordx4 v[112:115], v2, s[48:51], s72 offen offset:2048 sc1
  s_add_u32 s72, s71, 40960
  buffer_load_dwordx4 v[116:119], v2, s[48:51], s72 offen offset:0 sc1
  buffer_load_dwordx4 v[120:123], v2, s[48:51], s72 offen offset:2048 sc1
  s_waitcnt vmcnt(21)
  v_cmp_eq_u32 vcc, -1, v36
  s_cbranch_vccnz L_gr_58
L_gb_59:
  v_mfma_f32_16x16x32_bf16 v[12:15], a[0:3], v[36:39], 0
  v_mfma_f32_16x16x32_bf16 v[16:19], a[4:7], v[36:39], 0
  v_mfma_f32_16x16x32_bf16 v[20:23], a[8:11], v[36:39], 0
  s_add_u32 s72, s71, 45056
  buffer_load_dwordx4 v[36:39], v2, s[48:51], s72 offen offset:0 sc1
  s_waitcnt vmcnt(21)
  v_cmp_eq_u32 vcc, -1, v40
  s_cbranch_vccnz L_gr_60
L_gb_61:
  v_mfma_f32_16x16x32_bf16 v[12:15], a[12:15], v[40:43], v[12:15]
  v_mfma_f32_16x16x32_bf16 v[16:19], a[16:19], v[40:43], v[16:19]
  v_mfma_f32_16x16x32_bf16 v[20:23], a[20:23], v[40:43], v[20:23]
  buffer_load_dwordx4 v[40:43], v2, s[48:51], s72 offen offset:2048 sc1
  s_waitcnt vmcnt(21)
  v_cmp_eq_u32 vcc, -1, v44
  s_cbranch_vccnz L_gr_62
L_gb_63:
  v_mfma_f32_16x16x32_bf16 v[12:15], a[24:27], v[44:47], v[12:15]
  v_mfma_f32_16x16x32_bf16 v[16:19], a[28:31], v[44:47], v[16:19]
  v_mfma_f32_16x16x32_bf16 v[20:23], a[32:35], v[44:47], v[20:23]
  s_add_u32 s72, s71, 49152
  buffer_load_dwordx4 v[44:47], v2, s[48:51], s72 offen offset:0 sc1
  s_waitcnt vmcnt(21)
  v_cmp_eq_u32 vcc, -1, v48
  s_cbranch_vccnz L_gr_64
L_gb_65:
  v_mfma_f32_16x16x32_bf16 v[12:15], a[36:39], v[48:51], v[12:15]
  v_mfma_f32_16x16x32_bf16 v[16:19], a[40:43], v[48:51], v[16:19]
  v_mfma_f32_16x16x32_bf16 v[20:23], a[44:47], v[48:51], v[20:23]
  buffer_load_dwordx4 v[48:51], v2, s[48:51], s72 offen offset:2048 sc1
  s_waitcnt vmcnt(21)
  v_cmp_eq_u32 vcc, -1, v52
  s_cbranch_vccnz L_gr_66
L_gb_67:
  v_mfma_f32_16x16x32_bf16 v[12:15], a[48:51], v[52:55], v[12:15]
  v_mfma_f32_16x16x32_bf16 v[16:19], a[52:55], v[52:55], v[16:19]
  v_mfma_f32_16x16x32_bf16 v[20:23], a[56:59], v[52:55], v[20:23]
  s_add_u32 s72, s71, 53248
  buffer_load_dwordx4 v[52:55], v2, s[48:51], s72 offen offset:0 sc1
  s_waitcnt vmcnt(21)
  v_cmp_eq_u32 vcc, -1, v56
  s_cbranch_vccnz L_gr_68
L_gb_69:
  v_mfma_f32_16x16x32_bf16 v[12:15], a[60:63], v[56:59], v[12:15]
  v_mfma_f32_16x16x32_bf16 v[16:19], a[64:67], v[56:59], v[16:19]
  v_mfma_f32_16x16x32_bf16 v[20:23], a[68:71], v[56:59], v[20:23]
  buffer_load_dwordx4 v[56:59], v2, s[48:51], s72 offen offset:2048 sc1
  s_waitcnt vmcnt(21)
  v_cmp_eq_u32 vcc, -1, v60
  s_cbranch_vccnz L_gr_70
L_gb_71:
  v_mfma_f32_16x16x32_bf16 v[12:15], a[72:75], v[60:63], v[12:15]
  v_mfma_f32_16x16x32_bf16 v[16:19], a[76:79], v[60:63], v[16:19]
  v_mfma_f32_16x16x32_bf16 v[20:23], a[80:83], v[60:63], v[20:23]
  s_add_u32 s72, s71, 57344
  buffer_load_dwordx4 v[60:63], v2, s[48:51], s72 offen offset:0 sc1
  s_waitcnt vmcnt(21)
  v_cmp_eq_u32 vcc, -1, v64
  s_cbranch_vccnz L_gr_72
L_gb_73:
  v_mfma_f32_16x16x32_bf16 v[12:15], a[84:87], v[64:67], v[12:15]
  v_mfma_f32_16x16x32_bf16 v[16:19], a[88:91], v[64:67], v[16:19]
  v_mfma_f32_16x16x32_bf16 v[20:23], a[92:95], v[64:67], v[20:23]
  buffer_load_dwordx4 v[64:67], v2, s[48:51], s72 offen offset:2048 sc1
  s_waitcnt vmcnt(21)
  v_cmp_eq_u32 vcc, -1, v68
  s_cbranch_vccnz L_gr_74
L_gb_75:
  v_mfma_f32_16x16x32_bf16 v[12:15], a[96:99], v[68:71], v[12:15]
  v_mfma_f32_16x16x32_bf16 v[16:19], a[100:103], v[68:71], v[16:19]
  v_mfma_f32_16x16x32_bf16 v[20:23], a[104:107], v[68:71], v[20:23]
  s_add_u32 s72, s71, 61440
  buffer_load_dwordx4 v[68:71], v2, s[48:51], s72 offen offset:0 sc1
  s_waitcnt vmcnt(21)
  v_cmp_eq_u32 vcc, -1, v72
  s_cbranch_vccnz L_gr_76
L_gb_77:
  v_mfma_f32_16x16x32_bf16 v[12:15], a[108:111], v[72:75], v[12:15]
  v_mfma_f32_16x16x32_bf16 v[16:19], a[112:115], v[72:75], v[16:19]
  v_mfma_f32_16x16x32_bf16 v[20:23], a[116:119], v[72:75], v[20:23]
  buffer_load_dwordx4 v[72:75], v2, s[48:51], s72 offen offset:2048 sc1
  s_waitcnt vmcnt(21)
  v_cmp_eq_u32 vcc, -1, v76
  s_cbranch_vccnz L_gr_78
L_gb_79:
  v_mfma_f32_16x16x32_bf16 v[12:15], a[120:123], v[76:79], v[12:15]
  v_mfma_f32_16x16x32_bf16 v[16:19], a[124:127], v[76:79], v[16:19]
  v_mfma_f32_16x16x32_bf16 v[20:23], a[128:131], v[76:79], v[20:23]
  s_waitcnt vmcnt(20)
  v_cmp_eq_u32 vcc, -1, v80
  s_cbranch_vccnz L_gr_80
L_gb_81:
  v_mfma_f32_16x16x32_bf16 v[12:15], a[132:135], v[80:83], v[12:15]
  v_mfma_f32_16x16x32_bf16 v[16:19], a[136:139], v[80:83], v[16:19]
  v_mfma_f32_16x16x32_bf16 v[20:23], a[140:143], v[80:83], v[20:23]
  s_waitcnt vmcnt(19)
  v_cmp_eq_u32 vcc, -1, v84
  s_cbranch_vccnz L_gr_82
L_gb_83:
  v_mfma_f32_16x16x32_bf16 v[12:15], a[144:147], v[84:87], v[12:15]
  v_mfma_f32_16x16x32_bf16 v[16:19], a[148:151], v[84:87], v[16:19]
  v_mfma_f32_16x16x32_bf16 v[20:23], a[152:155], v[84:87], v[20:23]
  s_waitcnt vmcnt(18)
  v_cmp_eq_u32 vcc, -1, v88
  s_cbranch_vccnz L_gr_84
L_gb_85:
  v_mfma_f32_16x16x32_bf16 v[12:15], a[156:159], v[88:91], v[12:15]
  v_mfma_f32_16x16x32_bf16 v[16:19], a[160:163], v[88:91], v[16:19]
  v_mfma_f32_16x16x32_bf16 v[20:23], a[164:167], v[88:91], v[20:23]
  s_waitcnt vmcnt(17)
  v_cmp_eq_u32 vcc, -1, v92
  s_cbranch_vccnz L_gr_86
L_gb_87:
  v_mfma_f32_16x16x32_bf16 v[12:15], a[168:171], v[92:95], v[12:15]
  v_mfma_f32_16x16x32_bf16 v[16:19], a[172:175], v[92:95], v[16:19]
  v_mfma_f32_16x16x32_bf16 v[20:23], a[176:179], v[92:95], v[20:23]
  s_waitcnt vmcnt(16)
  v_cmp_eq_u32 vcc, -1, v96
  s_cbranch_vccnz L_gr_88
L_gb_89:
  v_mfma_f32_16x16x32_bf16 v[12:15], a[180:183], v[96:99], v[12:15]
  v_mfma_f32_16x16x32_bf16 v[16:19], a[184:187], v[96:99], v[16:19]
  v_mfma_f32_16x16x32_bf16 v[20:23], a[188:191], v[96:99], v[20:23]
  s_waitcnt vmcnt(15)
  v_cmp_eq_u32 vcc, -1, v100
  s_cbranch_vccnz L_gr_90
L_gb_91:
  v_mfma_f32_16x16x32_bf16 v[12:15], a[192:195], v[100:103], v[12:15]
  v_mfma_f32_16x16x32_bf16 v[16:19], a[196:199], v[100:103], v[16:19]
  v_mfma_f32_16x16x32_bf16 v[20:23], a[200:203], v[100:103], v[20:23]
  s_waitcnt vmcnt(14)
  v_cmp_eq_u32 vcc, -1, v104
  s_cbranch_vccnz L_gr_92
L_gb_93:
  v_mfma_f32_16x16x32_bf16 v[12:15], a[204:207], v[104:107], v[12:15]
  v_mfma_f32_16x16x32_bf16 v[16:19], a[208:211], v[104:107], v[16:19]
  v_mfma_f32_16x16x32_bf16 v[20:23], a[212:215], v[104:107], v[20:23]
  s_waitcnt vmcnt(13)
  v_cmp_eq_u32 vcc, -1, v108
  s_cbranch_vccnz L_gr_94
L_gb_95:
  v_mfma_f32_16x16x32_bf16 v[12:15], a[216:219], v[108:111], v[12:15]
  v_mfma_f32_16x16x32_bf16 v[16:19], a[220:223], v[108:111], v[16:19]
  v_mfma_f32_16x16x32_bf16 v[20:23], a[224:227], v[108:111], v[20:23]
  s_waitcnt vmcnt(12)
  v_cmp_eq_u32 vcc, -1, v112
  s_cbranch_vccnz L_gr_96
L_gb_97:
  v_mfma_f32_16x16x32_bf16 v[12:15], a[228:231], v[112:115], v[12:15]
  v_mfma_f32_16x16x32_bf16 v[16:19], a[232:235], v[112:115], v[16:19]
  v_mfma_f32_16x16x32_bf16 v[20:23], a[236:239], v[112:115], v[20:23]
  s_waitcnt vmcnt(11)
  v_cmp_eq_u32 vcc, -1, v116
  s_cbranch_vccnz L_gr_98
L_gb_99:
  v_mfma_f32_16x16x32_bf16 v[12:15], a[240:243], v[116:119], v[12:15]
  v_mfma_f32_16x16x32_bf16 v[16:19], a[244:247], v[116:119], v[16:19]
  v_mfma_f32_16x16x32_bf16 v[20:23], a[248:251], v[116:119], v[20:23]
  s_waitcnt vmcnt(10)
  v_cmp_eq_u32 vcc, -1, v120
  s_cbranch_vccnz L_gr_100
L_gb_101:
  v_mfma_f32_16x16x32_bf16 v[12:15], a[252:255], v[120:123], v[12:15]
  v_mfma_f32_16x16x32_bf16 v[16:19], v[128:131], v[120:123], v[16:19]
  v_mfma_f32_16x16x32_bf16 v[20:23], v[132:135], v[120:123], v[20:23]
  s_waitcnt vmcnt(9)
  v_cmp_eq_u32 vcc, -1, v36
  s_cbranch_vccnz L_gr_102
L_gb_103:
  v_mfma_f32_16x16x32_bf16 v[12:15], v[136:139], v[36:39], v[12:15]
  v_mfma_f32_16x16x32_bf16 v[16:19], v[140:143], v[36:39], v[16:19]
  v_mfma_f32_16x16x32_bf16 v[20:23], v[144:147], v[36:39], v[20:23]
  s_waitcnt vmcnt(8)
  v_cmp_eq_u32 vcc, -1, v40
  s_cbranch_vccnz L_gr_104
L_gb_105:
  v_mfma_f32_16x16x32_bf16 v[12:15], v[148:151], v[40:43], v[12:15]
  v_mfma_f32_16x16x32_bf16 v[16:19], v[152:155], v[40:43], v[16:19]
  v_mfma_f32_16x16x32_bf16 v[20:23], v[156:159], v[40:43], v[20:23]
  s_waitcnt vmcnt(7)
  v_cmp_eq_u32 vcc, -1, v44
  s_cbranch_vccnz L_gr_106
L_gb_107:
  v_mfma_f32_16x16x32_bf16 v[12:15], v[160:163], v[44:47], v[12:15]
  v_mfma_f32_16x16x32_bf16 v[16:19], v[164:167], v[44:47], v[16:19]
  v_mfma_f32_16x16x32_bf16 v[20:23], v[168:171], v[44:47], v[20:23]
  s_waitcnt vmcnt(6)
  v_cmp_eq_u32 vcc, -1, v48
  s_cbranch_vccnz L_gr_108
L_gb_109:
  v_mfma_f32_16x16x32_bf16 v[12:15], v[172:175], v[48:51], v[12:15]
  v_mfma_f32_16x16x32_bf16 v[16:19], v[176:179], v[48:51], v[16:19]
  v_mfma_f32_16x16x32_bf16 v[20:23], v[180:183], v[48:51], v[20:23]
  s_waitcnt vmcnt(5)
  v_cmp_eq_u32 vcc, -1, v52
  s_cbranch_vccnz L_gr_110
L_gb_111:
  v_mfma_f32_16x16x32_bf16 v[12:15], v[184:187], v[52:55], v[12:15]
  v_mfma_f32_16x16x32_bf16 v[16:19], v[188:191], v[52:55], v[16:19]
  v_mfma_f32_16x16x32_bf16 v[20:23], v[192:195], v[52:55], v[20:23]
  s_waitcnt vmcnt(4)
  v_cmp_eq_u32 vcc, -1, v56
  s_cbranch_vccnz L_gr_112
L_gb_113:
  v_mfma_f32_16x16x32_bf16 v[12:15], v[196:199], v[56:59], v[12:15]
  v_mfma_f32_16x16x32_bf16 v[16:19], v[200:203], v[56:59], v[16:19]
  v_mfma_f32_16x16x32_bf16 v[20:23], v[204:207], v[56:59], v[20:23]
  s_waitcnt vmcnt(3)
  v_cmp_eq_u32 vcc, -1, v60
  s_cbranch_vccnz L_gr_114
L_gb_115:
  v_mfma_f32_16x16x32_bf16 v[12:15], v[208:211], v[60:63], v[12:15]
  v_mfma_f32_16x16x32_bf16 v[16:19], v[212:215], v[60:63], v[16:19]
  v_mfma_f32_16x16x32_bf16 v[20:23], v[216:219], v[60:63], v[20:23]
  s_waitcnt vmcnt(2)
  v_cmp_eq_u32 vcc, -1, v64
  s_cbranch_vccnz L_gr_116
L_gb_117:
  v_mfma_f32_16x16x32_bf16 v[12:15], v[220:223], v[64:67], v[12:15]
  v_mfma_f32_16x16x32_bf16 v[16:19], v[224:227], v[64:67], v[16:19]
  v_mfma_f32_16x16x32_bf16 v[20:23], v[228:231], v[64:67], v[20:23]
  s_waitcnt vmcnt(1)
  v_cmp_eq_u32 vcc, -1, v68
  s_cbranch_vccnz L_gr_118
L_gb_119:
  v_mfma_f32_16x16x32_bf16 v[12:15], v[232:235], v[68:71], v[12:15]
  v_mfma_f32_16x16x32_bf16 v[16:19], v[236:239], v[68:71], v[16:19]
  v_mfma_f32_16x16x32_bf16 v[20:23], v[240:243], v[68:71], v[20:23]
  s_waitcnt vmcnt(0)
  v_cmp_eq_u32 vcc, -1, v72
  s_cbranch_vccnz L_gr_120
L_gb_121:
  v_mfma_f32_16x16x32_bf16 v[12:15], v[244:247], v[72:75], v[12:15]
  v_mfma_f32_16x16x32_bf16 v[16:19], v[248:251], v[72:75], v[16:19]
  v_mfma_f32_16x16x32_bf16 v[20:23], v[252:255], v[72:75], v[20:23]
  s_branch L_gj_122
L_gr_58:
  s_add_u32 s47, s47, 1
  s_cmp_gt_u32 s47, 131072
  s_cbranch_scc1 L_exit
  s_add_u32 s6, s71, 0
  buffer_load_dwordx4 v[36:39], v2, s[48:51], s6 offen sc1
  s_waitcnt vmcnt(0)
  v_cmp_eq_u32 vcc, -1, v36
  s_cbranch_vccnz L_gr_58
  s_branch L_gb_59
L_gr_60:
  s_add_u32 s47, s47, 1
  s_cmp_gt_u32 s47, 131072
  s_cbranch_scc1 L_exit
  s_add_u32 s6, s71, 2048
  buffer_load_dwordx4 v[40:43], v2, s[48:51], s6 offen sc1
  s_waitcnt vmcnt(0)
  v_cmp_eq_u32 vcc, -1, v40
  s_cbranch_vccnz L_gr_60
  s_branch L_gb_61
L_gr_62:
  s_add_u32 s47, s47, 1
  s_cmp_gt_u32 s47, 131072
  s_cbranch_scc1 L_exit
  s_add_u32 s6, s71, 4096
  buffer_load_dwordx4 v[44:47], v2, s[48:51], s6 offen sc1
  s_waitcnt vmcnt(0)
  v_cmp_eq_u32 vcc, -1, v44
  s_cbranch_vccnz L_gr_62
  s_branch L_gb_63
L_gr_64:
  s_add_u32 s47, s47, 1
  s_cmp_gt_u32 s47, 131072
  s_cbranch_scc1 L_exit
  s_add_u32 s6, s71, 6144
  buffer_load_dwordx4 v[48:51], v2, s[48:51], s6 offen sc1
  s_waitcnt vmcnt(0)
  v_cmp_eq_u32 vcc, -1, v48
  s_cbranch_vccnz L_gr_64
  s_branch L_gb_65
L_gr_66:
  s_add_u32 s47, s47, 1
  s_cmp_gt_u32 s47, 131072
  s_cbranch_scc1 L_exit
  s_add_u32 s6, s71, 8192
  buffer_load_dwordx4 v[52:55], v2, s[48:51], s6 offen sc1
  s_waitcnt vmcnt(0)
  v_cmp_eq_u32 vcc, -1, v52
  s_cbranch_vccnz L_gr_66
  s_branch L_gb_67
L_gr_68:
  s_add_u32 s47, s47, 1
  s_cmp_gt_u32 s47, 131072
  s_cbranch_scc1 L_exit
  s_add_u32 s6, s71, 10240
  buffer_load_dwordx4 v[56:59], v2, s[48:51], s6 offen sc1
  s_waitcnt vmcnt(0)
  v_cmp_eq_u32 vcc, -1, v56
  s_cbranch_vccnz L_gr_68
  s_branch L_gb_69
L_gr_70:
  s_add_u32 s47, s47, 1
  s_cmp_gt_u32 s47, 131072
  s_cbranch_scc1 L_exit
  s_add_u32 s6, s71, 12288
  buffer_load_dwordx4 v[60:63], v2, s[48:51], s6 offen sc1
  s_waitcnt vmcnt(0)
  v_cmp_eq_u32 vcc, -1, v60
  s_cbranch_vccnz L_gr_70
  s_branch L_gb_71
L_gr_72:
  s_add_u32 s47, s47, 1
  s_cmp_gt_u32 s47, 131072
  s_cbranch_scc1 L_exit
  s_add_u32 s6, s71, 14336
  buffer_load_dwordx4 v[64:67], v2, s[48:51], s6 offen sc1
  s_waitcnt vmcnt(0)
  v_cmp_eq_u32 vcc, -1, v64
  s_cbranch_vccnz L_gr_72
  s_branch L_gb_73
L_gr_74:
  s_add_u32 s47, s47, 1
  s_cmp_gt_u32 s47, 131072
  s_cbranch_scc1 L_exit
  s_add_u32 s6, s71, 16384
  buffer_load_dwordx4 v[68:71], v2, s[48:51], s6 offen sc1
  s_waitcnt vmcnt(0)
  v_cmp_eq_u32 vcc, -1, v68
  s_cbranch_vccnz L_gr_74
  s_branch L_gb_75
L_gr_76:
  s_add_u32 s47, s47, 1
  s_cmp_gt_u32 s47, 131072
  s_cbranch_scc1 L_exit
  s_add_u32 s6, s71, 18432
  buffer_load_dwordx4 v[72:75], v2, s[48:51], s6 offen sc1
  s_waitcnt vmcnt(0)
  v_cmp_eq_u32 vcc, -1, v72
  s_cbranch_vccnz L_gr_76
  s_branch L_gb_77
L_gr_78:
  s_add_u32 s47, s47, 1
  s_cmp_gt_u32 s47, 131072
  s_cbranch_scc1 L_exit
  s_add_u32 s6, s71, 20480
  buffer_load_dwordx4 v[76:79], v2, s[48:51], s6 offen sc1
  s_waitcnt vmcnt(0)
  v_cmp_eq_u32 vcc, -1, v76
  s_cbranch_vccnz L_gr_78
  s_branch L_gb_79
L_gr_80:
  s_add_u32 s47, s47, 1
  s_cmp_gt_u32 s47, 131072
  s_cbranch_scc1 L_exit
  s_add_u32 s6, s71, 22528
  buffer_load_dwordx4 v[80:83], v2, s[48:51], s6 offen sc1
  s_waitcnt vmcnt(0)
  v_cmp_eq_u32 vcc, -1, v80
  s_cbranch_vccnz L_gr_80
  s_branch L_gb_81
L_gr_82:
  s_add_u32 s47, s47, 1
  s_cmp_gt_u32 s47, 131072
  s_cbranch_scc1 L_exit
  s_add_u32 s6, s71, 24576
  buffer_load_dwordx4 v[84:87], v2, s[48:51], s6 offen sc1
  s_waitcnt vmcnt(0)
  v_cmp_eq_u32 vcc, -1, v84
  s_cbranch_vccnz L_gr_82
  s_branch L_gb_83
L_gr_84:
  s_add_u32 s47, s47, 1
  s_cmp_gt_u32 s47, 131072
  s_cbranch_scc1 L_exit
  s_add_u32 s6, s71, 26624
  buffer_load_dwordx4 v[88:91], v2, s[48:51], s6 offen sc1
  s_waitcnt vmcnt(0)
  v_cmp_eq_u32 vcc, -1, v88
  s_cbranch_vccnz L_gr_84
  s_branch L_gb_85
L_gr_86:
  s_add_u32 s47, s47, 1
  s_cmp_gt_u32 s47, 131072
  s_cbranch_scc1 L_exit
  s_add_u32 s6, s71, 28672
  buffer_load_dwordx4 v[92:95], v2, s[48:51], s6 offen sc1
  s_waitcnt vmcnt(0)
  v_cmp_eq_u32 vcc, -1, v92
  s_cbranch_vccnz L_gr_86
  s_branch L_gb_87
L_gr_88:
  s_add_u32 s47, s47, 1
  s_cmp_gt_u32 s47, 131072
  s_cbranch_scc1 L_exit
  s_add_u32 s6, s71, 30720
  buffer_load_dwordx4 v[96:99], v2, s[48:51], s6 offen sc1
  s_waitcnt vmcnt(0)
  v_cmp_eq_u32 vcc, -1, v96
  s_cbranch_vccnz L_gr_88
  s_branch L_gb_89
L_gr_90:
  s_add_u32 s47, s47, 1
  s_cmp_gt_u32 s47, 131072
  s_cbranch_scc1 L_exit
  s_add_u32 s6, s71, 32768
  buffer_load_dwordx4 v[100:103], v2, s[48:51], s6 offen sc1
  s_waitcnt vmcnt(0)
  v_cmp_eq_u32 vcc, -1, v100
  s_cbranch_vccnz L_gr_90
  s_branch L_gb_91
L_gr_92:
  s_add_u32 s47, s47, 1
  s_cmp_gt_u32 s47, 131072
  s_cbranch_scc1 L_exit
  s_add_u32 s6, s71, 34816
  buffer_load_dwordx4 v[104:107], v2, s[48:51], s6 offen sc1
  s_waitcnt vmcnt(0)
  v_cmp_eq_u32 vcc, -1, v104
  s_cbranch_vccnz L_gr_92
  s_branch L_gb_93
L_gr_94:
  s_add_u32 s47, s47, 1
  s_cmp_gt_u32 s47, 131072
  s_cbranch_scc1 L_exit
  s_add_u32 s6, s71, 36864
  buffer_load_dwordx4 v[108:111], v2, s[48:51], s6 offen sc1
  s_waitcnt vmcnt(0)
  v_cmp_eq_u32 vcc, -1, v108
  s_cbranch_vccnz L_gr_94
  s_branch L_gb_95
L_gr_96:
  s_add_u32 s47, s47, 1
  s_cmp_gt_u32 s47, 131072
  s_cbranch_scc1 L_exit
  s_add_u32 s6, s71, 38912
  buffer_load_dwordx4 v[112:115], v2, s[48:51], s6 offen sc1
  s_waitcnt vmcnt(0)
  v_cmp_eq_u32 vcc, -1, v112
  s_cbranch_vccnz L_gr_96
  s_branch L_gb_97
L_gr_98:
  s_add_u32 s47, s47, 1
  s_cmp_gt_u32 s47, 131072
  s_cbranch_scc1 L_exit
  s_add_u32 s6, s71, 40960
  buffer_load_dwordx4 v[116:119], v2, s[48:51], s6 offen sc1
  s_waitcnt vmcnt(0)
  v_cmp_eq_u32 vcc, -1, v116
  s_cbranch_vccnz L_gr_98
  s_branch L_gb_99
L_gr_100:
  s_add_u32 s47, s47, 1
  s_cmp_gt_u32 s47, 131072
  s_cbranch_scc1 L_exit
  s_add_u32 s6, s71, 43008
  buffer_load_dwordx4 v[120:123], v2, s[48:51], s6 offen sc1
  s_waitcnt vmcnt(0)
  v_cmp_eq_u32 vcc, -1, v120
  s_cbranch_vccnz L_gr_100
  s_branch L_gb_101
L_gr_102:
  s_add_u32 s47, s47, 1
  s_cmp_gt_u32 s47, 131072
  s_cbranch_scc1 L_exit
  s_add_u32 s6, s71, 45056
  buffer_load_dwordx4 v[36:39], v2, s[48:51], s6 offen sc1
  s_waitcnt vmcnt(0)
  v_cmp_eq_u32 vcc, -1, v36
  s_cbranch_vccnz L_gr_102
  s_branch L_gb_103
L_gr_104:
  s_add_u32 s47, s47, 1
  s_cmp_gt_u32 s47, 131072
  s_cbranch_scc1 L_exit
  s_add_u32 s6, s71, 47104
  buffer_load_dwordx4 v[40:43], v2, s[48:51], s6 offen sc1
  s_waitcnt vmcnt(0)
  v_cmp_eq_u32 vcc, -1, v40
  s_cbranch_vccnz L_gr_104
  s_branch L_gb_105
L_gr_106:
  s_add_u32 s47, s47, 1
  s_cmp_gt_u32 s47, 131072
  s_cbranch_scc1 L_exit
  s_add_u32 s6, s71, 49152
  buffer_load_dwordx4 v[44:47], v2, s[48:51], s6 offen sc1
  s_waitcnt vmcnt(0)
  v_cmp_eq_u32 vcc, -1, v44
  s_cbranch_vccnz L_gr_106
  s_branch L_gb_107
L_gr_108:
  s_add_u32 s47, s47, 1
  s_cmp_gt_u32 s47, 131072
  s_cbranch_scc1 L_exit
  s_add_u32 s6, s71, 51200
  buffer_load_dwordx4 v[48:51], v2, s[48:51], s6 offen sc1
  s_waitcnt vmcnt(0)
  v_cmp_eq_u32 vcc, -1, v48
  s_cbranch_vccnz L_gr_108
  s_branch L_gb_109
L_gr_110:
  s_add_u32 s47, s47, 1
  s_cmp_gt_u32 s47, 131072
  s_cbranch_scc1 L_exit
  s_add_u32 s6, s71, 53248
  buffer_load_dwordx4 v[52:55], v2, s[48:51], s6 offen sc1
  s_waitcnt vmcnt(0)
  v_cmp_eq_u32 vcc, -1, v52
  s_cbranch_vccnz L_gr_110
  s_branch L_gb_111
L_gr_112:
  s_add_u32 s47, s47, 1
  s_cmp_gt_u32 s47, 131072
  s_cbranch_scc1 L_exit
  s_add_u32 s6, s71, 55296
  buffer_load_dwordx4 v[56:59], v2, s[48:51], s6 offen sc1
  s_waitcnt vmcnt(0)
  v_cmp_eq_u32 vcc, -1, v56
  s_cbranch_vccnz L_gr_112
  s_branch L_gb_113
L_gr_114:
  s_add_u32 s47, s47, 1
  s_cmp_gt_u32 s47, 131072
  s_cbranch_scc1 L_exit
  s_add_u32 s6, s71, 57344
  buffer_load_dwordx4 v[60:63], v2, s[48:51], s6 offen sc1
  s_waitcnt vmcnt(0)
  v_cmp_eq_u32 vcc, -1, v60
  s_cbranch_vccnz L_gr_114
  s_branch L_gb_115
L_gr_116:
  s_add_u32 s47, s47, 1
  s_cmp_gt_u32 s47, 131072
  s_cbranch_scc1 L_exit
  s_add_u32 s6, s71, 59392
  buffer_load_dwordx4 v[64:67], v2, s[48:51], s6 offen sc1
  s_waitcnt vmcnt(0)
  v_cmp_eq_u32 vcc, -1, v64
  s_cbranch_vccnz L_gr_116
  s_branch L_gb_117
L_gr_118:
  s_add_u32 s47, s47, 1
  s_cmp_gt_u32 s47, 131072
  s_cbranch_scc1 L_exit
  s_add_u32 s6, s71, 61440
  buffer_load_dwordx4 v[68:71], v2, s[48:51], s6 offen sc1
  s_waitcnt vmcnt(0)
  v_cmp_eq_u32 vcc, -1, v68
  s_cbranch_vccnz L_gr_118
  s_branch L_gb_119
L_gr_120:
  s_add_u32 s47, s47, 1
  s_cmp_gt_u32 s47, 131072
  s_cbranch_scc1 L_exit
  s_add_u32 s6, s71, 63488
  buffer_load_dwordx4 v[72:75], v2, s[48:51], s6 offen sc1
  s_waitcnt vmcnt(0)
  v_cmp_eq_u32 vcc, -1, v72
  s_cbranch_vccnz L_gr_120
  s_branch L_gb_121
L_gj_122:
  s_mul_i32 s4, s3, 3072
  v_add_u32 v7, s4, v2
  s_nop 7
  ds_write_b128 v7, v[12:15] offset:0
  ds_write_b128 v7, v[16:19] offset:1024
  ds_write_b128 v7, v[20:23] offset:2048
  s_waitcnt lgkmcnt(0)
  s_barrier
  s_lshl_b32 s4, s3, 10
  v_add_u32 v7, s4, v2
  ds_read_b128 v[36:39], v7 offset:0
  ds_read_b128 v[40:43], v7 offset:3072
  ds_read_b128 v[44:47], v7 offset:6144
  ds_read_b128 v[48:51], v7 offset:9216
  s_waitcnt lgkmcnt(0)
  v_add_f32 v36, v36, v40
  v_add_f32 v44, v44, v48
  v_add_f32 v37, v37, v41
  v_add_f32 v45, v45, v49
  v_add_f32 v38, v38, v42
  v_add_f32 v46, v46, v50
  v_add_f32 v39, v39, v43
  v_add_f32 v47, v47, v51
  v_add_f32 v12, v36, v44
  v_add_f32 v13, v37, v45
  v_add_f32 v14, v38, v46
  v_add_f32 v15, v39, v47
  s_barrier
L_t5_epi:
  s_cmp_ge_u32 s3, 3
  s_cbranch_scc1 L_t5sk_123
  s_lshl_b32 s4, s70, 1
  s_add_u32 s4, s4, s75
  s_mul_i32 s4, s4, 12
  s_add_u32 s4, s4, s69
  s_mul_i32 s4, s4, 3072
  s_lshl_b32 s5, s3, 10
  s_add_u32 s4, s4, s5
  s_add_u32 s73, s4, 103809024
  buffer_load_dwordx4 v[36:39], v2, s[48:51], s73 offen sc1
  s_lshl_b32 s4, s70, 5
  s_lshl_b32 s9, s75, 4
  s_add_u32 s4, s4, s9
  s_lshl_b32 s9, s4, 2
  s_add_u32 s74, s9, 109051904
  v_and_b32 v76, 15, v0
  v_lshlrev_b32 v77, 2, v76
  buffer_load_dword v78, v77, s[48:51], s74 offen sc1
  s_movk_i32 s9, 1152
  v_mul_lo_u32 v76, v76, s9
  v_lshrrev_b32 v77, 4, v0
  v_lshlrev_b32 v77, 3, v77
  v_add_u32 v76, v76, v77
  s_mul_i32 s4, s4, 1152
  s_mul_i32 s9, s69, 96
  s_add_u32 s4, s4, s9
  s_lshl_b32 s9, s3, 5
  s_add_u32 s73, s4, s9
  s_waitcnt vmcnt(0)
  v_sub_f32 v12, v12, v36
  v_fma_f32 v12, v12, v78, v36
  v_sub_f32 v13, v13, v37
  v_fma_f32 v13, v13, v78, v37
  v_sub_f32 v14, v14, v38
  v_fma_f32 v14, v14, v78, v38
  v_sub_f32 v15, v15, v39
  v_fma_f32 v15, v15, v78, v39
  v_cvt_pk_bf16_f32 v12, v12, v13
  v_cvt_pk_bf16_f32 v13, v14, v15
  buffer_store_dwordx2 v[12:13], v76, s[64:67], s73 offen sc1
L_t5sk_123:
L_t5_next:
  s_add_u32 s76, s76, 1
  s_cmp_lt_u32 s76, 8
  s_cbranch_scc1 L_t5_loop
  s_branch L_exit
L_gate:
  s_sub_u32 s15, s14, 216
  s_mov_b32 s52, s16
  s_mov_b32 s53, s17
  s_mov_b32 s54, 2359296
  s_mov_b32 s55, 0x20000
  s_lshl_b32 s4, s15, 8
  s_lshl_b32 s5, s3, 6
  s_add_u32 s12, s4, s5
  v_add_u32 v2, s12, v0
  s_movk_i32 s4, 1152
  v_mul_lo_u32 v3, v2, s4
  v_mov_b32 v4, 0
  v_mov_b32 v7, 0
  s_load_dwordx16 s[68:83], s[38:39], 0
  s_load_dwordx16 s[84:99], s[38:39], 64
  buffer_load_dwordx4 v[8:11], v3, s[52:55], 0 offen offset:0
  buffer_load_dwordx4 v[12:15], v3, s[52:55], 0 offen offset:16
  buffer_load_dwordx4 v[16:19], v3, s[52:55], 0 offen offset:32
  buffer_load_dwordx4 v[20:23], v3, s[52:55], 0 offen offset:48
  buffer_load_dwordx4 v[24:27], v3, s[52:55], 0 offen offset:64
  buffer_load_dwordx4 v[28:31], v3, s[52:55], 0 offen offset:80
  buffer_load_dwordx4 v[32:35], v3, s[52:55], 0 offen offset:96
  buffer_load_dwordx4 v[36:39], v3, s[52:55], 0 offen offset:112
  s_waitcnt vmcnt(0) lgkmcnt(0)
  s_lshl_b32 s4, s68, 16
  s_and_b32 s5, s68, 0xffff0000
  v_lshlrev_b32 v5, 16, v8
  v_and_b32 v6, 0xffff0000, v8
  v_fma_f32 v4, v5, s4, v4
  v_fma_f32 v7, v6, s5, v7
  s_lshl_b32 s4, s69, 16
  s_and_b32 s5, s69, 0xffff0000
  v_lshlrev_b32 v5, 16, v9
  v_and_b32 v6, 0xffff0000, v9
  v_fma_f32 v4, v5, s4, v4
  v_fma_f32 v7, v6, s5, v7
  s_lshl_b32 s4, s70, 16
  s_and_b32 s5, s70, 0xffff0000
  v_lshlrev_b32 v5, 16, v10
  v_and_b32 v6, 0xffff0000, v10
  v_fma_f32 v4, v5, s4, v4
  v_fma_f32 v7, v6, s5, v7
  s_lshl_b32 s4, s71, 16
  s_and_b32 s5, s71, 0xffff0000
  v_lshlrev_b32 v5, 16, v11
  v_and_b32 v6, 0xffff0000, v11
  v_fma_f32 v4, v5, s4, v4
  v_fma_f32 v7, v6, s5, v7
  s_lshl_b32 s4, s72, 16
  s_and_b32 s5, s72, 0xffff0000
  v_lshlrev_b32 v5, 16, v12
  v_and_b32 v6, 0xffff0000, v12
  v_fma_f32 v4, v5, s4, v4
  v_fma_f32 v7, v6, s5, v7
  s_lshl_b32 s4, s73, 16
  s_and_b32 s5, s73, 0xffff0000
  v_lshlrev_b32 v5, 16, v13
  v_and_b32 v6, 0xffff0000, v13
  v_fma_f32 v4, v5, s4, v4
  v_fma_f32 v7, v6, s5, v7
  s_lshl_b32 s4, s74, 16
  s_and_b32 s5, s74, 0xffff0000
  v_lshlrev_b32 v5, 16, v14
  v_and_b32 v6, 0xffff0000, v14
  v_fma_f32 v4, v5, s4, v4
  v_fma_f32 v7, v6, s5, v7
  s_lshl_b32 s4, s75, 16
  s_and_b32 s5, s75, 0xffff0000
  v_lshlrev_b32 v5, 16, v15
  v_and_b32 v6, 0xffff0000, v15
  v_fma_f32 v4, v5, s4, v4
  v_fma_f32 v7, v6, s5, v7
  s_lshl_b32 s4, s76, 16
  s_and_b32 s5, s76, 0xffff0000
  v_lshlrev_b32 v5, 16, v16
  v_and_b32 v6, 0xffff0000, v16
  v_fma_f32 v4, v5, s4, v4
  v_fma_f32 v7, v6, s5, v7
  s_lshl_b32 s4, s77, 16
  s_and_b32 s5, s77, 0xffff0000
  v_lshlrev_b32 v5, 16, v17
  v_and_b32 v6, 0xffff0000, v17
  v_fma_f32 v4, v5, s4, v4
  v_fma_f32 v7, v6, s5, v7
  s_lshl_b32 s4, s78, 16
  s_and_b32 s5, s78, 0xffff0000
  v_lshlrev_b32 v5, 16, v18
  v_and_b32 v6, 0xffff0000, v18
  v_fma_f32 v4, v5, s4, v4
  v_fma_f32 v7, v6, s5, v7
  s_lshl_b32 s4, s79, 16
  s_and_b32 s5, s79, 0xffff0000
  v_lshlrev_b32 v5, 16, v19
  v_and_b32 v6, 0xffff0000, v19
  v_fma_f32 v4, v5, s4, v4
  v_fma_f32 v7, v6, s5, v7
  s_lshl_b32 s4, s80, 16
  s_and_b32 s5, s80, 0xffff0000
  v_lshlrev_b32 v5, 16, v20
  v_and_b32 v6, 0xffff0000, v20
  v_fma_f32 v4, v5, s4, v4
  v_fma_f32 v7, v6, s5, v7
  s_lshl_b32 s4, s81, 16
  s_and_b32 s5, s81, 0xffff0000
  v_lshlrev_b32 v5, 16, v21
  v_and_b32 v6, 0xffff0000, v21
  v_fma_f32 v4, v5, s4, v4
  v_fma_f32 v7, v6, s5, v7
  s_lshl_b32 s4, s82, 16
  s_and_b32 s5, s82, 0xffff0000
  v_lshlrev_b32 v5, 16, v22
  v_and_b32 v6, 0xffff0000, v22
  v_fma_f32 v4, v5, s4, v4
  v_fma_f32 v7, v6, s5, v7
  s_lshl_b32 s4, s83, 16
  s_and_b32 s5, s83, 0xffff0000
  v_lshlrev_b32 v5, 16, v23
  v_and_b32 v6, 0xffff0000, v23
  v_fma_f32 v4, v5, s4, v4
  v_fma_f32 v7, v6, s5, v7
  s_lshl_b32 s4, s84, 16
  s_and_b32 s5, s84, 0xffff0000
  v_lshlrev_b32 v5, 16, v24
  v_and_b32 v6, 0xffff0000, v24
  v_fma_f32 v4, v5, s4, v4
  v_fma_f32 v7, v6, s5, v7
  s_lshl_b32 s4, s85, 16
  s_and_b32 s5, s85, 0xffff0000
  v_lshlrev_b32 v5, 16, v25
  v_and_b32 v6, 0xffff0000, v25
  v_fma_f32 v4, v5, s4, v4
  v_fma_f32 v7, v6, s5, v7
  s_lshl_b32 s4, s86, 16
  s_and_b32 s5, s86, 0xffff0000
  v_lshlrev_b32 v5, 16, v26
  v_and_b32 v6, 0xffff0000, v26
  v_fma_f32 v4, v5, s4, v4
  v_fma_f32 v7, v6, s5, v7
  s_lshl_b32 s4, s87, 16
  s_and_b32 s5, s87, 0xffff0000
  v_lshlrev_b32 v5, 16, v27
  v_and_b32 v6, 0xffff0000, v27
  v_fma_f32 v4, v5, s4, v4
  v_fma_f32 v7, v6, s5, v7
  s_lshl_b32 s4, s88, 16
  s_and_b32 s5, s88, 0xffff0000
  v_lshlrev_b32 v5, 16, v28
  v_and_b32 v6, 0xffff0000, v28
  v_fma_f32 v4, v5, s4, v4
  v_fma_f32 v7, v6, s5, v7
  s_lshl_b32 s4, s89, 16
  s_and_b32 s5, s89, 0xffff0000
  v_lshlrev_b32 v5, 16, v29
  v_and_b32 v6, 0xffff0000, v29
  v_fma_f32 v4, v5, s4, v4
  v_fma_f32 v7, v6, s5, v7
  s_lshl_b32 s4, s90, 16
  s_and_b32 s5, s90, 0xffff0000
  v_lshlrev_b32 v5, 16, v30
  v_and_b32 v6, 0xffff0000, v30
  v_fma_f32 v4, v5, s4, v4
  v_fma_f32 v7, v6, s5, v7
  s_lshl_b32 s4, s91, 16
  s_and_b32 s5, s91, 0xffff0000
  v_lshlrev_b32 v5, 16, v31
  v_and_b32 v6, 0xffff0000, v31
  v_fma_f32 v4, v5, s4, v4
  v_fma_f32 v7, v6, s5, v7
  s_lshl_b32 s4, s92, 16
  s_and_b32 s5, s92, 0xffff0000
  v_lshlrev_b32 v5, 16, v32
  v_and_b32 v6, 0xffff0000, v32
  v_fma_f32 v4, v5, s4, v4
  v_fma_f32 v7, v6, s5, v7
  s_lshl_b32 s4, s93, 16
  s_and_b32 s5, s93, 0xffff0000
  v_lshlrev_b32 v5, 16, v33
  v_and_b32 v6, 0xffff0000, v33
  v_fma_f32 v4, v5, s4, v4
  v_fma_f32 v7, v6, s5, v7
  s_lshl_b32 s4, s94, 16
  s_and_b32 s5, s94, 0xffff0000
  v_lshlrev_b32 v5, 16, v34
  v_and_b32 v6, 0xffff0000, v34
  v_fma_f32 v4, v5, s4, v4
  v_fma_f32 v7, v6, s5, v7
  s_lshl_b32 s4, s95, 16
  s_and_b32 s5, s95, 0xffff0000
  v_lshlrev_b32 v5, 16, v35
  v_and_b32 v6, 0xffff0000, v35
  v_fma_f32 v4, v5, s4, v4
  v_fma_f32 v7, v6, s5, v7
  s_lshl_b32 s4, s96, 16
  s_and_b32 s5, s96, 0xffff0000
  v_lshlrev_b32 v5, 16, v36
  v_and_b32 v6, 0xffff0000, v36
  v_fma_f32 v4, v5, s4, v4
  v_fma_f32 v7, v6, s5, v7
  s_lshl_b32 s4, s97, 16
  s_and_b32 s5, s97, 0xffff0000
  v_lshlrev_b32 v5, 16, v37
  v_and_b32 v6, 0xffff0000, v37
  v_fma_f32 v4, v5, s4, v4
  v_fma_f32 v7, v6, s5, v7
  s_lshl_b32 s4, s98, 16
  s_and_b32 s5, s98, 0xffff0000
  v_lshlrev_b32 v5, 16, v38
  v_and_b32 v6, 0xffff0000, v38
  v_fma_f32 v4, v5, s4, v4
  v_fma_f32 v7, v6, s5, v7
  s_lshl_b32 s4, s99, 16
  s_and_b32 s5, s99, 0xffff0000
  v_lshlrev_b32 v5, 16, v39
  v_and_b32 v6, 0xffff0000, v39
  v_fma_f32 v4, v5, s4, v4
  v_fma_f32 v7, v6, s5, v7
  s_load_dwordx16 s[68:83], s[38:39], 128
  s_load_dwordx16 s[84:99], s[38:39], 192
  buffer_load_dwordx4 v[8:11], v3, s[52:55], 0 offen offset:128
  buffer_load_dwordx4 v[12:15], v3, s[52:55], 0 offen offset:144
  buffer_load_dwordx4 v[16:19], v3, s[52:55], 0 offen offset:160
  buffer_load_dwordx4 v[20:23], v3, s[52:55], 0 offen offset:176
  buffer_load_dwordx4 v[24:27], v3, s[52:55], 0 offen offset:192
  buffer_load_dwordx4 v[28:31], v3, s[52:55], 0 offen offset:208
  buffer_load_dwordx4 v[32:35], v3, s[52:55], 0 offen offset:224
  buffer_load_dwordx4 v[36:39], v3, s[52:55], 0 offen offset:240
  s_waitcnt vmcnt(0) lgkmcnt(0)
  s_lshl_b32 s4, s68, 16
  s_and_b32 s5, s68, 0xffff0000
  v_lshlrev_b32 v5, 16, v8
  v_and_b32 v6, 0xffff0000, v8
  v_fma_f32 v4, v5, s4, v4
  v_fma_f32 v7, v6, s5, v7
  s_lshl_b32 s4, s69, 16
  s_and_b32 s5, s69, 0xffff0000
  v_lshlrev_b32 v5, 16, v9
  v_and_b32 v6, 0xffff0000, v9
  v_fma_f32 v4, v5, s4, v4
  v_fma_f32 v7, v6, s5, v7
  s_lshl_b32 s4, s70, 16
  s_and_b32 s5, s70, 0xffff0000
  v_lshlrev_b32 v5, 16, v10
  v_and_b32 v6, 0xffff0000, v10
  v_fma_f32 v4, v5, s4, v4
  v_fma_f32 v7, v6, s5, v7
  s_lshl_b32 s4, s71, 16
  s_and_b32 s5, s71, 0xffff0000
  v_lshlrev_b32 v5, 16, v11
  v_and_b32 v6, 0xffff0000, v11
  v_fma_f32 v4, v5, s4, v4
  v_fma_f32 v7, v6, s5, v7
  s_lshl_b32 s4, s72, 16
  s_and_b32 s5, s72, 0xffff0000
  v_lshlrev_b32 v5, 16, v12
  v_and_b32 v6, 0xffff0000, v12
  v_fma_f32 v4, v5, s4, v4
  v_fma_f32 v7, v6, s5, v7
  s_lshl_b32 s4, s73, 16
  s_and_b32 s5, s73, 0xffff0000
  v_lshlrev_b32 v5, 16, v13
  v_and_b32 v6, 0xffff0000, v13
  v_fma_f32 v4, v5, s4, v4
  v_fma_f32 v7, v6, s5, v7
  s_lshl_b32 s4, s74, 16
  s_and_b32 s5, s74, 0xffff0000
  v_lshlrev_b32 v5, 16, v14
  v_and_b32 v6, 0xffff0000, v14
  v_fma_f32 v4, v5, s4, v4
  v_fma_f32 v7, v6, s5, v7
  s_lshl_b32 s4, s75, 16
  s_and_b32 s5, s75, 0xffff0000
  v_lshlrev_b32 v5, 16, v15
  v_and_b32 v6, 0xffff0000, v15
  v_fma_f32 v4, v5, s4, v4
  v_fma_f32 v7, v6, s5, v7
  s_lshl_b32 s4, s76, 16
  s_and_b32 s5, s76, 0xffff0000
  v_lshlrev_b32 v5, 16, v16
  v_and_b32 v6, 0xffff0000, v16
  v_fma_f32 v4, v5, s4, v4
  v_fma_f32 v7, v6, s5, v7
  s_lshl_b32 s4, s77, 16
  s_and_b32 s5, s77, 0xffff0000
  v_lshlrev_b32 v5, 16, v17
  v_and_b32 v6, 0xffff0000, v17
  v_fma_f32 v4, v5, s4, v4
  v_fma_f32 v7, v6, s5, v7
  s_lshl_b32 s4, s78, 16
  s_and_b32 s5, s78, 0xffff0000
  v_lshlrev_b32 v5, 16, v18
  v_and_b32 v6, 0xffff0000, v18
  v_fma_f32 v4, v5, s4, v4
  v_fma_f32 v7, v6, s5, v7
  s_lshl_b32 s4, s79, 16
  s_and_b32 s5, s79, 0xffff0000
  v_lshlrev_b32 v5, 16, v19
  v_and_b32 v6, 0xffff0000, v19
  v_fma_f32 v4, v5, s4, v4
  v_fma_f32 v7, v6, s5, v7
  s_lshl_b32 s4, s80, 16
  s_and_b32 s5, s80, 0xffff0000
  v_lshlrev_b32 v5, 16, v20
  v_and_b32 v6, 0xffff0000, v20
  v_fma_f32 v4, v5, s4, v4
  v_fma_f32 v7, v6, s5, v7
  s_lshl_b32 s4, s81, 16
  s_and_b32 s5, s81, 0xffff0000
  v_lshlrev_b32 v5, 16, v21
  v_and_b32 v6, 0xffff0000, v21
  v_fma_f32 v4, v5, s4, v4
  v_fma_f32 v7, v6, s5, v7
  s_lshl_b32 s4, s82, 16
  s_and_b32 s5, s82, 0xffff0000
  v_lshlrev_b32 v5, 16, v22
  v_and_b32 v6, 0xffff0000, v22
  v_fma_f32 v4, v5, s4, v4
  v_fma_f32 v7, v6, s5, v7
  s_lshl_b32 s4, s83, 16
  s_and_b32 s5, s83, 0xffff0000
  v_lshlrev_b32 v5, 16, v23
  v_and_b32 v6, 0xffff0000, v23
  v_fma_f32 v4, v5, s4, v4
  v_fma_f32 v7, v6, s5, v7
  s_lshl_b32 s4, s84, 16
  s_and_b32 s5, s84, 0xffff0000
  v_lshlrev_b32 v5, 16, v24
  v_and_b32 v6, 0xffff0000, v24
  v_fma_f32 v4, v5, s4, v4
  v_fma_f32 v7, v6, s5, v7
  s_lshl_b32 s4, s85, 16
  s_and_b32 s5, s85, 0xffff0000
  v_lshlrev_b32 v5, 16, v25
  v_and_b32 v6, 0xffff0000, v25
  v_fma_f32 v4, v5, s4, v4
  v_fma_f32 v7, v6, s5, v7
  s_lshl_b32 s4, s86, 16
  s_and_b32 s5, s86, 0xffff0000
  v_lshlrev_b32 v5, 16, v26
  v_and_b32 v6, 0xffff0000, v26
  v_fma_f32 v4, v5, s4, v4
  v_fma_f32 v7, v6, s5, v7
  s_lshl_b32 s4, s87, 16
  s_and_b32 s5, s87, 0xffff0000
  v_lshlrev_b32 v5, 16, v27
  v_and_b32 v6, 0xffff0000, v27
  v_fma_f32 v4, v5, s4, v4
  v_fma_f32 v7, v6, s5, v7
  s_lshl_b32 s4, s88, 16
  s_and_b32 s5, s88, 0xffff0000
  v_lshlrev_b32 v5, 16, v28
  v_and_b32 v6, 0xffff0000, v28
  v_fma_f32 v4, v5, s4, v4
  v_fma_f32 v7, v6, s5, v7
  s_lshl_b32 s4, s89, 16
  s_and_b32 s5, s89, 0xffff0000
  v_lshlrev_b32 v5, 16, v29
  v_and_b32 v6, 0xffff0000, v29
  v_fma_f32 v4, v5, s4, v4
  v_fma_f32 v7, v6, s5, v7
  s_lshl_b32 s4, s90, 16
  s_and_b32 s5, s90, 0xffff0000
  v_lshlrev_b32 v5, 16, v30
  v_and_b32 v6, 0xffff0000, v30
  v_fma_f32 v4, v5, s4, v4
  v_fma_f32 v7, v6, s5, v7
  s_lshl_b32 s4, s91, 16
  s_and_b32 s5, s91, 0xffff0000
  v_lshlrev_b32 v5, 16, v31
  v_and_b32 v6, 0xffff0000, v31
  v_fma_f32 v4, v5, s4, v4
  v_fma_f32 v7, v6, s5, v7
  s_lshl_b32 s4, s92, 16
  s_and_b32 s5, s92, 0xffff0000
  v_lshlrev_b32 v5, 16, v32
  v_and_b32 v6, 0xffff0000, v32
  v_fma_f32 v4, v5, s4, v4
  v_fma_f32 v7, v6, s5, v7
  s_lshl_b32 s4, s93, 16
  s_and_b32 s5, s93, 0xffff0000
  v_lshlrev_b32 v5, 16, v33
  v_and_b32 v6, 0xffff0000, v33
  v_fma_f32 v4, v5, s4, v4
  v_fma_f32 v7, v6, s5, v7
  s_lshl_b32 s4, s94, 16
  s_and_b32 s5, s94, 0xffff0000
  v_lshlrev_b32 v5, 16, v34
  v_and_b32 v6, 0xffff0000, v34
  v_fma_f32 v4, v5, s4, v4
  v_fma_f32 v7, v6, s5, v7
  s_lshl_b32 s4, s95, 16
  s_and_b32 s5, s95, 0xffff0000
  v_lshlrev_b32 v5, 16, v35
  v_and_b32 v6, 0xffff0000, v35
  v_fma_f32 v4, v5, s4, v4
  v_fma_f32 v7, v6, s5, v7
  s_lshl_b32 s4, s96, 16
  s_and_b32 s5, s96, 0xffff0000
  v_lshlrev_b32 v5, 16, v36
  v_and_b32 v6, 0xffff0000, v36
  v_fma_f32 v4, v5, s4, v4
  v_fma_f32 v7, v6, s5, v7
  s_lshl_b32 s4, s97, 16
  s_and_b32 s5, s97, 0xffff0000
  v_lshlrev_b32 v5, 16, v37
  v_and_b32 v6, 0xffff0000, v37
  v_fma_f32 v4, v5, s4, v4
  v_fma_f32 v7, v6, s5, v7
  s_lshl_b32 s4, s98, 16
  s_and_b32 s5, s98, 0xffff0000
  v_lshlrev_b32 v5, 16, v38
  v_and_b32 v6, 0xffff0000, v38
  v_fma_f32 v4, v5, s4, v4
  v_fma_f32 v7, v6, s5, v7
  s_lshl_b32 s4, s99, 16
  s_and_b32 s5, s99, 0xffff0000
  v_lshlrev_b32 v5, 16, v39
  v_and_b32 v6, 0xffff0000, v39
  v_fma_f32 v4, v5, s4, v4
  v_fma_f32 v7, v6, s5, v7
  s_load_dwordx16 s[68:83], s[38:39], 256
  s_load_dwordx16 s[84:99], s[38:39], 320
  buffer_load_dwordx4 v[8:11], v3, s[52:55], 0 offen offset:256
  buffer_load_dwordx4 v[12:15], v3, s[52:55], 0 offen offset:272
  buffer_load_dwordx4 v[16:19], v3, s[52:55], 0 offen offset:288
  buffer_load_dwordx4 v[20:23], v3, s[52:55], 0 offen offset:304
  buffer_load_dwordx4 v[24:27], v3, s[52:55], 0 offen offset:320
  buffer_load_dwordx4 v[28:31], v3, s[52:55], 0 offen offset:336
  buffer_load_dwordx4 v[32:35], v3, s[52:55], 0 offen offset:352
  buffer_load_dwordx4 v[36:39], v3, s[52:55], 0 offen offset:368
  s_waitcnt vmcnt(0) lgkmcnt(0)
  s_lshl_b32 s4, s68, 16
  s_and_b32 s5, s68, 0xffff0000
  v_lshlrev_b32 v5, 16, v8
  v_and_b32 v6, 0xffff0000, v8
  v_fma_f32 v4, v5, s4, v4
  v_fma_f32 v7, v6, s5, v7
  s_lshl_b32 s4, s69, 16
  s_and_b32 s5, s69, 0xffff0000
  v_lshlrev_b32 v5, 16, v9
  v_and_b32 v6, 0xffff0000, v9
  v_fma_f32 v4, v5, s4, v4
  v_fma_f32 v7, v6, s5, v7
  s_lshl_b32 s4, s70, 16
  s_and_b32 s5, s70, 0xffff0000
  v_lshlrev_b32 v5, 16, v10
  v_and_b32 v6, 0xffff0000, v10
  v_fma_f32 v4, v5, s4, v4
  v_fma_f32 v7, v6, s5, v7
  s_lshl_b32 s4, s71, 16
  s_and_b32 s5, s71, 0xffff0000
  v_lshlrev_b32 v5, 16, v11
  v_and_b32 v6, 0xffff0000, v11
  v_fma_f32 v4, v5, s4, v4
  v_fma_f32 v7, v6, s5, v7
  s_lshl_b32 s4, s72, 16
  s_and_b32 s5, s72, 0xffff0000
  v_lshlrev_b32 v5, 16, v12
  v_and_b32 v6, 0xffff0000, v12
  v_fma_f32 v4, v5, s4, v4
  v_fma_f32 v7, v6, s5, v7
  s_lshl_b32 s4, s73, 16
  s_and_b32 s5, s73, 0xffff0000
  v_lshlrev_b32 v5, 16, v13
  v_and_b32 v6, 0xffff0000, v13
  v_fma_f32 v4, v5, s4, v4
  v_fma_f32 v7, v6, s5, v7
  s_lshl_b32 s4, s74, 16
  s_and_b32 s5, s74, 0xffff0000
  v_lshlrev_b32 v5, 16, v14
  v_and_b32 v6, 0xffff0000, v14
  v_fma_f32 v4, v5, s4, v4
  v_fma_f32 v7, v6, s5, v7
  s_lshl_b32 s4, s75, 16
  s_and_b32 s5, s75, 0xffff0000
  v_lshlrev_b32 v5, 16, v15
  v_and_b32 v6, 0xffff0000, v15
  v_fma_f32 v4, v5, s4, v4
  v_fma_f32 v7, v6, s5, v7
  s_lshl_b32 s4, s76, 16
  s_and_b32 s5, s76, 0xffff0000
  v_lshlrev_b32 v5, 16, v16
  v_and_b32 v6, 0xffff0000, v16
  v_fma_f32 v4, v5, s4, v4
  v_fma_f32 v7, v6, s5, v7
  s_lshl_b32 s4, s77, 16
  s_and_b32 s5, s77, 0xffff0000
  v_lshlrev_b32 v5, 16, v17
  v_and_b32 v6, 0xffff0000, v17
  v_fma_f32 v4, v5, s4, v4
  v_fma_f32 v7, v6, s5, v7
  s_lshl_b32 s4, s78, 16
  s_and_b32 s5, s78, 0xffff0000
  v_lshlrev_b32 v5, 16, v18
  v_and_b32 v6, 0xffff0000, v18
  v_fma_f32 v4, v5, s4, v4
  v_fma_f32 v7, v6, s5, v7
  s_lshl_b32 s4, s79, 16
  s_and_b32 s5, s79, 0xffff0000
  v_lshlrev_b32 v5, 16, v19
  v_and_b32 v6, 0xffff0000, v19
  v_fma_f32 v4, v5, s4, v4
  v_fma_f32 v7, v6, s5, v7
  s_lshl_b32 s4, s80, 16
  s_and_b32 s5, s80, 0xffff0000
  v_lshlrev_b32 v5, 16, v20
  v_and_b32 v6, 0xffff0000, v20
  v_fma_f32 v4, v5, s4, v4
  v_fma_f32 v7, v6, s5, v7
  s_lshl_b32 s4, s81, 16
  s_and_b32 s5, s81, 0xffff0000
  v_lshlrev_b32 v5, 16, v21
  v_and_b32 v6, 0xffff0000, v21
  v_fma_f32 v4, v5, s4, v4
  v_fma_f32 v7, v6, s5, v7
  s_lshl_b32 s4, s82, 16
  s_and_b32 s5, s82, 0xffff0000
  v_lshlrev_b32 v5, 16, v22
  v_and_b32 v6, 0xffff0000, v22
  v_fma_f32 v4, v5, s4, v4
  v_fma_f32 v7, v6, s5, v7
  s_lshl_b32 s4, s83, 16
  s_and_b32 s5, s83, 0xffff0000
  v_lshlrev_b32 v5, 16, v23
  v_and_b32 v6, 0xffff0000, v23
  v_fma_f32 v4, v5, s4, v4
  v_fma_f32 v7, v6, s5, v7
  s_lshl_b32 s4, s84, 16
  s_and_b32 s5, s84, 0xffff0000
  v_lshlrev_b32 v5, 16, v24
  v_and_b32 v6, 0xffff0000, v24
  v_fma_f32 v4, v5, s4, v4
  v_fma_f32 v7, v6, s5, v7
  s_lshl_b32 s4, s85, 16
  s_and_b32 s5, s85, 0xffff0000
  v_lshlrev_b32 v5, 16, v25
  v_and_b32 v6, 0xffff0000, v25
  v_fma_f32 v4, v5, s4, v4
  v_fma_f32 v7, v6, s5, v7
  s_lshl_b32 s4, s86, 16
  s_and_b32 s5, s86, 0xffff0000
  v_lshlrev_b32 v5, 16, v26
  v_and_b32 v6, 0xffff0000, v26
  v_fma_f32 v4, v5, s4, v4
  v_fma_f32 v7, v6, s5, v7
  s_lshl_b32 s4, s87, 16
  s_and_b32 s5, s87, 0xffff0000
  v_lshlrev_b32 v5, 16, v27
  v_and_b32 v6, 0xffff0000, v27
  v_fma_f32 v4, v5, s4, v4
  v_fma_f32 v7, v6, s5, v7
  s_lshl_b32 s4, s88, 16
  s_and_b32 s5, s88, 0xffff0000
  v_lshlrev_b32 v5, 16, v28
  v_and_b32 v6, 0xffff0000, v28
  v_fma_f32 v4, v5, s4, v4
  v_fma_f32 v7, v6, s5, v7
  s_lshl_b32 s4, s89, 16
  s_and_b32 s5, s89, 0xffff0000
  v_lshlrev_b32 v5, 16, v29
  v_and_b32 v6, 0xffff0000, v29
  v_fma_f32 v4, v5, s4, v4
  v_fma_f32 v7, v6, s5, v7
  s_lshl_b32 s4, s90, 16
  s_and_b32 s5, s90, 0xffff0000
  v_lshlrev_b32 v5, 16, v30
  v_and_b32 v6, 0xffff0000, v30
  v_fma_f32 v4, v5, s4, v4
  v_fma_f32 v7, v6, s5, v7
  s_lshl_b32 s4, s91, 16
  s_and_b32 s5, s91, 0xffff0000
  v_lshlrev_b32 v5, 16, v31
  v_and_b32 v6, 0xffff0000, v31
  v_fma_f32 v4, v5, s4, v4
  v_fma_f32 v7, v6, s5, v7
  s_lshl_b32 s4, s92, 16
  s_and_b32 s5, s92, 0xffff0000
  v_lshlrev_b32 v5, 16, v32
  v_and_b32 v6, 0xffff0000, v32
  v_fma_f32 v4, v5, s4, v4
  v_fma_f32 v7, v6, s5, v7
  s_lshl_b32 s4, s93, 16
  s_and_b32 s5, s93, 0xffff0000
  v_lshlrev_b32 v5, 16, v33
  v_and_b32 v6, 0xffff0000, v33
  v_fma_f32 v4, v5, s4, v4
  v_fma_f32 v7, v6, s5, v7
  s_lshl_b32 s4, s94, 16
  s_and_b32 s5, s94, 0xffff0000
  v_lshlrev_b32 v5, 16, v34
  v_and_b32 v6, 0xffff0000, v34
  v_fma_f32 v4, v5, s4, v4
  v_fma_f32 v7, v6, s5, v7
  s_lshl_b32 s4, s95, 16
  s_and_b32 s5, s95, 0xffff0000
  v_lshlrev_b32 v5, 16, v35
  v_and_b32 v6, 0xffff0000, v35
  v_fma_f32 v4, v5, s4, v4
  v_fma_f32 v7, v6, s5, v7
  s_lshl_b32 s4, s96, 16
  s_and_b32 s5, s96, 0xffff0000
  v_lshlrev_b32 v5, 16, v36
  v_and_b32 v6, 0xffff0000, v36
  v_fma_f32 v4, v5, s4, v4
  v_fma_f32 v7, v6, s5, v7
  s_lshl_b32 s4, s97, 16
  s_and_b32 s5, s97, 0xffff0000
  v_lshlrev_b32 v5, 16, v37
  v_and_b32 v6, 0xffff0000, v37
  v_fma_f32 v4, v5, s4, v4
  v_fma_f32 v7, v6, s5, v7
  s_lshl_b32 s4, s98, 16
  s_and_b32 s5, s98, 0xffff0000
  v_lshlrev_b32 v5, 16, v38
  v_and_b32 v6, 0xffff0000, v38
  v_fma_f32 v4, v5, s4, v4
  v_fma_f32 v7, v6, s5, v7
  s_lshl_b32 s4, s99, 16
  s_and_b32 s5, s99, 0xffff0000
  v_lshlrev_b32 v5, 16, v39
  v_and_b32 v6, 0xffff0000, v39
  v_fma_f32 v4, v5, s4, v4
  v_fma_f32 v7, v6, s5, v7
  s_load_dwordx16 s[68:83], s[38:39], 384
  s_load_dwordx16 s[84:99], s[38:39], 448
  buffer_load_dwordx4 v[8:11], v3, s[52:55], 0 offen offset:384
  buffer_load_dwordx4 v[12:15], v3, s[52:55], 0 offen offset:400
  buffer_load_dwordx4 v[16:19], v3, s[52:55], 0 offen offset:416
  buffer_load_dwordx4 v[20:23], v3, s[52:55], 0 offen offset:432
  buffer_load_dwordx4 v[24:27], v3, s[52:55], 0 offen offset:448
  buffer_load_dwordx4 v[28:31], v3, s[52:55], 0 offen offset:464
  buffer_load_dwordx4 v[32:35], v3, s[52:55], 0 offen offset:480
  buffer_load_dwordx4 v[36:39], v3, s[52:55], 0 offen offset:496
  s_waitcnt vmcnt(0) lgkmcnt(0)
  s_lshl_b32 s4, s68, 16
  s_and_b32 s5, s68, 0xffff0000
  v_lshlrev_b32 v5, 16, v8
  v_and_b32 v6, 0xffff0000, v8
  v_fma_f32 v4, v5, s4, v4
  v_fma_f32 v7, v6, s5, v7
  s_lshl_b32 s4, s69, 16
  s_and_b32 s5, s69, 0xffff0000
  v_lshlrev_b32 v5, 16, v9
  v_and_b32 v6, 0xffff0000, v9
  v_fma_f32 v4, v5, s4, v4
  v_fma_f32 v7, v6, s5, v7
  s_lshl_b32 s4, s70, 16
  s_and_b32 s5, s70, 0xffff0000
  v_lshlrev_b32 v5, 16, v10
  v_and_b32 v6, 0xffff0000, v10
  v_fma_f32 v4, v5, s4, v4
  v_fma_f32 v7, v6, s5, v7
  s_lshl_b32 s4, s71, 16
  s_and_b32 s5, s71, 0xffff0000
  v_lshlrev_b32 v5, 16, v11
  v_and_b32 v6, 0xffff0000, v11
  v_fma_f32 v4, v5, s4, v4
  v_fma_f32 v7, v6, s5, v7
  s_lshl_b32 s4, s72, 16
  s_and_b32 s5, s72, 0xffff0000
  v_lshlrev_b32 v5, 16, v12
  v_and_b32 v6, 0xffff0000, v12
  v_fma_f32 v4, v5, s4, v4
  v_fma_f32 v7, v6, s5, v7
  s_lshl_b32 s4, s73, 16
  s_and_b32 s5, s73, 0xffff0000
  v_lshlrev_b32 v5, 16, v13
  v_and_b32 v6, 0xffff0000, v13
  v_fma_f32 v4, v5, s4, v4
  v_fma_f32 v7, v6, s5, v7
  s_lshl_b32 s4, s74, 16
  s_and_b32 s5, s74, 0xffff0000
  v_lshlrev_b32 v5, 16, v14
  v_and_b32 v6, 0xffff0000, v14
  v_fma_f32 v4, v5, s4, v4
  v_fma_f32 v7, v6, s5, v7
  s_lshl_b32 s4, s75, 16
  s_and_b32 s5, s75, 0xffff0000
  v_lshlrev_b32 v5, 16, v15
  v_and_b32 v6, 0xffff0000, v15
  v_fma_f32 v4, v5, s4, v4
  v_fma_f32 v7, v6, s5, v7
  s_lshl_b32 s4, s76, 16
  s_and_b32 s5, s76, 0xffff0000
  v_lshlrev_b32 v5, 16, v16
  v_and_b32 v6, 0xffff0000, v16
  v_fma_f32 v4, v5, s4, v4
  v_fma_f32 v7, v6, s5, v7
  s_lshl_b32 s4, s77, 16
  s_and_b32 s5, s77, 0xffff0000
  v_lshlrev_b32 v5, 16, v17
  v_and_b32 v6, 0xffff0000, v17
  v_fma_f32 v4, v5, s4, v4
  v_fma_f32 v7, v6, s5, v7
  s_lshl_b32 s4, s78, 16
  s_and_b32 s5, s78, 0xffff0000
  v_lshlrev_b32 v5, 16, v18
  v_and_b32 v6, 0xffff0000, v18
  v_fma_f32 v4, v5, s4, v4
  v_fma_f32 v7, v6, s5, v7
  s_lshl_b32 s4, s79, 16
  s_and_b32 s5, s79, 0xffff0000
  v_lshlrev_b32 v5, 16, v19
  v_and_b32 v6, 0xffff0000, v19
  v_fma_f32 v4, v5, s4, v4
  v_fma_f32 v7, v6, s5, v7
  s_lshl_b32 s4, s80, 16
  s_and_b32 s5, s80, 0xffff0000
  v_lshlrev_b32 v5, 16, v20
  v_and_b32 v6, 0xffff0000, v20
  v_fma_f32 v4, v5, s4, v4
  v_fma_f32 v7, v6, s5, v7
  s_lshl_b32 s4, s81, 16
  s_and_b32 s5, s81, 0xffff0000
  v_lshlrev_b32 v5, 16, v21
  v_and_b32 v6, 0xffff0000, v21
  v_fma_f32 v4, v5, s4, v4
  v_fma_f32 v7, v6, s5, v7
  s_lshl_b32 s4, s82, 16
  s_and_b32 s5, s82, 0xffff0000
  v_lshlrev_b32 v5, 16, v22
  v_and_b32 v6, 0xffff0000, v22
  v_fma_f32 v4, v5, s4, v4
  v_fma_f32 v7, v6, s5, v7
  s_lshl_b32 s4, s83, 16
  s_and_b32 s5, s83, 0xffff0000
  v_lshlrev_b32 v5, 16, v23
  v_and_b32 v6, 0xffff0000, v23
  v_fma_f32 v4, v5, s4, v4
  v_fma_f32 v7, v6, s5, v7
  s_lshl_b32 s4, s84, 16
  s_and_b32 s5, s84, 0xffff0000
  v_lshlrev_b32 v5, 16, v24
  v_and_b32 v6, 0xffff0000, v24
  v_fma_f32 v4, v5, s4, v4
  v_fma_f32 v7, v6, s5, v7
  s_lshl_b32 s4, s85, 16
  s_and_b32 s5, s85, 0xffff0000
  v_lshlrev_b32 v5, 16, v25
  v_and_b32 v6, 0xffff0000, v25
  v_fma_f32 v4, v5, s4, v4
  v_fma_f32 v7, v6, s5, v7
  s_lshl_b32 s4, s86, 16
  s_and_b32 s5, s86, 0xffff0000
  v_lshlrev_b32 v5, 16, v26
  v_and_b32 v6, 0xffff0000, v26
  v_fma_f32 v4, v5, s4, v4
  v_fma_f32 v7, v6, s5, v7
  s_lshl_b32 s4, s87, 16
  s_and_b32 s5, s87, 0xffff0000
  v_lshlrev_b32 v5, 16, v27
  v_and_b32 v6, 0xffff0000, v27
  v_fma_f32 v4, v5, s4, v4
  v_fma_f32 v7, v6, s5, v7
  s_lshl_b32 s4, s88, 16
  s_and_b32 s5, s88, 0xffff0000
  v_lshlrev_b32 v5, 16, v28
  v_and_b32 v6, 0xffff0000, v28
  v_fma_f32 v4, v5, s4, v4
  v_fma_f32 v7, v6, s5, v7
  s_lshl_b32 s4, s89, 16
  s_and_b32 s5, s89, 0xffff0000
  v_lshlrev_b32 v5, 16, v29
  v_and_b32 v6, 0xffff0000, v29
  v_fma_f32 v4, v5, s4, v4
  v_fma_f32 v7, v6, s5, v7
  s_lshl_b32 s4, s90, 16
  s_and_b32 s5, s90, 0xffff0000
  v_lshlrev_b32 v5, 16, v30
  v_and_b32 v6, 0xffff0000, v30
  v_fma_f32 v4, v5, s4, v4
  v_fma_f32 v7, v6, s5, v7
  s_lshl_b32 s4, s91, 16
  s_and_b32 s5, s91, 0xffff0000
  v_lshlrev_b32 v5, 16, v31
  v_and_b32 v6, 0xffff0000, v31
  v_fma_f32 v4, v5, s4, v4
  v_fma_f32 v7, v6, s5, v7
  s_lshl_b32 s4, s92, 16
  s_and_b32 s5, s92, 0xffff0000
  v_lshlrev_b32 v5, 16, v32
  v_and_b32 v6, 0xffff0000, v32
  v_fma_f32 v4, v5, s4, v4
  v_fma_f32 v7, v6, s5, v7
  s_lshl_b32 s4, s93, 16
  s_and_b32 s5, s93, 0xffff0000
  v_lshlrev_b32 v5, 16, v33
  v_and_b32 v6, 0xffff0000, v33
  v_fma_f32 v4, v5, s4, v4
  v_fma_f32 v7, v6, s5, v7
  s_lshl_b32 s4, s94, 16
  s_and_b32 s5, s94, 0xffff0000
  v_lshlrev_b32 v5, 16, v34
  v_and_b32 v6, 0xffff0000, v34
  v_fma_f32 v4, v5, s4, v4
  v_fma_f32 v7, v6, s5, v7
  s_lshl_b32 s4, s95, 16
  s_and_b32 s5, s95, 0xffff0000
  v_lshlrev_b32 v5, 16, v35
  v_and_b32 v6, 0xffff0000, v35
  v_fma_f32 v4, v5, s4, v4
  v_fma_f32 v7, v6, s5, v7
  s_lshl_b32 s4, s96, 16
  s_and_b32 s5, s96, 0xffff0000
  v_lshlrev_b32 v5, 16, v36
  v_and_b32 v6, 0xffff0000, v36
  v_fma_f32 v4, v5, s4, v4
  v_fma_f32 v7, v6, s5, v7
  s_lshl_b32 s4, s97, 16
  s_and_b32 s5, s97, 0xffff0000
  v_lshlrev_b32 v5, 16, v37
  v_and_b32 v6, 0xffff0000, v37
  v_fma_f32 v4, v5, s4, v4
  v_fma_f32 v7, v6, s5, v7
  s_lshl_b32 s4, s98, 16
  s_and_b32 s5, s98, 0xffff0000
  v_lshlrev_b32 v5, 16, v38
  v_and_b32 v6, 0xffff0000, v38
  v_fma_f32 v4, v5, s4, v4
  v_fma_f32 v7, v6, s5, v7
  s_lshl_b32 s4, s99, 16
  s_and_b32 s5, s99, 0xffff0000
  v_lshlrev_b32 v5, 16, v39
  v_and_b32 v6, 0xffff0000, v39
  v_fma_f32 v4, v5, s4, v4
  v_fma_f32 v7, v6, s5, v7
  s_load_dwordx16 s[68:83], s[38:39], 512
  s_load_dwordx16 s[84:99], s[38:39], 576
  buffer_load_dwordx4 v[8:11], v3, s[52:55], 0 offen offset:512
  buffer_load_dwordx4 v[12:15], v3, s[52:55], 0 offen offset:528
  buffer_load_dwordx4 v[16:19], v3, s[52:55], 0 offen offset:544
  buffer_load_dwordx4 v[20:23], v3, s[52:55], 0 offen offset:560
  buffer_load_dwordx4 v[24:27], v3, s[52:55], 0 offen offset:576
  buffer_load_dwordx4 v[28:31], v3, s[52:55], 0 offen offset:592
  buffer_load_dwordx4 v[32:35], v3, s[52:55], 0 offen offset:608
  buffer_load_dwordx4 v[36:39], v3, s[52:55], 0 offen offset:624
  s_waitcnt vmcnt(0) lgkmcnt(0)
  s_lshl_b32 s4, s68, 16
  s_and_b32 s5, s68, 0xffff0000
  v_lshlrev_b32 v5, 16, v8
  v_and_b32 v6, 0xffff0000, v8
  v_fma_f32 v4, v5, s4, v4
  v_fma_f32 v7, v6, s5, v7
  s_lshl_b32 s4, s69, 16
  s_and_b32 s5, s69, 0xffff0000
  v_lshlrev_b32 v5, 16, v9
  v_and_b32 v6, 0xffff0000, v9
  v_fma_f32 v4, v5, s4, v4
  v_fma_f32 v7, v6, s5, v7
  s_lshl_b32 s4, s70, 16
  s_and_b32 s5, s70, 0xffff0000
  v_lshlrev_b32 v5, 16, v10
  v_and_b32 v6, 0xffff0000, v10
  v_fma_f32 v4, v5, s4, v4
  v_fma_f32 v7, v6, s5, v7
  s_lshl_b32 s4, s71, 16
  s_and_b32 s5, s71, 0xffff0000
  v_lshlrev_b32 v5, 16, v11
  v_and_b32 v6, 0xffff0000, v11
  v_fma_f32 v4, v5, s4, v4
  v_fma_f32 v7, v6, s5, v7
  s_lshl_b32 s4, s72, 16
  s_and_b32 s5, s72, 0xffff0000
  v_lshlrev_b32 v5, 16, v12
  v_and_b32 v6, 0xffff0000, v12
  v_fma_f32 v4, v5, s4, v4
  v_fma_f32 v7, v6, s5, v7
  s_lshl_b32 s4, s73, 16
  s_and_b32 s5, s73, 0xffff0000
  v_lshlrev_b32 v5, 16, v13
  v_and_b32 v6, 0xffff0000, v13
  v_fma_f32 v4, v5, s4, v4
  v_fma_f32 v7, v6, s5, v7
  s_lshl_b32 s4, s74, 16
  s_and_b32 s5, s74, 0xffff0000
  v_lshlrev_b32 v5, 16, v14
  v_and_b32 v6, 0xffff0000, v14
  v_fma_f32 v4, v5, s4, v4
  v_fma_f32 v7, v6, s5, v7
  s_lshl_b32 s4, s75, 16
  s_and_b32 s5, s75, 0xffff0000
  v_lshlrev_b32 v5, 16, v15
  v_and_b32 v6, 0xffff0000, v15
  v_fma_f32 v4, v5, s4, v4
  v_fma_f32 v7, v6, s5, v7
  s_lshl_b32 s4, s76, 16
  s_and_b32 s5, s76, 0xffff0000
  v_lshlrev_b32 v5, 16, v16
  v_and_b32 v6, 0xffff0000, v16
  v_fma_f32 v4, v5, s4, v4
  v_fma_f32 v7, v6, s5, v7
  s_lshl_b32 s4, s77, 16
  s_and_b32 s5, s77, 0xffff0000
  v_lshlrev_b32 v5, 16, v17
  v_and_b32 v6, 0xffff0000, v17
  v_fma_f32 v4, v5, s4, v4
  v_fma_f32 v7, v6, s5, v7
  s_lshl_b32 s4, s78, 16
  s_and_b32 s5, s78, 0xffff0000
  v_lshlrev_b32 v5, 16, v18
  v_and_b32 v6, 0xffff0000, v18
  v_fma_f32 v4, v5, s4, v4
  v_fma_f32 v7, v6, s5, v7
  s_lshl_b32 s4, s79, 16
  s_and_b32 s5, s79, 0xffff0000
  v_lshlrev_b32 v5, 16, v19
  v_and_b32 v6, 0xffff0000, v19
  v_fma_f32 v4, v5, s4, v4
  v_fma_f32 v7, v6, s5, v7
  s_lshl_b32 s4, s80, 16
  s_and_b32 s5, s80, 0xffff0000
  v_lshlrev_b32 v5, 16, v20
  v_and_b32 v6, 0xffff0000, v20
  v_fma_f32 v4, v5, s4, v4
  v_fma_f32 v7, v6, s5, v7
  s_lshl_b32 s4, s81, 16
  s_and_b32 s5, s81, 0xffff0000
  v_lshlrev_b32 v5, 16, v21
  v_and_b32 v6, 0xffff0000, v21
  v_fma_f32 v4, v5, s4, v4
  v_fma_f32 v7, v6, s5, v7
  s_lshl_b32 s4, s82, 16
  s_and_b32 s5, s82, 0xffff0000
  v_lshlrev_b32 v5, 16, v22
  v_and_b32 v6, 0xffff0000, v22
  v_fma_f32 v4, v5, s4, v4
  v_fma_f32 v7, v6, s5, v7
  s_lshl_b32 s4, s83, 16
  s_and_b32 s5, s83, 0xffff0000
  v_lshlrev_b32 v5, 16, v23
  v_and_b32 v6, 0xffff0000, v23
  v_fma_f32 v4, v5, s4, v4
  v_fma_f32 v7, v6, s5, v7
  s_lshl_b32 s4, s84, 16
  s_and_b32 s5, s84, 0xffff0000
  v_lshlrev_b32 v5, 16, v24
  v_and_b32 v6, 0xffff0000, v24
  v_fma_f32 v4, v5, s4, v4
  v_fma_f32 v7, v6, s5, v7
  s_lshl_b32 s4, s85, 16
  s_and_b32 s5, s85, 0xffff0000
  v_lshlrev_b32 v5, 16, v25
  v_and_b32 v6, 0xffff0000, v25
  v_fma_f32 v4, v5, s4, v4
  v_fma_f32 v7, v6, s5, v7
  s_lshl_b32 s4, s86, 16
  s_and_b32 s5, s86, 0xffff0000
  v_lshlrev_b32 v5, 16, v26
  v_and_b32 v6, 0xffff0000, v26
  v_fma_f32 v4, v5, s4, v4
  v_fma_f32 v7, v6, s5, v7
  s_lshl_b32 s4, s87, 16
  s_and_b32 s5, s87, 0xffff0000
  v_lshlrev_b32 v5, 16, v27
  v_and_b32 v6, 0xffff0000, v27
  v_fma_f32 v4, v5, s4, v4
  v_fma_f32 v7, v6, s5, v7
  s_lshl_b32 s4, s88, 16
  s_and_b32 s5, s88, 0xffff0000
  v_lshlrev_b32 v5, 16, v28
  v_and_b32 v6, 0xffff0000, v28
  v_fma_f32 v4, v5, s4, v4
  v_fma_f32 v7, v6, s5, v7
  s_lshl_b32 s4, s89, 16
  s_and_b32 s5, s89, 0xffff0000
  v_lshlrev_b32 v5, 16, v29
  v_and_b32 v6, 0xffff0000, v29
  v_fma_f32 v4, v5, s4, v4
  v_fma_f32 v7, v6, s5, v7
  s_lshl_b32 s4, s90, 16
  s_and_b32 s5, s90, 0xffff0000
  v_lshlrev_b32 v5, 16, v30
  v_and_b32 v6, 0xffff0000, v30
  v_fma_f32 v4, v5, s4, v4
  v_fma_f32 v7, v6, s5, v7
  s_lshl_b32 s4, s91, 16
  s_and_b32 s5, s91, 0xffff0000
  v_lshlrev_b32 v5, 16, v31
  v_and_b32 v6, 0xffff0000, v31
  v_fma_f32 v4, v5, s4, v4
  v_fma_f32 v7, v6, s5, v7
  s_lshl_b32 s4, s92, 16
  s_and_b32 s5, s92, 0xffff0000
  v_lshlrev_b32 v5, 16, v32
  v_and_b32 v6, 0xffff0000, v32
  v_fma_f32 v4, v5, s4, v4
  v_fma_f32 v7, v6, s5, v7
  s_lshl_b32 s4, s93, 16
  s_and_b32 s5, s93, 0xffff0000
  v_lshlrev_b32 v5, 16, v33
  v_and_b32 v6, 0xffff0000, v33
  v_fma_f32 v4, v5, s4, v4
  v_fma_f32 v7, v6, s5, v7
  s_lshl_b32 s4, s94, 16
  s_and_b32 s5, s94, 0xffff0000
  v_lshlrev_b32 v5, 16, v34
  v_and_b32 v6, 0xffff0000, v34
  v_fma_f32 v4, v5, s4, v4
  v_fma_f32 v7, v6, s5, v7
  s_lshl_b32 s4, s95, 16
  s_and_b32 s5, s95, 0xffff0000
  v_lshlrev_b32 v5, 16, v35
  v_and_b32 v6, 0xffff0000, v35
  v_fma_f32 v4, v5, s4, v4
  v_fma_f32 v7, v6, s5, v7
  s_lshl_b32 s4, s96, 16
  s_and_b32 s5, s96, 0xffff0000
  v_lshlrev_b32 v5, 16, v36
  v_and_b32 v6, 0xffff0000, v36
  v_fma_f32 v4, v5, s4, v4
  v_fma_f32 v7, v6, s5, v7
  s_lshl_b32 s4, s97, 16
  s_and_b32 s5, s97, 0xffff0000
  v_lshlrev_b32 v5, 16, v37
  v_and_b32 v6, 0xffff0000, v37
  v_fma_f32 v4, v5, s4, v4
  v_fma_f32 v7, v6, s5, v7
  s_lshl_b32 s4, s98, 16
  s_and_b32 s5, s98, 0xffff0000
  v_lshlrev_b32 v5, 16, v38
  v_and_b32 v6, 0xffff0000, v38
  v_fma_f32 v4, v5, s4, v4
  v_fma_f32 v7, v6, s5, v7
  s_lshl_b32 s4, s99, 16
  s_and_b32 s5, s99, 0xffff0000
  v_lshlrev_b32 v5, 16, v39
  v_and_b32 v6, 0xffff0000, v39
  v_fma_f32 v4, v5, s4, v4
  v_fma_f32 v7, v6, s5, v7
  s_load_dwordx16 s[68:83], s[38:39], 640
  s_load_dwordx16 s[84:99], s[38:39], 704
  buffer_load_dwordx4 v[8:11], v3, s[52:55], 0 offen offset:640
  buffer_load_dwordx4 v[12:15], v3, s[52:55], 0 offen offset:656
  buffer_load_dwordx4 v[16:19], v3, s[52:55], 0 offen offset:672
  buffer_load_dwordx4 v[20:23], v3, s[52:55], 0 offen offset:688
  buffer_load_dwordx4 v[24:27], v3, s[52:55], 0 offen offset:704
  buffer_load_dwordx4 v[28:31], v3, s[52:55], 0 offen offset:720
  buffer_load_dwordx4 v[32:35], v3, s[52:55], 0 offen offset:736
  buffer_load_dwordx4 v[36:39], v3, s[52:55], 0 offen offset:752
  s_waitcnt vmcnt(0) lgkmcnt(0)
  s_lshl_b32 s4, s68, 16
  s_and_b32 s5, s68, 0xffff0000
  v_lshlrev_b32 v5, 16, v8
  v_and_b32 v6, 0xffff0000, v8
  v_fma_f32 v4, v5, s4, v4
  v_fma_f32 v7, v6, s5, v7
  s_lshl_b32 s4, s69, 16
  s_and_b32 s5, s69, 0xffff0000
  v_lshlrev_b32 v5, 16, v9
  v_and_b32 v6, 0xffff0000, v9
  v_fma_f32 v4, v5, s4, v4
  v_fma_f32 v7, v6, s5, v7
  s_lshl_b32 s4, s70, 16
  s_and_b32 s5, s70, 0xffff0000
  v_lshlrev_b32 v5, 16, v10
  v_and_b32 v6, 0xffff0000, v10
  v_fma_f32 v4, v5, s4, v4
  v_fma_f32 v7, v6, s5, v7
  s_lshl_b32 s4, s71, 16
  s_and_b32 s5, s71, 0xffff0000
  v_lshlrev_b32 v5, 16, v11
  v_and_b32 v6, 0xffff0000, v11
  v_fma_f32 v4, v5, s4, v4
  v_fma_f32 v7, v6, s5, v7
  s_lshl_b32 s4, s72, 16
  s_and_b32 s5, s72, 0xffff0000
  v_lshlrev_b32 v5, 16, v12
  v_and_b32 v6, 0xffff0000, v12
  v_fma_f32 v4, v5, s4, v4
  v_fma_f32 v7, v6, s5, v7
  s_lshl_b32 s4, s73, 16
  s_and_b32 s5, s73, 0xffff0000
  v_lshlrev_b32 v5, 16, v13
  v_and_b32 v6, 0xffff0000, v13
  v_fma_f32 v4, v5, s4, v4
  v_fma_f32 v7, v6, s5, v7
  s_lshl_b32 s4, s74, 16
  s_and_b32 s5, s74, 0xffff0000
  v_lshlrev_b32 v5, 16, v14
  v_and_b32 v6, 0xffff0000, v14
  v_fma_f32 v4, v5, s4, v4
  v_fma_f32 v7, v6, s5, v7
  s_lshl_b32 s4, s75, 16
  s_and_b32 s5, s75, 0xffff0000
  v_lshlrev_b32 v5, 16, v15
  v_and_b32 v6, 0xffff0000, v15
  v_fma_f32 v4, v5, s4, v4
  v_fma_f32 v7, v6, s5, v7
  s_lshl_b32 s4, s76, 16
  s_and_b32 s5, s76, 0xffff0000
  v_lshlrev_b32 v5, 16, v16
  v_and_b32 v6, 0xffff0000, v16
  v_fma_f32 v4, v5, s4, v4
  v_fma_f32 v7, v6, s5, v7
  s_lshl_b32 s4, s77, 16
  s_and_b32 s5, s77, 0xffff0000
  v_lshlrev_b32 v5, 16, v17
  v_and_b32 v6, 0xffff0000, v17
  v_fma_f32 v4, v5, s4, v4
  v_fma_f32 v7, v6, s5, v7
  s_lshl_b32 s4, s78, 16
  s_and_b32 s5, s78, 0xffff0000
  v_lshlrev_b32 v5, 16, v18
  v_and_b32 v6, 0xffff0000, v18
  v_fma_f32 v4, v5, s4, v4
  v_fma_f32 v7, v6, s5, v7
  s_lshl_b32 s4, s79, 16
  s_and_b32 s5, s79, 0xffff0000
  v_lshlrev_b32 v5, 16, v19
  v_and_b32 v6, 0xffff0000, v19
  v_fma_f32 v4, v5, s4, v4
  v_fma_f32 v7, v6, s5, v7
  s_lshl_b32 s4, s80, 16
  s_and_b32 s5, s80, 0xffff0000
  v_lshlrev_b32 v5, 16, v20
  v_and_b32 v6, 0xffff0000, v20
  v_fma_f32 v4, v5, s4, v4
  v_fma_f32 v7, v6, s5, v7
  s_lshl_b32 s4, s81, 16
  s_and_b32 s5, s81, 0xffff0000
  v_lshlrev_b32 v5, 16, v21
  v_and_b32 v6, 0xffff0000, v21
  v_fma_f32 v4, v5, s4, v4
  v_fma_f32 v7, v6, s5, v7
  s_lshl_b32 s4, s82, 16
  s_and_b32 s5, s82, 0xffff0000
  v_lshlrev_b32 v5, 16, v22
  v_and_b32 v6, 0xffff0000, v22
  v_fma_f32 v4, v5, s4, v4
  v_fma_f32 v7, v6, s5, v7
  s_lshl_b32 s4, s83, 16
  s_and_b32 s5, s83, 0xffff0000
  v_lshlrev_b32 v5, 16, v23
  v_and_b32 v6, 0xffff0000, v23
  v_fma_f32 v4, v5, s4, v4
  v_fma_f32 v7, v6, s5, v7
  s_lshl_b32 s4, s84, 16
  s_and_b32 s5, s84, 0xffff0000
  v_lshlrev_b32 v5, 16, v24
  v_and_b32 v6, 0xffff0000, v24
  v_fma_f32 v4, v5, s4, v4
  v_fma_f32 v7, v6, s5, v7
  s_lshl_b32 s4, s85, 16
  s_and_b32 s5, s85, 0xffff0000
  v_lshlrev_b32 v5, 16, v25
  v_and_b32 v6, 0xffff0000, v25
  v_fma_f32 v4, v5, s4, v4
  v_fma_f32 v7, v6, s5, v7
  s_lshl_b32 s4, s86, 16
  s_and_b32 s5, s86, 0xffff0000
  v_lshlrev_b32 v5, 16, v26
  v_and_b32 v6, 0xffff0000, v26
  v_fma_f32 v4, v5, s4, v4
  v_fma_f32 v7, v6, s5, v7
  s_lshl_b32 s4, s87, 16
  s_and_b32 s5, s87, 0xffff0000
  v_lshlrev_b32 v5, 16, v27
  v_and_b32 v6, 0xffff0000, v27
  v_fma_f32 v4, v5, s4, v4
  v_fma_f32 v7, v6, s5, v7
  s_lshl_b32 s4, s88, 16
  s_and_b32 s5, s88, 0xffff0000
  v_lshlrev_b32 v5, 16, v28
  v_and_b32 v6, 0xffff0000, v28
  v_fma_f32 v4, v5, s4, v4
  v_fma_f32 v7, v6, s5, v7
  s_lshl_b32 s4, s89, 16
  s_and_b32 s5, s89, 0xffff0000
  v_lshlrev_b32 v5, 16, v29
  v_and_b32 v6, 0xffff0000, v29
  v_fma_f32 v4, v5, s4, v4
  v_fma_f32 v7, v6, s5, v7
  s_lshl_b32 s4, s90, 16
  s_and_b32 s5, s90, 0xffff0000
  v_lshlrev_b32 v5, 16, v30
  v_and_b32 v6, 0xffff0000, v30
  v_fma_f32 v4, v5, s4, v4
  v_fma_f32 v7, v6, s5, v7
  s_lshl_b32 s4, s91, 16
  s_and_b32 s5, s91, 0xffff0000
  v_lshlrev_b32 v5, 16, v31
  v_and_b32 v6, 0xffff0000, v31
  v_fma_f32 v4, v5, s4, v4
  v_fma_f32 v7, v6, s5, v7
  s_lshl_b32 s4, s92, 16
  s_and_b32 s5, s92, 0xffff0000
  v_lshlrev_b32 v5, 16, v32
  v_and_b32 v6, 0xffff0000, v32
  v_fma_f32 v4, v5, s4, v4
  v_fma_f32 v7, v6, s5, v7
  s_lshl_b32 s4, s93, 16
  s_and_b32 s5, s93, 0xffff0000
  v_lshlrev_b32 v5, 16, v33
  v_and_b32 v6, 0xffff0000, v33
  v_fma_f32 v4, v5, s4, v4
  v_fma_f32 v7, v6, s5, v7
  s_lshl_b32 s4, s94, 16
  s_and_b32 s5, s94, 0xffff0000
  v_lshlrev_b32 v5, 16, v34
  v_and_b32 v6, 0xffff0000, v34
  v_fma_f32 v4, v5, s4, v4
  v_fma_f32 v7, v6, s5, v7
  s_lshl_b32 s4, s95, 16
  s_and_b32 s5, s95, 0xffff0000
  v_lshlrev_b32 v5, 16, v35
  v_and_b32 v6, 0xffff0000, v35
  v_fma_f32 v4, v5, s4, v4
  v_fma_f32 v7, v6, s5, v7
  s_lshl_b32 s4, s96, 16
  s_and_b32 s5, s96, 0xffff0000
  v_lshlrev_b32 v5, 16, v36
  v_and_b32 v6, 0xffff0000, v36
  v_fma_f32 v4, v5, s4, v4
  v_fma_f32 v7, v6, s5, v7
  s_lshl_b32 s4, s97, 16
  s_and_b32 s5, s97, 0xffff0000
  v_lshlrev_b32 v5, 16, v37
  v_and_b32 v6, 0xffff0000, v37
  v_fma_f32 v4, v5, s4, v4
  v_fma_f32 v7, v6, s5, v7
  s_lshl_b32 s4, s98, 16
  s_and_b32 s5, s98, 0xffff0000
  v_lshlrev_b32 v5, 16, v38
  v_and_b32 v6, 0xffff0000, v38
  v_fma_f32 v4, v5, s4, v4
  v_fma_f32 v7, v6, s5, v7
  s_lshl_b32 s4, s99, 16
  s_and_b32 s5, s99, 0xffff0000
  v_lshlrev_b32 v5, 16, v39
  v_and_b32 v6, 0xffff0000, v39
  v_fma_f32 v4, v5, s4, v4
  v_fma_f32 v7, v6, s5, v7
  s_load_dwordx16 s[68:83], s[38:39], 768
  s_load_dwordx16 s[84:99], s[38:39], 832
  buffer_load_dwordx4 v[8:11], v3, s[52:55], 0 offen offset:768
  buffer_load_dwordx4 v[12:15], v3, s[52:55], 0 offen offset:784
  buffer_load_dwordx4 v[16:19], v3, s[52:55], 0 offen offset:800
  buffer_load_dwordx4 v[20:23], v3, s[52:55], 0 offen offset:816
  buffer_load_dwordx4 v[24:27], v3, s[52:55], 0 offen offset:832
  buffer_load_dwordx4 v[28:31], v3, s[52:55], 0 offen offset:848
  buffer_load_dwordx4 v[32:35], v3, s[52:55], 0 offen offset:864
  buffer_load_dwordx4 v[36:39], v3, s[52:55], 0 offen offset:880
  s_waitcnt vmcnt(0) lgkmcnt(0)
  s_lshl_b32 s4, s68, 16
  s_and_b32 s5, s68, 0xffff0000
  v_lshlrev_b32 v5, 16, v8
  v_and_b32 v6, 0xffff0000, v8
  v_fma_f32 v4, v5, s4, v4
  v_fma_f32 v7, v6, s5, v7
  s_lshl_b32 s4, s69, 16
  s_and_b32 s5, s69, 0xffff0000
  v_lshlrev_b32 v5, 16, v9
  v_and_b32 v6, 0xffff0000, v9
  v_fma_f32 v4, v5, s4, v4
  v_fma_f32 v7, v6, s5, v7
  s_lshl_b32 s4, s70, 16
  s_and_b32 s5, s70, 0xffff0000
  v_lshlrev_b32 v5, 16, v10
  v_and_b32 v6, 0xffff0000, v10
  v_fma_f32 v4, v5, s4, v4
  v_fma_f32 v7, v6, s5, v7
  s_lshl_b32 s4, s71, 16
  s_and_b32 s5, s71, 0xffff0000
  v_lshlrev_b32 v5, 16, v11
  v_and_b32 v6, 0xffff0000, v11
  v_fma_f32 v4, v5, s4, v4
  v_fma_f32 v7, v6, s5, v7
  s_lshl_b32 s4, s72, 16
  s_and_b32 s5, s72, 0xffff0000
  v_lshlrev_b32 v5, 16, v12
  v_and_b32 v6, 0xffff0000, v12
  v_fma_f32 v4, v5, s4, v4
  v_fma_f32 v7, v6, s5, v7
  s_lshl_b32 s4, s73, 16
  s_and_b32 s5, s73, 0xffff0000
  v_lshlrev_b32 v5, 16, v13
  v_and_b32 v6, 0xffff0000, v13
  v_fma_f32 v4, v5, s4, v4
  v_fma_f32 v7, v6, s5, v7
  s_lshl_b32 s4, s74, 16
  s_and_b32 s5, s74, 0xffff0000
  v_lshlrev_b32 v5, 16, v14
  v_and_b32 v6, 0xffff0000, v14
  v_fma_f32 v4, v5, s4, v4
  v_fma_f32 v7, v6, s5, v7
  s_lshl_b32 s4, s75, 16
  s_and_b32 s5, s75, 0xffff0000
  v_lshlrev_b32 v5, 16, v15
  v_and_b32 v6, 0xffff0000, v15
  v_fma_f32 v4, v5, s4, v4
  v_fma_f32 v7, v6, s5, v7
  s_lshl_b32 s4, s76, 16
  s_and_b32 s5, s76, 0xffff0000
  v_lshlrev_b32 v5, 16, v16
  v_and_b32 v6, 0xffff0000, v16
  v_fma_f32 v4, v5, s4, v4
  v_fma_f32 v7, v6, s5, v7
  s_lshl_b32 s4, s77, 16
  s_and_b32 s5, s77, 0xffff0000
  v_lshlrev_b32 v5, 16, v17
  v_and_b32 v6, 0xffff0000, v17
  v_fma_f32 v4, v5, s4, v4
  v_fma_f32 v7, v6, s5, v7
  s_lshl_b32 s4, s78, 16
  s_and_b32 s5, s78, 0xffff0000
  v_lshlrev_b32 v5, 16, v18
  v_and_b32 v6, 0xffff0000, v18
  v_fma_f32 v4, v5, s4, v4
  v_fma_f32 v7, v6, s5, v7
  s_lshl_b32 s4, s79, 16
  s_and_b32 s5, s79, 0xffff0000
  v_lshlrev_b32 v5, 16, v19
  v_and_b32 v6, 0xffff0000, v19
  v_fma_f32 v4, v5, s4, v4
  v_fma_f32 v7, v6, s5, v7
  s_lshl_b32 s4, s80, 16
  s_and_b32 s5, s80, 0xffff0000
  v_lshlrev_b32 v5, 16, v20
  v_and_b32 v6, 0xffff0000, v20
  v_fma_f32 v4, v5, s4, v4
  v_fma_f32 v7, v6, s5, v7
  s_lshl_b32 s4, s81, 16
  s_and_b32 s5, s81, 0xffff0000
  v_lshlrev_b32 v5, 16, v21
  v_and_b32 v6, 0xffff0000, v21
  v_fma_f32 v4, v5, s4, v4
  v_fma_f32 v7, v6, s5, v7
  s_lshl_b32 s4, s82, 16
  s_and_b32 s5, s82, 0xffff0000
  v_lshlrev_b32 v5, 16, v22
  v_and_b32 v6, 0xffff0000, v22
  v_fma_f32 v4, v5, s4, v4
  v_fma_f32 v7, v6, s5, v7
  s_lshl_b32 s4, s83, 16
  s_and_b32 s5, s83, 0xffff0000
  v_lshlrev_b32 v5, 16, v23
  v_and_b32 v6, 0xffff0000, v23
  v_fma_f32 v4, v5, s4, v4
  v_fma_f32 v7, v6, s5, v7
  s_lshl_b32 s4, s84, 16
  s_and_b32 s5, s84, 0xffff0000
  v_lshlrev_b32 v5, 16, v24
  v_and_b32 v6, 0xffff0000, v24
  v_fma_f32 v4, v5, s4, v4
  v_fma_f32 v7, v6, s5, v7
  s_lshl_b32 s4, s85, 16
  s_and_b32 s5, s85, 0xffff0000
  v_lshlrev_b32 v5, 16, v25
  v_and_b32 v6, 0xffff0000, v25
  v_fma_f32 v4, v5, s4, v4
  v_fma_f32 v7, v6, s5, v7
  s_lshl_b32 s4, s86, 16
  s_and_b32 s5, s86, 0xffff0000
  v_lshlrev_b32 v5, 16, v26
  v_and_b32 v6, 0xffff0000, v26
  v_fma_f32 v4, v5, s4, v4
  v_fma_f32 v7, v6, s5, v7
  s_lshl_b32 s4, s87, 16
  s_and_b32 s5, s87, 0xffff0000
  v_lshlrev_b32 v5, 16, v27
  v_and_b32 v6, 0xffff0000, v27
  v_fma_f32 v4, v5, s4, v4
  v_fma_f32 v7, v6, s5, v7
  s_lshl_b32 s4, s88, 16
  s_and_b32 s5, s88, 0xffff0000
  v_lshlrev_b32 v5, 16, v28
  v_and_b32 v6, 0xffff0000, v28
  v_fma_f32 v4, v5, s4, v4
  v_fma_f32 v7, v6, s5, v7
  s_lshl_b32 s4, s89, 16
  s_and_b32 s5, s89, 0xffff0000
  v_lshlrev_b32 v5, 16, v29
  v_and_b32 v6, 0xffff0000, v29
  v_fma_f32 v4, v5, s4, v4
  v_fma_f32 v7, v6, s5, v7
  s_lshl_b32 s4, s90, 16
  s_and_b32 s5, s90, 0xffff0000
  v_lshlrev_b32 v5, 16, v30
  v_and_b32 v6, 0xffff0000, v30
  v_fma_f32 v4, v5, s4, v4
  v_fma_f32 v7, v6, s5, v7
  s_lshl_b32 s4, s91, 16
  s_and_b32 s5, s91, 0xffff0000
  v_lshlrev_b32 v5, 16, v31
  v_and_b32 v6, 0xffff0000, v31
  v_fma_f32 v4, v5, s4, v4
  v_fma_f32 v7, v6, s5, v7
  s_lshl_b32 s4, s92, 16
  s_and_b32 s5, s92, 0xffff0000
  v_lshlrev_b32 v5, 16, v32
  v_and_b32 v6, 0xffff0000, v32
  v_fma_f32 v4, v5, s4, v4
  v_fma_f32 v7, v6, s5, v7
  s_lshl_b32 s4, s93, 16
  s_and_b32 s5, s93, 0xffff0000
  v_lshlrev_b32 v5, 16, v33
  v_and_b32 v6, 0xffff0000, v33
  v_fma_f32 v4, v5, s4, v4
  v_fma_f32 v7, v6, s5, v7
  s_lshl_b32 s4, s94, 16
  s_and_b32 s5, s94, 0xffff0000
  v_lshlrev_b32 v5, 16, v34
  v_and_b32 v6, 0xffff0000, v34
  v_fma_f32 v4, v5, s4, v4
  v_fma_f32 v7, v6, s5, v7
  s_lshl_b32 s4, s95, 16
  s_and_b32 s5, s95, 0xffff0000
  v_lshlrev_b32 v5, 16, v35
  v_and_b32 v6, 0xffff0000, v35
  v_fma_f32 v4, v5, s4, v4
  v_fma_f32 v7, v6, s5, v7
  s_lshl_b32 s4, s96, 16
  s_and_b32 s5, s96, 0xffff0000
  v_lshlrev_b32 v5, 16, v36
  v_and_b32 v6, 0xffff0000, v36
  v_fma_f32 v4, v5, s4, v4
  v_fma_f32 v7, v6, s5, v7
  s_lshl_b32 s4, s97, 16
  s_and_b32 s5, s97, 0xffff0000
  v_lshlrev_b32 v5, 16, v37
  v_and_b32 v6, 0xffff0000, v37
  v_fma_f32 v4, v5, s4, v4
  v_fma_f32 v7, v6, s5, v7
  s_lshl_b32 s4, s98, 16
  s_and_b32 s5, s98, 0xffff0000
  v_lshlrev_b32 v5, 16, v38
  v_and_b32 v6, 0xffff0000, v38
  v_fma_f32 v4, v5, s4, v4
  v_fma_f32 v7, v6, s5, v7
  s_lshl_b32 s4, s99, 16
  s_and_b32 s5, s99, 0xffff0000
  v_lshlrev_b32 v5, 16, v39
  v_and_b32 v6, 0xffff0000, v39
  v_fma_f32 v4, v5, s4, v4
  v_fma_f32 v7, v6, s5, v7
  s_load_dwordx16 s[68:83], s[38:39], 896
  s_load_dwordx16 s[84:99], s[38:39], 960
  buffer_load_dwordx4 v[8:11], v3, s[52:55], 0 offen offset:896
  buffer_load_dwordx4 v[12:15], v3, s[52:55], 0 offen offset:912
  buffer_load_dwordx4 v[16:19], v3, s[52:55], 0 offen offset:928
  buffer_load_dwordx4 v[20:23], v3, s[52:55], 0 offen offset:944
  buffer_load_dwordx4 v[24:27], v3, s[52:55], 0 offen offset:960
  buffer_load_dwordx4 v[28:31], v3, s[52:55], 0 offen offset:976
  buffer_load_dwordx4 v[32:35], v3, s[52:55], 0 offen offset:992
  buffer_load_dwordx4 v[36:39], v3, s[52:55], 0 offen offset:1008
  s_waitcnt vmcnt(0) lgkmcnt(0)
  s_lshl_b32 s4, s68, 16
  s_and_b32 s5, s68, 0xffff0000
  v_lshlrev_b32 v5, 16, v8
  v_and_b32 v6, 0xffff0000, v8
  v_fma_f32 v4, v5, s4, v4
  v_fma_f32 v7, v6, s5, v7
  s_lshl_b32 s4, s69, 16
  s_and_b32 s5, s69, 0xffff0000
  v_lshlrev_b32 v5, 16, v9
  v_and_b32 v6, 0xffff0000, v9
  v_fma_f32 v4, v5, s4, v4
  v_fma_f32 v7, v6, s5, v7
  s_lshl_b32 s4, s70, 16
  s_and_b32 s5, s70, 0xffff0000
  v_lshlrev_b32 v5, 16, v10
  v_and_b32 v6, 0xffff0000, v10
  v_fma_f32 v4, v5, s4, v4
  v_fma_f32 v7, v6, s5, v7
  s_lshl_b32 s4, s71, 16
  s_and_b32 s5, s71, 0xffff0000
  v_lshlrev_b32 v5, 16, v11
  v_and_b32 v6, 0xffff0000, v11
  v_fma_f32 v4, v5, s4, v4
  v_fma_f32 v7, v6, s5, v7
  s_lshl_b32 s4, s72, 16
  s_and_b32 s5, s72, 0xffff0000
  v_lshlrev_b32 v5, 16, v12
  v_and_b32 v6, 0xffff0000, v12
  v_fma_f32 v4, v5, s4, v4
  v_fma_f32 v7, v6, s5, v7
  s_lshl_b32 s4, s73, 16
  s_and_b32 s5, s73, 0xffff0000
  v_lshlrev_b32 v5, 16, v13
  v_and_b32 v6, 0xffff0000, v13
  v_fma_f32 v4, v5, s4, v4
  v_fma_f32 v7, v6, s5, v7
  s_lshl_b32 s4, s74, 16
  s_and_b32 s5, s74, 0xffff0000
  v_lshlrev_b32 v5, 16, v14
  v_and_b32 v6, 0xffff0000, v14
  v_fma_f32 v4, v5, s4, v4
  v_fma_f32 v7, v6, s5, v7
  s_lshl_b32 s4, s75, 16
  s_and_b32 s5, s75, 0xffff0000
  v_lshlrev_b32 v5, 16, v15
  v_and_b32 v6, 0xffff0000, v15
  v_fma_f32 v4, v5, s4, v4
  v_fma_f32 v7, v6, s5, v7
  s_lshl_b32 s4, s76, 16
  s_and_b32 s5, s76, 0xffff0000
  v_lshlrev_b32 v5, 16, v16
  v_and_b32 v6, 0xffff0000, v16
  v_fma_f32 v4, v5, s4, v4
  v_fma_f32 v7, v6, s5, v7
  s_lshl_b32 s4, s77, 16
  s_and_b32 s5, s77, 0xffff0000
  v_lshlrev_b32 v5, 16, v17
  v_and_b32 v6, 0xffff0000, v17
  v_fma_f32 v4, v5, s4, v4
  v_fma_f32 v7, v6, s5, v7
  s_lshl_b32 s4, s78, 16
  s_and_b32 s5, s78, 0xffff0000
  v_lshlrev_b32 v5, 16, v18
  v_and_b32 v6, 0xffff0000, v18
  v_fma_f32 v4, v5, s4, v4
  v_fma_f32 v7, v6, s5, v7
  s_lshl_b32 s4, s79, 16
  s_and_b32 s5, s79, 0xffff0000
  v_lshlrev_b32 v5, 16, v19
  v_and_b32 v6, 0xffff0000, v19
  v_fma_f32 v4, v5, s4, v4
  v_fma_f32 v7, v6, s5, v7
  s_lshl_b32 s4, s80, 16
  s_and_b32 s5, s80, 0xffff0000
  v_lshlrev_b32 v5, 16, v20
  v_and_b32 v6, 0xffff0000, v20
  v_fma_f32 v4, v5, s4, v4
  v_fma_f32 v7, v6, s5, v7
  s_lshl_b32 s4, s81, 16
  s_and_b32 s5, s81, 0xffff0000
  v_lshlrev_b32 v5, 16, v21
  v_and_b32 v6, 0xffff0000, v21
  v_fma_f32 v4, v5, s4, v4
  v_fma_f32 v7, v6, s5, v7
  s_lshl_b32 s4, s82, 16
  s_and_b32 s5, s82, 0xffff0000
  v_lshlrev_b32 v5, 16, v22
  v_and_b32 v6, 0xffff0000, v22
  v_fma_f32 v4, v5, s4, v4
  v_fma_f32 v7, v6, s5, v7
  s_lshl_b32 s4, s83, 16
  s_and_b32 s5, s83, 0xffff0000
  v_lshlrev_b32 v5, 16, v23
  v_and_b32 v6, 0xffff0000, v23
  v_fma_f32 v4, v5, s4, v4
  v_fma_f32 v7, v6, s5, v7
  s_lshl_b32 s4, s84, 16
  s_and_b32 s5, s84, 0xffff0000
  v_lshlrev_b32 v5, 16, v24
  v_and_b32 v6, 0xffff0000, v24
  v_fma_f32 v4, v5, s4, v4
  v_fma_f32 v7, v6, s5, v7
  s_lshl_b32 s4, s85, 16
  s_and_b32 s5, s85, 0xffff0000
  v_lshlrev_b32 v5, 16, v25
  v_and_b32 v6, 0xffff0000, v25
  v_fma_f32 v4, v5, s4, v4
  v_fma_f32 v7, v6, s5, v7
  s_lshl_b32 s4, s86, 16
  s_and_b32 s5, s86, 0xffff0000
  v_lshlrev_b32 v5, 16, v26
  v_and_b32 v6, 0xffff0000, v26
  v_fma_f32 v4, v5, s4, v4
  v_fma_f32 v7, v6, s5, v7
  s_lshl_b32 s4, s87, 16
  s_and_b32 s5, s87, 0xffff0000
  v_lshlrev_b32 v5, 16, v27
  v_and_b32 v6, 0xffff0000, v27
  v_fma_f32 v4, v5, s4, v4
  v_fma_f32 v7, v6, s5, v7
  s_lshl_b32 s4, s88, 16
  s_and_b32 s5, s88, 0xffff0000
  v_lshlrev_b32 v5, 16, v28
  v_and_b32 v6, 0xffff0000, v28
  v_fma_f32 v4, v5, s4, v4
  v_fma_f32 v7, v6, s5, v7
  s_lshl_b32 s4, s89, 16
  s_and_b32 s5, s89, 0xffff0000
  v_lshlrev_b32 v5, 16, v29
  v_and_b32 v6, 0xffff0000, v29
  v_fma_f32 v4, v5, s4, v4
  v_fma_f32 v7, v6, s5, v7
  s_lshl_b32 s4, s90, 16
  s_and_b32 s5, s90, 0xffff0000
  v_lshlrev_b32 v5, 16, v30
  v_and_b32 v6, 0xffff0000, v30
  v_fma_f32 v4, v5, s4, v4
  v_fma_f32 v7, v6, s5, v7
  s_lshl_b32 s4, s91, 16
  s_and_b32 s5, s91, 0xffff0000
  v_lshlrev_b32 v5, 16, v31
  v_and_b32 v6, 0xffff0000, v31
  v_fma_f32 v4, v5, s4, v4
  v_fma_f32 v7, v6, s5, v7
  s_lshl_b32 s4, s92, 16
  s_and_b32 s5, s92, 0xffff0000
  v_lshlrev_b32 v5, 16, v32
  v_and_b32 v6, 0xffff0000, v32
  v_fma_f32 v4, v5, s4, v4
  v_fma_f32 v7, v6, s5, v7
  s_lshl_b32 s4, s93, 16
  s_and_b32 s5, s93, 0xffff0000
  v_lshlrev_b32 v5, 16, v33
  v_and_b32 v6, 0xffff0000, v33
  v_fma_f32 v4, v5, s4, v4
  v_fma_f32 v7, v6, s5, v7
  s_lshl_b32 s4, s94, 16
  s_and_b32 s5, s94, 0xffff0000
  v_lshlrev_b32 v5, 16, v34
  v_and_b32 v6, 0xffff0000, v34
  v_fma_f32 v4, v5, s4, v4
  v_fma_f32 v7, v6, s5, v7
  s_lshl_b32 s4, s95, 16
  s_and_b32 s5, s95, 0xffff0000
  v_lshlrev_b32 v5, 16, v35
  v_and_b32 v6, 0xffff0000, v35
  v_fma_f32 v4, v5, s4, v4
  v_fma_f32 v7, v6, s5, v7
  s_lshl_b32 s4, s96, 16
  s_and_b32 s5, s96, 0xffff0000
  v_lshlrev_b32 v5, 16, v36
  v_and_b32 v6, 0xffff0000, v36
  v_fma_f32 v4, v5, s4, v4
  v_fma_f32 v7, v6, s5, v7
  s_lshl_b32 s4, s97, 16
  s_and_b32 s5, s97, 0xffff0000
  v_lshlrev_b32 v5, 16, v37
  v_and_b32 v6, 0xffff0000, v37
  v_fma_f32 v4, v5, s4, v4
  v_fma_f32 v7, v6, s5, v7
  s_lshl_b32 s4, s98, 16
  s_and_b32 s5, s98, 0xffff0000
  v_lshlrev_b32 v5, 16, v38
  v_and_b32 v6, 0xffff0000, v38
  v_fma_f32 v4, v5, s4, v4
  v_fma_f32 v7, v6, s5, v7
  s_lshl_b32 s4, s99, 16
  s_and_b32 s5, s99, 0xffff0000
  v_lshlrev_b32 v5, 16, v39
  v_and_b32 v6, 0xffff0000, v39
  v_fma_f32 v4, v5, s4, v4
  v_fma_f32 v7, v6, s5, v7
  s_load_dwordx16 s[68:83], s[38:39], 1024
  s_load_dwordx16 s[84:99], s[38:39], 1088
  buffer_load_dwordx4 v[8:11], v3, s[52:55], 0 offen offset:1024
  buffer_load_dwordx4 v[12:15], v3, s[52:55], 0 offen offset:1040
  buffer_load_dwordx4 v[16:19], v3, s[52:55], 0 offen offset:1056
  buffer_load_dwordx4 v[20:23], v3, s[52:55], 0 offen offset:1072
  buffer_load_dwordx4 v[24:27], v3, s[52:55], 0 offen offset:1088
  buffer_load_dwordx4 v[28:31], v3, s[52:55], 0 offen offset:1104
  buffer_load_dwordx4 v[32:35], v3, s[52:55], 0 offen offset:1120
  buffer_load_dwordx4 v[36:39], v3, s[52:55], 0 offen offset:1136
  s_waitcnt vmcnt(0) lgkmcnt(0)
  s_lshl_b32 s4, s68, 16
  s_and_b32 s5, s68, 0xffff0000
  v_lshlrev_b32 v5, 16, v8
  v_and_b32 v6, 0xffff0000, v8
  v_fma_f32 v4, v5, s4, v4
  v_fma_f32 v7, v6, s5, v7
  s_lshl_b32 s4, s69, 16
  s_and_b32 s5, s69, 0xffff0000
  v_lshlrev_b32 v5, 16, v9
  v_and_b32 v6, 0xffff0000, v9
  v_fma_f32 v4, v5, s4, v4
  v_fma_f32 v7, v6, s5, v7
  s_lshl_b32 s4, s70, 16
  s_and_b32 s5, s70, 0xffff0000
  v_lshlrev_b32 v5, 16, v10
  v_and_b32 v6, 0xffff0000, v10
  v_fma_f32 v4, v5, s4, v4
  v_fma_f32 v7, v6, s5, v7
  s_lshl_b32 s4, s71, 16
  s_and_b32 s5, s71, 0xffff0000
  v_lshlrev_b32 v5, 16, v11
  v_and_b32 v6, 0xffff0000, v11
  v_fma_f32 v4, v5, s4, v4
  v_fma_f32 v7, v6, s5, v7
  s_lshl_b32 s4, s72, 16
  s_and_b32 s5, s72, 0xffff0000
  v_lshlrev_b32 v5, 16, v12
  v_and_b32 v6, 0xffff0000, v12
  v_fma_f32 v4, v5, s4, v4
  v_fma_f32 v7, v6, s5, v7
  s_lshl_b32 s4, s73, 16
  s_and_b32 s5, s73, 0xffff0000
  v_lshlrev_b32 v5, 16, v13
  v_and_b32 v6, 0xffff0000, v13
  v_fma_f32 v4, v5, s4, v4
  v_fma_f32 v7, v6, s5, v7
  s_lshl_b32 s4, s74, 16
  s_and_b32 s5, s74, 0xffff0000
  v_lshlrev_b32 v5, 16, v14
  v_and_b32 v6, 0xffff0000, v14
  v_fma_f32 v4, v5, s4, v4
  v_fma_f32 v7, v6, s5, v7
  s_lshl_b32 s4, s75, 16
  s_and_b32 s5, s75, 0xffff0000
  v_lshlrev_b32 v5, 16, v15
  v_and_b32 v6, 0xffff0000, v15
  v_fma_f32 v4, v5, s4, v4
  v_fma_f32 v7, v6, s5, v7
  s_lshl_b32 s4, s76, 16
  s_and_b32 s5, s76, 0xffff0000
  v_lshlrev_b32 v5, 16, v16
  v_and_b32 v6, 0xffff0000, v16
  v_fma_f32 v4, v5, s4, v4
  v_fma_f32 v7, v6, s5, v7
  s_lshl_b32 s4, s77, 16
  s_and_b32 s5, s77, 0xffff0000
  v_lshlrev_b32 v5, 16, v17
  v_and_b32 v6, 0xffff0000, v17
  v_fma_f32 v4, v5, s4, v4
  v_fma_f32 v7, v6, s5, v7
  s_lshl_b32 s4, s78, 16
  s_and_b32 s5, s78, 0xffff0000
  v_lshlrev_b32 v5, 16, v18
  v_and_b32 v6, 0xffff0000, v18
  v_fma_f32 v4, v5, s4, v4
  v_fma_f32 v7, v6, s5, v7
  s_lshl_b32 s4, s79, 16
  s_and_b32 s5, s79, 0xffff0000
  v_lshlrev_b32 v5, 16, v19
  v_and_b32 v6, 0xffff0000, v19
  v_fma_f32 v4, v5, s4, v4
  v_fma_f32 v7, v6, s5, v7
  s_lshl_b32 s4, s80, 16
  s_and_b32 s5, s80, 0xffff0000
  v_lshlrev_b32 v5, 16, v20
  v_and_b32 v6, 0xffff0000, v20
  v_fma_f32 v4, v5, s4, v4
  v_fma_f32 v7, v6, s5, v7
  s_lshl_b32 s4, s81, 16
  s_and_b32 s5, s81, 0xffff0000
  v_lshlrev_b32 v5, 16, v21
  v_and_b32 v6, 0xffff0000, v21
  v_fma_f32 v4, v5, s4, v4
  v_fma_f32 v7, v6, s5, v7
  s_lshl_b32 s4, s82, 16
  s_and_b32 s5, s82, 0xffff0000
  v_lshlrev_b32 v5, 16, v22
  v_and_b32 v6, 0xffff0000, v22
  v_fma_f32 v4, v5, s4, v4
  v_fma_f32 v7, v6, s5, v7
  s_lshl_b32 s4, s83, 16
  s_and_b32 s5, s83, 0xffff0000
  v_lshlrev_b32 v5, 16, v23
  v_and_b32 v6, 0xffff0000, v23
  v_fma_f32 v4, v5, s4, v4
  v_fma_f32 v7, v6, s5, v7
  s_lshl_b32 s4, s84, 16
  s_and_b32 s5, s84, 0xffff0000
  v_lshlrev_b32 v5, 16, v24
  v_and_b32 v6, 0xffff0000, v24
  v_fma_f32 v4, v5, s4, v4
  v_fma_f32 v7, v6, s5, v7
  s_lshl_b32 s4, s85, 16
  s_and_b32 s5, s85, 0xffff0000
  v_lshlrev_b32 v5, 16, v25
  v_and_b32 v6, 0xffff0000, v25
  v_fma_f32 v4, v5, s4, v4
  v_fma_f32 v7, v6, s5, v7
  s_lshl_b32 s4, s86, 16
  s_and_b32 s5, s86, 0xffff0000
  v_lshlrev_b32 v5, 16, v26
  v_and_b32 v6, 0xffff0000, v26
  v_fma_f32 v4, v5, s4, v4
  v_fma_f32 v7, v6, s5, v7
  s_lshl_b32 s4, s87, 16
  s_and_b32 s5, s87, 0xffff0000
  v_lshlrev_b32 v5, 16, v27
  v_and_b32 v6, 0xffff0000, v27
  v_fma_f32 v4, v5, s4, v4
  v_fma_f32 v7, v6, s5, v7
  s_lshl_b32 s4, s88, 16
  s_and_b32 s5, s88, 0xffff0000
  v_lshlrev_b32 v5, 16, v28
  v_and_b32 v6, 0xffff0000, v28
  v_fma_f32 v4, v5, s4, v4
  v_fma_f32 v7, v6, s5, v7
  s_lshl_b32 s4, s89, 16
  s_and_b32 s5, s89, 0xffff0000
  v_lshlrev_b32 v5, 16, v29
  v_and_b32 v6, 0xffff0000, v29
  v_fma_f32 v4, v5, s4, v4
  v_fma_f32 v7, v6, s5, v7
  s_lshl_b32 s4, s90, 16
  s_and_b32 s5, s90, 0xffff0000
  v_lshlrev_b32 v5, 16, v30
  v_and_b32 v6, 0xffff0000, v30
  v_fma_f32 v4, v5, s4, v4
  v_fma_f32 v7, v6, s5, v7
  s_lshl_b32 s4, s91, 16
  s_and_b32 s5, s91, 0xffff0000
  v_lshlrev_b32 v5, 16, v31
  v_and_b32 v6, 0xffff0000, v31
  v_fma_f32 v4, v5, s4, v4
  v_fma_f32 v7, v6, s5, v7
  s_lshl_b32 s4, s92, 16
  s_and_b32 s5, s92, 0xffff0000
  v_lshlrev_b32 v5, 16, v32
  v_and_b32 v6, 0xffff0000, v32
  v_fma_f32 v4, v5, s4, v4
  v_fma_f32 v7, v6, s5, v7
  s_lshl_b32 s4, s93, 16
  s_and_b32 s5, s93, 0xffff0000
  v_lshlrev_b32 v5, 16, v33
  v_and_b32 v6, 0xffff0000, v33
  v_fma_f32 v4, v5, s4, v4
  v_fma_f32 v7, v6, s5, v7
  s_lshl_b32 s4, s94, 16
  s_and_b32 s5, s94, 0xffff0000
  v_lshlrev_b32 v5, 16, v34
  v_and_b32 v6, 0xffff0000, v34
  v_fma_f32 v4, v5, s4, v4
  v_fma_f32 v7, v6, s5, v7
  s_lshl_b32 s4, s95, 16
  s_and_b32 s5, s95, 0xffff0000
  v_lshlrev_b32 v5, 16, v35
  v_and_b32 v6, 0xffff0000, v35
  v_fma_f32 v4, v5, s4, v4
  v_fma_f32 v7, v6, s5, v7
  s_lshl_b32 s4, s96, 16
  s_and_b32 s5, s96, 0xffff0000
  v_lshlrev_b32 v5, 16, v36
  v_and_b32 v6, 0xffff0000, v36
  v_fma_f32 v4, v5, s4, v4
  v_fma_f32 v7, v6, s5, v7
  s_lshl_b32 s4, s97, 16
  s_and_b32 s5, s97, 0xffff0000
  v_lshlrev_b32 v5, 16, v37
  v_and_b32 v6, 0xffff0000, v37
  v_fma_f32 v4, v5, s4, v4
  v_fma_f32 v7, v6, s5, v7
  s_lshl_b32 s4, s98, 16
  s_and_b32 s5, s98, 0xffff0000
  v_lshlrev_b32 v5, 16, v38
  v_and_b32 v6, 0xffff0000, v38
  v_fma_f32 v4, v5, s4, v4
  v_fma_f32 v7, v6, s5, v7
  s_lshl_b32 s4, s99, 16
  s_and_b32 s5, s99, 0xffff0000
  v_lshlrev_b32 v5, 16, v39
  v_and_b32 v6, 0xffff0000, v39
  v_fma_f32 v4, v5, s4, v4
  v_fma_f32 v7, v6, s5, v7
  v_add_f32 v4, v4, v7
  v_mul_f32 v4, 0xbfb8aa3b, v4
  v_exp_f32 v4, v4
  s_nop 0
  v_add_f32 v4, 1.0, v4
  v_rcp_f32 v4, v4
  v_lshlrev_b32 v2, 2, v2
  s_mov_b32 s4, 109051904
  s_nop 0
  buffer_store_dword v4, v2, s[48:51], s4 offen sc1
  s_waitcnt vmcnt(0)
  s_barrier
  s_cmp_lg_u32 s3, 0
  s_cbranch_scc1 L_sig_124
  s_mov_b32 s46, 24576
  s_mov_b64 s[8:9], exec
  s_mov_b64 exec, 1
  v_mov_b32 v28, 0
  v_mov_b32 v29, 1
  buffer_atomic_add v29, v28, s[48:51], s46 offen
  s_mov_b64 exec, s[8:9]
L_sig_124:
  s_branch L_exit
L_chain:
  s_lshr_b32 s68, s2, 3
  s_xor_b32 s68, s68, 0
  v_lshlrev_b32 v1, 4, v0
  v_lshlrev_b32 v9, 2, v0
  v_mov_b32 v12, 0
  v_mov_b32 v13, 0
  v_mov_b32 v14, 0
  v_mov_b32 v15, 0
  v_mov_b32 v16, -1
  v_mov_b32 v17, -1
  v_mov_b32 v18, -1
  v_mov_b32 v19, -1
  s_lshl_b32 s4, s3, 10
  v_add_u32 v20, s4, v1
  s_mul_i32 s5, s68, 800
  v_cmp_gt_u32 vcc, 800, v20
  s_and_saveexec_b64 s[8:9], vcc
  s_cbranch_execz L_ci_nf
  buffer_store_dwordx4 v[12:15], v20, s[48:51], s5 offen sc1
L_ci_nf:
  s_mov_b64 exec, s[8:9]
  s_mul_i32 s5, s68, 18432
  s_add_u32 s5, s5, 65536
  buffer_store_dwordx4 v[16:19], v20, s[48:51], s5 offen sc1
  s_add_u32 s5, s5, 4096
  buffer_store_dwordx4 v[16:19], v20, s[48:51], s5 offen sc1
  s_add_u32 s5, s5, 4096
  buffer_store_dwordx4 v[16:19], v20, s[48:51], s5 offen sc1
  s_add_u32 s5, s5, 4096
  buffer_store_dwordx4 v[16:19], v20, s[48:51], s5 offen sc1
  s_add_u32 s5, s5, 4096
  v_cmp_gt_u32 vcc, 2048, v20
  s_and_saveexec_b64 s[8:9], vcc
  s_cbranch_execz L_ci_np
  buffer_store_dwordx4 v[16:19], v20, s[48:51], s5 offen sc1
L_ci_np:
  s_mov_b64 exec, s[8:9]
  s_lshl_b32 s5, s68, 2
  s_add_u32 s5, s5, s3
  s_cmp_ge_u32 s5, 108
  s_cbranch_scc1 L_ci_nm2
  s_mul_hi_u32 s6, s5, 0x1c71c71d
  s_mul_i32 s7, s6, 9
  s_sub_u32 s7, s5, s7
  s_lshr_b32 s5, s6, 2
  s_add_u32 s5, s5, 1
  s_lshl_b32 s5, s5, 16
  s_and_b32 s6, s6, 3
  s_mul_i32 s6, s6, 9472
  s_add_u32 s5, s5, s6
  s_lshl_b32 s7, s7, 10
  s_add_u32 s5, s5, s7
  s_add_u32 s5, s5, 655360
  buffer_store_dwordx4 v[16:19], v1, s[48:51], s5 offen sc1
L_ci_nm2:
  s_lshl_b32 s5, s68, 12
  s_lshl_b32 s6, s3, 10
  s_add_u32 s5, s5, s6
  s_add_u32 s5, s5, 59637760
  buffer_store_dwordx4 v[16:19], v1, s[48:51], s5 offen sc1
  s_lshl_b32 s5, s68, 13
  s_lshl_b32 s6, s3, 11
  s_add_u32 s5, s5, s6
  s_add_u32 s5, s5, 84672512
  buffer_store_dwordx4 v[16:19], v1, s[48:51], s5 offen sc1
  buffer_store_dwordx4 v[16:19], v1, s[48:51], s5 offen offset:1024 sc1
  s_mov_b32 s52, s18
  s_mov_b32 s53, s19
  s_mov_b32 s54, 9216
  s_mov_b32 s55, 0x20000
  s_cmp_ge_u32 s68, 9
  s_cbranch_scc1 L_ci_m0e
  v_bfe_u32 v12, v0, 2, 2
  v_lshlrev_b32 v12, 1, v12
  v_and_b32 v13, 1, v0
  v_add_u32 v12, v12, v13
  s_movk_i32 s4, 1152
  v_mul_lo_u32 v12, v12, s4
  v_bfe_u32 v13, v0, 1, 1
  v_lshlrev_b32 v13, 6, v13
  v_add_u32 v12, v12, v13
  v_lshrrev_b32 v13, 5, v0
  v_lshlrev_b32 v13, 5, v13
  v_add_u32 v12, v12, v13
  v_bfe_u32 v13, v0, 4, 1
  v_lshlrev_b32 v13, 2, v13
  v_add_u32 v12, v12, v13
  s_lshl_b32 s4, s68, 7
  buffer_load_ushort v32, v12, s[52:55], s4 offen offset:0
  buffer_load_ushort v33, v12, s[52:55], s4 offen offset:8
  buffer_load_ushort v34, v12, s[52:55], s4 offen offset:16
  buffer_load_ushort v35, v12, s[52:55], s4 offen offset:24
  buffer_load_ushort v36, v12, s[52:55], s4 offen offset:2
  buffer_load_ushort v37, v12, s[52:55], s4 offen offset:10
  buffer_load_ushort v38, v12, s[52:55], s4 offen offset:18
  buffer_load_ushort v39, v12, s[52:55], s4 offen offset:26
  s_waitcnt vmcnt(0)
  v_lshl_or_b32 v24, v33, 16, v32
  v_lshl_or_b32 v25, v35, 16, v34
  v_lshl_or_b32 v26, v37, 16, v36
  v_lshl_or_b32 v27, v39, 16, v38
  s_lshl_b32 s4, s68, 10
  s_mul_i32 s5, s3, 9472
  s_add_u32 s4, s4, s5
  s_add_u32 s4, s4, 655360
  buffer_store_dwordx4 v[24:27], v1, s[48:51], s4 offen sc1
  s_nop 1
L_ci_m0e:
  v_lshrrev_b32 v12, 4, v0
  v_and_b32 v13, 1, v12
  s_lshr_b32 s4, s3, 1
  s_lshl_b32 s4, s4, 2
  v_or_b32 v13, s4, v13
  v_lshlrev_b32 v14, 1, v13
  v_and_b32 v21, 15, v0
  v_xor_b32 v22, v21, v14
  v_lshlrev_b32 v22, 4, v22
  v_lshlrev_b32 v12, 13, v12
  v_add_u32 v24, v12, v22
  v_xor_b32 v14, 4, v14
  v_xor_b32 v22, v21, v14
  v_lshlrev_b32 v22, 4, v22
  v_add_u32 v25, v12, v22
  v_lshrrev_b32 v12, 3, v0
  s_movk_i32 s4, 1152
  v_mul_lo_u32 v12, v12, s4
  v_lshrrev_b32 v13, 5, v0
  s_and_b32 s4, s3, 1
  s_lshl_b32 s4, s4, 1
  v_or_b32 v13, s4, v13
  v_lshlrev_b32 v13, 1, v13
  v_and_b32 v21, 7, v0
  v_xor_b32 v21, v21, v13
  v_lshlrev_b32 v21, 4, v21
  v_add_u32 v26, v12, v21
  v_lshrrev_b32 v12, 4, v0
  v_bfe_u32 v13, v0, 2, 2
  v_lshrrev_b32 v14, 1, v13
  v_lshlrev_b32 v14, 5, v14
  v_and_b32 v21, 1, v13
  v_lshlrev_b32 v21, 2, v21
  v_add3_u32 v14, v14, v21, v12
  v_lshlrev_b32 v14, 8, v14
  v_and_b32 v21, 1, v0
  v_lshlrev_b32 v21, 3, v21
  v_add_u32 v14, v14, v21
  v_and_b32 v21, 1, v12
  v_lshlrev_b32 v21, 1, v21
  v_lshlrev_b32 v22, 2, v13
  v_add_u32 v21, v21, v22
  v_bfe_u32 v22, v0, 1, 1
  s_lshl_b32 s4, s3, 2
  v_add_u32 v22, s4, v22
  v_xor_b32 v23, v22, v21
  v_lshlrev_b32 v23, 4, v23
  v_add_u32 v28, v14, v23
  v_add_u32 v22, 2, v22
  v_xor_b32 v23, v22, v21
  v_lshlrev_b32 v23, 4, v23
  v_add_u32 v29, v14, v23
  v_lshrrev_b32 v14, 1, v13
  v_lshlrev_b32 v21, 5, v14
  v_lshrrev_b32 v22, 1, v12
  v_lshlrev_b32 v22, 3, v22
  v_add_u32 v21, v21, v22
  v_and_b32 v22, 1, v12
  v_lshlrev_b32 v23, 2, v22
  v_add_u32 v21, v21, v23
  v_and_b32 v23, 1, v13
  v_add_u32 v21, v21, v23
  v_lshlrev_b32 v21, 7, v21
  v_lshlrev_b32 v14, 1, v14
  v_or_b32 v22, v22, v14
  v_lshlrev_b32 v22, 1, v22
  v_bfe_u32 v23, v0, 1, 1
  s_lshl_b32 s4, s3, 1
  v_add_u32 v23, s4, v23
  v_xor_b32 v23, v23, v22
  v_lshlrev_b32 v23, 4, v23
  v_and_b32 v22, 1, v0
  v_lshlrev_b32 v22, 3, v22
  v_add3_u32 v27, v21, v23, v22
  s_mov_b32 s52, s20
  s_mov_b32 s53, s21
  s_mov_b32 s54, 4718592
  s_mov_b32 s55, 0x20000
  s_mov_b32 s56, s22
  s_mov_b32 s57, s23
  s_mov_b32 s58, 4718592
  s_mov_b32 s59, 0x20000
  s_mov_b32 s60, s24
  s_mov_b32 s61, s25
  s_mov_b32 s62, 4718592
  s_mov_b32 s63, 0x20000
  s_mov_b32 s64, s26
  s_mov_b32 s65, s27
  s_mov_b32 s66, 4718592
  s_mov_b32 s67, 0x20000
  s_lshl_b32 s76, s68, 8
  s_mul_i32 s6, s3, 131072
  s_add_u32 s6, s6, s76
  s_mul_i32 s7, s68, 147456
  s_mul_i32 s4, s3, 36864
  s_add_u32 s7, s7, s4
  s_lshl_b32 s12, s3, 12
  s_and_b32 s13, s68, 3
  s_add_u32 m0, s12, 0
  s_add_u32 s4, s7, 0
  buffer_load_dwordx4 v26, s[64:67], s4 offen lds
  s_add_u32 m0, s12, 1024
  s_add_u32 s4, s7, 9216
  buffer_load_dwordx4 v26, s[64:67], s4 offen lds
  s_add_u32 m0, s12, 2048
  s_add_u32 s4, s7, 18432
  buffer_load_dwordx4 v26, s[64:67], s4 offen lds
  s_add_u32 m0, s12, 3072
  s_add_u32 s4, s7, 27648
  buffer_load_dwordx4 v26, s[64:67], s4 offen lds
  s_add_u32 m0, s12, 16384
  s_add_u32 s4, s7, 128
  buffer_load_dwordx4 v26, s[64:67], s4 offen lds
  s_add_u32 m0, s12, 17408
  s_add_u32 s4, s7, 9344
  buffer_load_dwordx4 v26, s[64:67], s4 offen lds
  s_add_u32 m0, s12, 18432
  s_add_u32 s4, s7, 18560
  buffer_load_dwordx4 v26, s[64:67], s4 offen lds
  s_add_u32 m0, s12, 19456
  s_add_u32 s4, s7, 27776
  buffer_load_dwordx4 v26, s[64:67], s4 offen lds
  s_add_u32 m0, s12, 32768
  s_add_u32 s4, s7, 256
  buffer_load_dwordx4 v26, s[64:67], s4 offen lds
  s_add_u32 m0, s12, 33792
  s_add_u32 s4, s7, 9472
  buffer_load_dwordx4 v26, s[64:67], s4 offen lds
  s_add_u32 m0, s12, 34816
  s_add_u32 s4, s7, 18688
  buffer_load_dwordx4 v26, s[64:67], s4 offen lds
  s_add_u32 m0, s12, 35840
  s_add_u32 s4, s7, 27904
  buffer_load_dwordx4 v26, s[64:67], s4 offen lds
  s_add_u32 m0, s12, 49152
  s_add_u32 s4, s7, 384
  buffer_load_dwordx4 v26, s[64:67], s4 offen lds
  s_add_u32 m0, s12, 50176
  s_add_u32 s4, s7, 9600
  buffer_load_dwordx4 v26, s[64:67], s4 offen lds
  s_add_u32 m0, s12, 51200
  s_add_u32 s4, s7, 18816
  buffer_load_dwordx4 v26, s[64:67], s4 offen lds
  s_add_u32 m0, s12, 52224
  s_add_u32 s4, s7, 28032
  buffer_load_dwordx4 v26, s[64:67], s4 offen lds
  s_add_u32 m0, s12, 65536
  s_add_u32 s4, s7, 512
  buffer_load_dwordx4 v26, s[64:67], s4 offen lds
  s_add_u32 m0, s12, 66560
  s_add_u32 s4, s7, 9728
  buffer_load_dwordx4 v26, s[64:67], s4 offen lds
  s_add_u32 m0, s12, 67584
  s_add_u32 s4, s7, 18944
  buffer_load_dwordx4 v26, s[64:67], s4 offen lds
  s_add_u32 m0, s12, 68608
  s_add_u32 s4, s7, 28160
  buffer_load_dwordx4 v26, s[64:67], s4 offen lds
  s_add_u32 m0, s12, 81920
  s_add_u32 s4, s7, 640
  buffer_load_dwordx4 v26, s[64:67], s4 offen lds
  s_add_u32 m0, s12, 82944
  s_add_u32 s4, s7, 9856
  buffer_load_dwordx4 v26, s[64:67], s4 offen lds
  s_add_u32 m0, s12, 83968
  s_add_u32 s4, s7, 19072
  buffer_load_dwordx4 v26, s[64:67], s4 offen lds
  s_add_u32 m0, s12, 84992
  s_add_u32 s4, s7, 28288
  buffer_load_dwordx4 v26, s[64:67], s4 offen lds
  s_add_u32 m0, s12, 98304
  s_add_u32 s4, s7, 768
  buffer_load_dwordx4 v26, s[64:67], s4 offen lds
  s_add_u32 m0, s12, 99328
  s_add_u32 s4, s7, 9984
  buffer_load_dwordx4 v26, s[64:67], s4 offen lds
  s_add_u32 m0, s12, 100352
  s_add_u32 s4, s7, 19200
  buffer_load_dwordx4 v26, s[64:67], s4 offen lds
  s_add_u32 m0, s12, 101376
  s_add_u32 s4, s7, 28416
  buffer_load_dwordx4 v26, s[64:67], s4 offen lds
  s_add_u32 m0, s12, 114688
  s_add_u32 s4, s7, 896
  buffer_load_dwordx4 v26, s[64:67], s4 offen lds
  s_add_u32 m0, s12, 115712
  s_add_u32 s4, s7, 10112
  buffer_load_dwordx4 v26, s[64:67], s4 offen lds
  s_add_u32 m0, s12, 116736
  s_add_u32 s4, s7, 19328
  buffer_load_dwordx4 v26, s[64:67], s4 offen lds
  s_add_u32 m0, s12, 117760
  s_add_u32 s4, s7, 28544
  buffer_load_dwordx4 v26, s[64:67], s4 offen lds
  s_add_u32 m0, s12, 131072
  s_add_u32 s4, s7, 1024
  buffer_load_dwordx4 v26, s[64:67], s4 offen lds
  s_add_u32 m0, s12, 132096
  s_add_u32 s4, s7, 10240
  buffer_load_dwordx4 v26, s[64:67], s4 offen lds
  s_add_u32 m0, s12, 133120
  s_add_u32 s4, s7, 19456
  buffer_load_dwordx4 v26, s[64:67], s4 offen lds
  s_add_u32 m0, s12, 134144
  s_add_u32 s4, s7, 28672
  buffer_load_dwordx4 v26, s[64:67], s4 offen lds
  s_add_u32 m0, s12, 147456
  s_add_u32 s4, s6, 524288
  buffer_load_dwordx4 v24, s[52:55], s4 offen lds
  s_add_u32 m0, s12, 148480
  s_add_u32 s4, s6, 557056
  buffer_load_dwordx4 v25, s[52:55], s4 offen lds
  s_add_u32 m0, s12, 149504
  s_add_u32 s4, s6, 589824
  buffer_load_dwordx4 v24, s[52:55], s4 offen lds
  s_add_u32 m0, s12, 150528
  s_add_u32 s4, s6, 622592
  buffer_load_dwordx4 v25, s[52:55], s4 offen lds
  s_waitcnt vmcnt(40)
  s_barrier
  s_cmp_lg_u32 s3, 3
  s_cbranch_scc1 L_cpf_125
  s_getpc_b64 s[10:11]
L_pc_126:
  s_add_u32 s10, s10, (L_common_f-L_pc_126)&0xffffffff
  s_addc_u32 s11, s11, ((L_common_f-L_pc_126)>>32)&0xffffffff
  v_lshlrev_b32 v12, 7, v0
  v_min_u32 v14, L_exit-L_common_f, v12
  global_load_dword v13, v14, s[10:11]
L_cpf_125:
  s_cmp_lg_u32 s3, 0
  s_cbranch_scc1 L_ci_hs
  s_getreg_b32 s4, hwreg(HW_REG_XCC_ID)
  s_and_b32 s4, s4, 7
  s_mul_i32 s4, s4, 7
  s_mov_b64 s[10:11], 1
  s_lshl_b64 s[10:11], s[10:11], s4
  s_mov_b64 s[8:9], exec
  s_mov_b64 exec, 1
  v_mov_b32 v12, 0
  v_mov_b32 v14, s10
  v_mov_b32 v15, s11
  v_mov_b32 v13, 1
  global_atomic_add_x2 v12, v[14:15], s[42:43]
  global_atomic_add v12, v13, s[42:43] offset:16
  s_mov_b64 exec, s[8:9]
L_ci_hs:
  s_lshl_b32 s4, s3, 12
  v_add_u32 v3, s4, v1
  v_add_u32 v4, 0x10000, v3
  s_lshl_b32 s4, s3, 11
  s_add_u32 s4, s4, 98304
  v_add_u32 v5, s4, v1
  s_waitcnt vmcnt(36) lgkmcnt(0)
  s_barrier
  v_add_u32 v30, 0, v27
  ds_read_b64_tr_b16 a[152:153], v30 offset:0
  ds_read_b64_tr_b16 a[154:155], v30 offset:256
  ds_read_b64_tr_b16 a[156:157], v30 offset:2048
  ds_read_b64_tr_b16 a[158:159], v30 offset:2304
  ds_read_b64_tr_b16 a[160:161], v30 offset:8192
  ds_read_b64_tr_b16 a[162:163], v30 offset:8448
  ds_read_b64_tr_b16 a[164:165], v30 offset:10240
  ds_read_b64_tr_b16 a[166:167], v30 offset:10496
  s_waitcnt vmcnt(32) lgkmcnt(0)
  s_barrier
  s_add_u32 m0, s12, 0
  s_add_u32 s4, s6, 1048576
  buffer_load_dwordx4 v24, s[52:55], s4 offen lds
  s_add_u32 m0, s12, 1024
  s_add_u32 s4, s6, 1081344
  buffer_load_dwordx4 v25, s[52:55], s4 offen lds
  s_add_u32 m0, s12, 2048
  s_add_u32 s4, s6, 1114112
  buffer_load_dwordx4 v24, s[52:55], s4 offen lds
  s_add_u32 m0, s12, 3072
  s_add_u32 s4, s6, 1146880
  buffer_load_dwordx4 v25, s[52:55], s4 offen lds
  v_add_u32 v30, 16384, v27
  ds_read_b64_tr_b16 a[168:169], v30 offset:0
  ds_read_b64_tr_b16 a[170:171], v30 offset:256
  ds_read_b64_tr_b16 a[172:173], v30 offset:2048
  ds_read_b64_tr_b16 a[174:175], v30 offset:2304
  ds_read_b64_tr_b16 v[32:33], v30 offset:8192
  ds_read_b64_tr_b16 v[34:35], v30 offset:8448
  ds_read_b64_tr_b16 v[36:37], v30 offset:10240
  ds_read_b64_tr_b16 v[38:39], v30 offset:10496
  s_waitcnt vmcnt(32) lgkmcnt(0)
  s_barrier
  s_add_u32 m0, s12, 16384
  s_add_u32 s4, s6, 1572864
  buffer_load_dwordx4 v24, s[52:55], s4 offen lds
  s_add_u32 m0, s12, 17408
  s_add_u32 s4, s6, 1605632
  buffer_load_dwordx4 v25, s[52:55], s4 offen lds
  s_add_u32 m0, s12, 18432
  s_add_u32 s4, s6, 1638400
  buffer_load_dwordx4 v24, s[52:55], s4 offen lds
  s_add_u32 m0, s12, 19456
  s_add_u32 s4, s6, 1671168
  buffer_load_dwordx4 v25, s[52:55], s4 offen lds
  v_add_u32 v30, 32768, v27
  ds_read_b64_tr_b16 a[176:177], v30 offset:0
  ds_read_b64_tr_b16 a[178:179], v30 offset:256
  ds_read_b64_tr_b16 a[180:181], v30 offset:2048
  ds_read_b64_tr_b16 a[182:183], v30 offset:2304
  ds_read_b64_tr_b16 a[184:185], v30 offset:8192
  ds_read_b64_tr_b16 a[186:187], v30 offset:8448
  ds_read_b64_tr_b16 a[188:189], v30 offset:10240
  ds_read_b64_tr_b16 a[190:191], v30 offset:10496
  s_waitcnt vmcnt(32) lgkmcnt(0)
  s_barrier
  s_add_u32 m0, s12, 32768
  s_add_u32 s4, s6, 2097152
  buffer_load_dwordx4 v24, s[52:55], s4 offen lds
  s_add_u32 m0, s12, 33792
  s_add_u32 s4, s6, 2129920
  buffer_load_dwordx4 v25, s[52:55], s4 offen lds
  s_add_u32 m0, s12, 34816
  s_add_u32 s4, s6, 2162688
  buffer_load_dwordx4 v24, s[52:55], s4 offen lds
  s_add_u32 m0, s12, 35840
  s_add_u32 s4, s6, 2195456
  buffer_load_dwordx4 v25, s[52:55], s4 offen lds
  v_add_u32 v30, 49152, v27
  ds_read_b64_tr_b16 a[192:193], v30 offset:0
  ds_read_b64_tr_b16 a[194:195], v30 offset:256
  ds_read_b64_tr_b16 a[196:197], v30 offset:2048
  ds_read_b64_tr_b16 a[198:199], v30 offset:2304
  ds_read_b64_tr_b16 v[40:41], v30 offset:8192
  ds_read_b64_tr_b16 v[42:43], v30 offset:8448
  ds_read_b64_tr_b16 v[44:45], v30 offset:10240
  ds_read_b64_tr_b16 v[46:47], v30 offset:10496
  s_waitcnt vmcnt(32) lgkmcnt(0)
  s_barrier
  s_add_u32 m0, s12, 49152
  s_add_u32 s4, s6, 3145728
  buffer_load_dwordx4 v24, s[52:55], s4 offen lds
  s_add_u32 m0, s12, 50176
  s_add_u32 s4, s6, 3178496
  buffer_load_dwordx4 v25, s[52:55], s4 offen lds
  s_add_u32 m0, s12, 51200
  s_add_u32 s4, s6, 3211264
  buffer_load_dwordx4 v24, s[52:55], s4 offen lds
  s_add_u32 m0, s12, 52224
  s_add_u32 s4, s6, 3244032
  buffer_load_dwordx4 v25, s[52:55], s4 offen lds
  v_add_u32 v30, 65536, v27
  ds_read_b64_tr_b16 a[200:201], v30 offset:0
  ds_read_b64_tr_b16 a[202:203], v30 offset:256
  ds_read_b64_tr_b16 a[204:205], v30 offset:2048
  ds_read_b64_tr_b16 a[206:207], v30 offset:2304
  ds_read_b64_tr_b16 a[208:209], v30 offset:8192
  ds_read_b64_tr_b16 a[210:211], v30 offset:8448
  ds_read_b64_tr_b16 a[212:213], v30 offset:10240
  ds_read_b64_tr_b16 a[214:215], v30 offset:10496
  s_waitcnt vmcnt(32) lgkmcnt(0)
  s_barrier
  s_add_u32 m0, s12, 65536
  s_add_u32 s4, s6, 3670016
  buffer_load_dwordx4 v24, s[52:55], s4 offen lds
  s_add_u32 m0, s12, 66560
  s_add_u32 s4, s6, 3702784
  buffer_load_dwordx4 v25, s[52:55], s4 offen lds
  s_add_u32 m0, s12, 67584
  s_add_u32 s4, s6, 3735552
  buffer_load_dwordx4 v24, s[52:55], s4 offen lds
  s_add_u32 m0, s12, 68608
  s_add_u32 s4, s6, 3768320
  buffer_load_dwordx4 v25, s[52:55], s4 offen lds
  v_add_u32 v30, 81920, v27
  ds_read_b64_tr_b16 a[216:217], v30 offset:0
  ds_read_b64_tr_b16 a[218:219], v30 offset:256
  ds_read_b64_tr_b16 a[220:221], v30 offset:2048
  ds_read_b64_tr_b16 a[222:223], v30 offset:2304
  ds_read_b64_tr_b16 v[48:49], v30 offset:8192
  ds_read_b64_tr_b16 v[50:51], v30 offset:8448
  ds_read_b64_tr_b16 v[52:53], v30 offset:10240
  ds_read_b64_tr_b16 v[54:55], v30 offset:10496
  s_waitcnt vmcnt(32) lgkmcnt(0)
  s_barrier
  s_add_u32 m0, s12, 81920
  s_add_u32 s4, s6, 4194304
  buffer_load_dwordx4 v24, s[52:55], s4 offen lds
  s_add_u32 m0, s12, 82944
  s_add_u32 s4, s6, 4227072
  buffer_load_dwordx4 v25, s[52:55], s4 offen lds
  s_add_u32 m0, s12, 83968
  s_add_u32 s4, s6, 4259840
  buffer_load_dwordx4 v24, s[52:55], s4 offen lds
  s_add_u32 m0, s12, 84992
  s_add_u32 s4, s6, 4292608
  buffer_load_dwordx4 v25, s[52:55], s4 offen lds
  v_add_u32 v30, 98304, v27
  ds_read_b64_tr_b16 a[224:225], v30 offset:0
  ds_read_b64_tr_b16 a[226:227], v30 offset:256
  ds_read_b64_tr_b16 a[228:229], v30 offset:2048
  ds_read_b64_tr_b16 a[230:231], v30 offset:2304
  ds_read_b64_tr_b16 a[232:233], v30 offset:8192
  ds_read_b64_tr_b16 a[234:235], v30 offset:8448
  ds_read_b64_tr_b16 a[236:237], v30 offset:10240
  ds_read_b64_tr_b16 a[238:239], v30 offset:10496
  s_waitcnt vmcnt(32) lgkmcnt(0)
  s_barrier
  s_add_u32 m0, s12, 98304
  s_add_u32 s4, s6, 0
  buffer_load_dwordx4 v24, s[56:59], s4 offen lds
  s_add_u32 m0, s12, 99328
  s_add_u32 s4, s6, 32768
  buffer_load_dwordx4 v25, s[56:59], s4 offen lds
  s_add_u32 m0, s12, 100352
  s_add_u32 s4, s6, 65536
  buffer_load_dwordx4 v24, s[56:59], s4 offen lds
  s_add_u32 m0, s12, 101376
  s_add_u32 s4, s6, 98304
  buffer_load_dwordx4 v25, s[56:59], s4 offen lds
  v_add_u32 v30, 114688, v27
  ds_read_b64_tr_b16 a[240:241], v30 offset:0
  ds_read_b64_tr_b16 a[242:243], v30 offset:256
  ds_read_b64_tr_b16 a[244:245], v30 offset:2048
  ds_read_b64_tr_b16 a[246:247], v30 offset:2304
  ds_read_b64_tr_b16 v[56:57], v30 offset:8192
  ds_read_b64_tr_b16 v[58:59], v30 offset:8448
  ds_read_b64_tr_b16 v[60:61], v30 offset:10240
  ds_read_b64_tr_b16 v[62:63], v30 offset:10496
  s_waitcnt vmcnt(32) lgkmcnt(0)
  s_barrier
  s_add_u32 m0, s12, 114688
  s_add_u32 s4, s6, 524288
  buffer_load_dwordx4 v24, s[56:59], s4 offen lds
  s_add_u32 m0, s12, 115712
  s_add_u32 s4, s6, 557056
  buffer_load_dwordx4 v25, s[56:59], s4 offen lds
  s_add_u32 m0, s12, 116736
  s_add_u32 s4, s6, 589824
  buffer_load_dwordx4 v24, s[56:59], s4 offen lds
  s_add_u32 m0, s12, 117760
  s_add_u32 s4, s6, 622592
  buffer_load_dwordx4 v25, s[56:59], s4 offen lds
  v_add_u32 v30, 131072, v27
  ds_read_b64_tr_b16 a[248:249], v30 offset:0
  ds_read_b64_tr_b16 a[250:251], v30 offset:256
  ds_read_b64_tr_b16 a[252:253], v30 offset:2048
  ds_read_b64_tr_b16 a[254:255], v30 offset:2304
  ds_read_b64_tr_b16 v[64:65], v30 offset:8192
  ds_read_b64_tr_b16 v[66:67], v30 offset:8448
  ds_read_b64_tr_b16 v[68:69], v30 offset:10240
  ds_read_b64_tr_b16 v[70:71], v30 offset:10496
  s_waitcnt vmcnt(32) lgkmcnt(0)
  s_barrier
  s_add_u32 m0, s12, 131072
  s_add_u32 s4, s6, 1572864
  buffer_load_dwordx4 v24, s[56:59], s4 offen lds
  s_add_u32 m0, s12, 132096
  s_add_u32 s4, s6, 1605632
  buffer_load_dwordx4 v25, s[56:59], s4 offen lds
  s_add_u32 m0, s12, 133120
  s_add_u32 s4, s6, 1638400
  buffer_load_dwordx4 v24, s[56:59], s4 offen lds
  s_add_u32 m0, s12, 134144
  s_add_u32 s4, s6, 1671168
  buffer_load_dwordx4 v25, s[56:59], s4 offen lds
  v_add_u32 v30, 147456, v28
  ds_read_b64_tr_b16 v[104:105], v30 offset:0
  ds_read_b64_tr_b16 v[106:107], v30 offset:2048
  ds_read_b64_tr_b16 v[108:109], v30 offset:4096
  ds_read_b64_tr_b16 v[110:111], v30 offset:6144
  v_add_u32 v30, 147456, v29
  ds_read_b64_tr_b16 v[112:113], v30 offset:0
  ds_read_b64_tr_b16 v[114:115], v30 offset:2048
  ds_read_b64_tr_b16 v[116:117], v30 offset:4096
  ds_read_b64_tr_b16 v[118:119], v30 offset:6144
  s_waitcnt vmcnt(32) lgkmcnt(0)
  s_barrier
  s_add_u32 m0, s12, 147456
  s_add_u32 s4, s6, 2097152
  buffer_load_dwordx4 v24, s[56:59], s4 offen lds
  s_add_u32 m0, s12, 148480
  s_add_u32 s4, s6, 2129920
  buffer_load_dwordx4 v25, s[56:59], s4 offen lds
  s_add_u32 m0, s12, 149504
  s_add_u32 s4, s6, 2162688
  buffer_load_dwordx4 v24, s[56:59], s4 offen lds
  s_add_u32 m0, s12, 150528
  s_add_u32 s4, s6, 2195456
  buffer_load_dwordx4 v25, s[56:59], s4 offen lds
  v_add_u32 v30, 0, v28
  ds_read_b64_tr_b16 v[152:153], v30 offset:0
  ds_read_b64_tr_b16 v[154:155], v30 offset:2048
  ds_read_b64_tr_b16 v[156:157], v30 offset:4096
  ds_read_b64_tr_b16 v[158:159], v30 offset:6144
  v_add_u32 v30, 0, v29
  ds_read_b64_tr_b16 v[160:161], v30 offset:0
  ds_read_b64_tr_b16 v[162:163], v30 offset:2048
  ds_read_b64_tr_b16 v[164:165], v30 offset:4096
  ds_read_b64_tr_b16 v[166:167], v30 offset:6144
  s_waitcnt vmcnt(32) lgkmcnt(0)
  s_barrier
  s_add_u32 m0, s12, 0
  s_add_u32 s4, s6, 2621440
  buffer_load_dwordx4 v24, s[56:59], s4 offen lds
  s_add_u32 m0, s12, 1024
  s_add_u32 s4, s6, 2654208
  buffer_load_dwordx4 v25, s[56:59], s4 offen lds
  s_add_u32 m0, s12, 2048
  s_add_u32 s4, s6, 2686976
  buffer_load_dwordx4 v24, s[56:59], s4 offen lds
  s_add_u32 m0, s12, 3072
  s_add_u32 s4, s6, 2719744
  buffer_load_dwordx4 v25, s[56:59], s4 offen lds
  v_add_u32 v30, 16384, v28
  ds_read_b64_tr_b16 v[184:185], v30 offset:0
  ds_read_b64_tr_b16 v[186:187], v30 offset:2048
  ds_read_b64_tr_b16 v[188:189], v30 offset:4096
  ds_read_b64_tr_b16 v[190:191], v30 offset:6144
  v_add_u32 v30, 16384, v29
  ds_read_b64_tr_b16 v[192:193], v30 offset:0
  ds_read_b64_tr_b16 v[194:195], v30 offset:2048
  ds_read_b64_tr_b16 v[196:197], v30 offset:4096
  ds_read_b64_tr_b16 v[198:199], v30 offset:6144
  s_waitcnt vmcnt(32) lgkmcnt(0)
  s_barrier
  s_add_u32 m0, s12, 16384
  s_add_u32 s4, s6, 3670016
  buffer_load_dwordx4 v24, s[56:59], s4 offen lds
  s_add_u32 m0, s12, 17408
  s_add_u32 s4, s6, 3702784
  buffer_load_dwordx4 v25, s[56:59], s4 offen lds
  s_add_u32 m0, s12, 18432
  s_add_u32 s4, s6, 3735552
  buffer_load_dwordx4 v24, s[56:59], s4 offen lds
  s_add_u32 m0, s12, 19456
  s_add_u32 s4, s6, 3768320
  buffer_load_dwordx4 v25, s[56:59], s4 offen lds
  v_add_u32 v30, 32768, v28
  ds_read_b64_tr_b16 v[216:217], v30 offset:0
  ds_read_b64_tr_b16 v[218:219], v30 offset:2048
  ds_read_b64_tr_b16 v[220:221], v30 offset:4096
  ds_read_b64_tr_b16 v[222:223], v30 offset:6144
  v_add_u32 v30, 32768, v29
  ds_read_b64_tr_b16 v[224:225], v30 offset:0
  ds_read_b64_tr_b16 v[226:227], v30 offset:2048
  ds_read_b64_tr_b16 v[228:229], v30 offset:4096
  ds_read_b64_tr_b16 v[230:231], v30 offset:6144
  s_waitcnt vmcnt(32) lgkmcnt(0)
  s_barrier
  s_add_u32 m0, s12, 32768
  s_add_u32 s4, s6, 4194304
  buffer_load_dwordx4 v24, s[56:59], s4 offen lds
  s_add_u32 m0, s12, 33792
  s_add_u32 s4, s6, 4227072
  buffer_load_dwordx4 v25, s[56:59], s4 offen lds
  s_add_u32 m0, s12, 34816
  s_add_u32 s4, s6, 4259840
  buffer_load_dwordx4 v24, s[56:59], s4 offen lds
  s_add_u32 m0, s12, 35840
  s_add_u32 s4, s6, 4292608
  buffer_load_dwordx4 v25, s[56:59], s4 offen lds
  v_add_u32 v30, 49152, v28
  ds_read_b64_tr_b16 a[40:41], v30 offset:0
  ds_read_b64_tr_b16 a[42:43], v30 offset:2048
  ds_read_b64_tr_b16 a[44:45], v30 offset:4096
  ds_read_b64_tr_b16 a[46:47], v30 offset:6144
  v_add_u32 v30, 49152, v29
  ds_read_b64_tr_b16 a[48:49], v30 offset:0
  ds_read_b64_tr_b16 a[50:51], v30 offset:2048
  ds_read_b64_tr_b16 a[52:53], v30 offset:4096
  ds_read_b64_tr_b16 a[54:55], v30 offset:6144
  s_waitcnt vmcnt(32) lgkmcnt(0)
  s_barrier
  s_add_u32 m0, s12, 49152
  s_add_u32 s4, s6, 0
  buffer_load_dwordx4 v24, s[60:63], s4 offen lds
  s_add_u32 m0, s12, 50176
  s_add_u32 s4, s6, 32768
  buffer_load_dwordx4 v25, s[60:63], s4 offen lds
  s_add_u32 m0, s12, 51200
  s_add_u32 s4, s6, 65536
  buffer_load_dwordx4 v24, s[60:63], s4 offen lds
  s_add_u32 m0, s12, 52224
  s_add_u32 s4, s6, 98304
  buffer_load_dwordx4 v25, s[60:63], s4 offen lds
  v_add_u32 v30, 65536, v28
  ds_read_b64_tr_b16 a[72:73], v30 offset:0
  ds_read_b64_tr_b16 a[74:75], v30 offset:2048
  ds_read_b64_tr_b16 a[76:77], v30 offset:4096
  ds_read_b64_tr_b16 a[78:79], v30 offset:6144
  v_add_u32 v30, 65536, v29
  ds_read_b64_tr_b16 a[80:81], v30 offset:0
  ds_read_b64_tr_b16 a[82:83], v30 offset:2048
  ds_read_b64_tr_b16 a[84:85], v30 offset:4096
  ds_read_b64_tr_b16 a[86:87], v30 offset:6144
  s_waitcnt vmcnt(32) lgkmcnt(0)
  s_barrier
  s_add_u32 m0, s12, 65536
  s_add_u32 s4, s6, 524288
  buffer_load_dwordx4 v24, s[60:63], s4 offen lds
  s_add_u32 m0, s12, 66560
  s_add_u32 s4, s6, 557056
  buffer_load_dwordx4 v25, s[60:63], s4 offen lds
  s_add_u32 m0, s12, 67584
  s_add_u32 s4, s6, 589824
  buffer_load_dwordx4 v24, s[60:63], s4 offen lds
  s_add_u32 m0, s12, 68608
  s_add_u32 s4, s6, 622592
  buffer_load_dwordx4 v25, s[60:63], s4 offen lds
  v_add_u32 v30, 81920, v28
  ds_read_b64_tr_b16 a[120:121], v30 offset:0
  ds_read_b64_tr_b16 a[122:123], v30 offset:2048
  ds_read_b64_tr_b16 a[124:125], v30 offset:4096
  ds_read_b64_tr_b16 a[126:127], v30 offset:6144
  v_add_u32 v30, 81920, v29
  ds_read_b64_tr_b16 a[128:129], v30 offset:0
  ds_read_b64_tr_b16 a[130:131], v30 offset:2048
  ds_read_b64_tr_b16 a[132:133], v30 offset:4096
  ds_read_b64_tr_b16 a[134:135], v30 offset:6144
  s_waitcnt vmcnt(32) lgkmcnt(0)
  s_barrier
  s_add_u32 m0, s12, 81920
  s_add_u32 s4, s6, 1048576
  buffer_load_dwordx4 v24, s[60:63], s4 offen lds
  s_add_u32 m0, s12, 82944
  s_add_u32 s4, s6, 1081344
  buffer_load_dwordx4 v25, s[60:63], s4 offen lds
  s_add_u32 m0, s12, 83968
  s_add_u32 s4, s6, 1114112
  buffer_load_dwordx4 v24, s[60:63], s4 offen lds
  s_add_u32 m0, s12, 84992
  s_add_u32 s4, s6, 1146880
  buffer_load_dwordx4 v25, s[60:63], s4 offen lds
  v_add_u32 v30, 98304, v28
  ds_read_b64_tr_b16 v[72:73], v30 offset:0
  ds_read_b64_tr_b16 v[74:75], v30 offset:2048
  ds_read_b64_tr_b16 v[76:77], v30 offset:4096
  ds_read_b64_tr_b16 v[78:79], v30 offset:6144
  v_add_u32 v30, 98304, v29
  ds_read_b64_tr_b16 v[80:81], v30 offset:0
  ds_read_b64_tr_b16 v[82:83], v30 offset:2048
  ds_read_b64_tr_b16 v[84:85], v30 offset:4096
  ds_read_b64_tr_b16 v[86:87], v30 offset:6144
  s_waitcnt vmcnt(32) lgkmcnt(0)
  s_barrier
  s_add_u32 m0, s12, 98304
  s_add_u32 s4, s6, 2097152
  buffer_load_dwordx4 v24, s[60:63], s4 offen lds
  s_add_u32 m0, s12, 99328
  s_add_u32 s4, s6, 2129920
  buffer_load_dwordx4 v25, s[60:63], s4 offen lds
  s_add_u32 m0, s12, 100352
  s_add_u32 s4, s6, 2162688
  buffer_load_dwordx4 v24, s[60:63], s4 offen lds
  s_add_u32 m0, s12, 101376
  s_add_u32 s4, s6, 2195456
  buffer_load_dwordx4 v25, s[60:63], s4 offen lds
  v_add_u32 v30, 114688, v28
  ds_read_b64_tr_b16 v[120:121], v30 offset:0
  ds_read_b64_tr_b16 v[122:123], v30 offset:2048
  ds_read_b64_tr_b16 v[124:125], v30 offset:4096
  ds_read_b64_tr_b16 v[126:127], v30 offset:6144
  v_add_u32 v30, 114688, v29
  ds_read_b64_tr_b16 v[128:129], v30 offset:0
  ds_read_b64_tr_b16 v[130:131], v30 offset:2048
  ds_read_b64_tr_b16 v[132:133], v30 offset:4096
  ds_read_b64_tr_b16 v[134:135], v30 offset:6144
  s_waitcnt vmcnt(32) lgkmcnt(0)
  s_barrier
  s_add_u32 m0, s12, 114688
  s_add_u32 s4, s6, 2621440
  buffer_load_dwordx4 v24, s[60:63], s4 offen lds
  s_add_u32 m0, s12, 115712
  s_add_u32 s4, s6, 2654208
  buffer_load_dwordx4 v25, s[60:63], s4 offen lds
  s_add_u32 m0, s12, 116736
  s_add_u32 s4, s6, 2686976
  buffer_load_dwordx4 v24, s[60:63], s4 offen lds
  s_add_u32 m0, s12, 117760
  s_add_u32 s4, s6, 2719744
  buffer_load_dwordx4 v25, s[60:63], s4 offen lds
  v_add_u32 v30, 131072, v28
  ds_read_b64_tr_b16 v[200:201], v30 offset:0
  ds_read_b64_tr_b16 v[202:203], v30 offset:2048
  ds_read_b64_tr_b16 v[204:205], v30 offset:4096
  ds_read_b64_tr_b16 v[206:207], v30 offset:6144
  v_add_u32 v30, 131072, v29
  ds_read_b64_tr_b16 v[208:209], v30 offset:0
  ds_read_b64_tr_b16 v[210:211], v30 offset:2048
  ds_read_b64_tr_b16 v[212:213], v30 offset:4096
  ds_read_b64_tr_b16 v[214:215], v30 offset:6144
  s_waitcnt vmcnt(32) lgkmcnt(0)
  s_barrier
  s_add_u32 m0, s12, 131072
  s_add_u32 s4, s6, 3145728
  buffer_load_dwordx4 v24, s[60:63], s4 offen lds
  s_add_u32 m0, s12, 132096
  s_add_u32 s4, s6, 3178496
  buffer_load_dwordx4 v25, s[60:63], s4 offen lds
  s_add_u32 m0, s12, 133120
  s_add_u32 s4, s6, 3211264
  buffer_load_dwordx4 v24, s[60:63], s4 offen lds
  s_add_u32 m0, s12, 134144
  s_add_u32 s4, s6, 3244032
  buffer_load_dwordx4 v25, s[60:63], s4 offen lds
  v_add_u32 v30, 147456, v28
  ds_read_b64_tr_b16 v[232:233], v30 offset:0
  ds_read_b64_tr_b16 v[234:235], v30 offset:2048
  ds_read_b64_tr_b16 v[236:237], v30 offset:4096
  ds_read_b64_tr_b16 v[238:239], v30 offset:6144
  v_add_u32 v30, 147456, v29
  ds_read_b64_tr_b16 v[240:241], v30 offset:0
  ds_read_b64_tr_b16 v[242:243], v30 offset:2048
  ds_read_b64_tr_b16 v[244:245], v30 offset:4096
  ds_read_b64_tr_b16 v[246:247], v30 offset:6144
  s_waitcnt vmcnt(32) lgkmcnt(0)
  s_barrier
  s_add_u32 m0, s12, 147456
  s_add_u32 s4, s6, 3670016
  buffer_load_dwordx4 v24, s[60:63], s4 offen lds
  s_add_u32 m0, s12, 148480
  s_add_u32 s4, s6, 3702784
  buffer_load_dwordx4 v25, s[60:63], s4 offen lds
  s_add_u32 m0, s12, 149504
  s_add_u32 s4, s6, 3735552
  buffer_load_dwordx4 v24, s[60:63], s4 offen lds
  s_add_u32 m0, s12, 150528
  s_add_u32 s4, s6, 3768320
  buffer_load_dwordx4 v25, s[60:63], s4 offen lds
  v_add_u32 v30, 0, v28
  ds_read_b64_tr_b16 a[8:9], v30 offset:0
  ds_read_b64_tr_b16 a[10:11], v30 offset:2048
  ds_read_b64_tr_b16 a[12:13], v30 offset:4096
  ds_read_b64_tr_b16 a[14:15], v30 offset:6144
  v_add_u32 v30, 0, v29
  ds_read_b64_tr_b16 a[16:17], v30 offset:0
  ds_read_b64_tr_b16 a[18:19], v30 offset:2048
  ds_read_b64_tr_b16 a[20:21], v30 offset:4096
  ds_read_b64_tr_b16 a[22:23], v30 offset:6144
  s_waitcnt vmcnt(32) lgkmcnt(0)
  s_barrier
  s_add_u32 m0, s12, 0
  s_add_u32 s4, s6, 0
  buffer_load_dwordx4 v24, s[52:55], s4 offen lds
  s_add_u32 m0, s12, 1024
  s_add_u32 s4, s6, 32768
  buffer_load_dwordx4 v25, s[52:55], s4 offen lds
  s_add_u32 m0, s12, 2048
  s_add_u32 s4, s6, 65536
  buffer_load_dwordx4 v24, s[52:55], s4 offen lds
  s_add_u32 m0, s12, 3072
  s_add_u32 s4, s6, 98304
  buffer_load_dwordx4 v25, s[52:55], s4 offen lds
  v_add_u32 v30, 16384, v28
  ds_read_b64_tr_b16 a[88:89], v30 offset:0
  ds_read_b64_tr_b16 a[90:91], v30 offset:2048
  ds_read_b64_tr_b16 a[92:93], v30 offset:4096
  ds_read_b64_tr_b16 a[94:95], v30 offset:6144
  v_add_u32 v30, 16384, v29
  ds_read_b64_tr_b16 a[96:97], v30 offset:0
  ds_read_b64_tr_b16 a[98:99], v30 offset:2048
  ds_read_b64_tr_b16 a[100:101], v30 offset:4096
  ds_read_b64_tr_b16 a[102:103], v30 offset:6144
  s_waitcnt vmcnt(32) lgkmcnt(0)
  s_barrier
  s_add_u32 m0, s12, 16384
  s_add_u32 s4, s6, 1048576
  buffer_load_dwordx4 v24, s[56:59], s4 offen lds
  s_add_u32 m0, s12, 17408
  s_add_u32 s4, s6, 1081344
  buffer_load_dwordx4 v25, s[56:59], s4 offen lds
  s_add_u32 m0, s12, 18432
  s_add_u32 s4, s6, 1114112
  buffer_load_dwordx4 v24, s[56:59], s4 offen lds
  s_add_u32 m0, s12, 19456
  s_add_u32 s4, s6, 1146880
  buffer_load_dwordx4 v25, s[56:59], s4 offen lds
  v_add_u32 v30, 32768, v28
  ds_read_b64_tr_b16 a[136:137], v30 offset:0
  ds_read_b64_tr_b16 a[138:139], v30 offset:2048
  ds_read_b64_tr_b16 a[140:141], v30 offset:4096
  ds_read_b64_tr_b16 a[142:143], v30 offset:6144
  v_add_u32 v30, 32768, v29
  ds_read_b64_tr_b16 a[144:145], v30 offset:0
  ds_read_b64_tr_b16 a[146:147], v30 offset:2048
  ds_read_b64_tr_b16 a[148:149], v30 offset:4096
  ds_read_b64_tr_b16 a[150:151], v30 offset:6144
  s_waitcnt vmcnt(32) lgkmcnt(0)
  s_barrier
  s_add_u32 m0, s12, 32768
  s_add_u32 s4, s6, 1572864
  buffer_load_dwordx4 v24, s[60:63], s4 offen lds
  s_add_u32 m0, s12, 33792
  s_add_u32 s4, s6, 1605632
  buffer_load_dwordx4 v25, s[60:63], s4 offen lds
  s_add_u32 m0, s12, 34816
  s_add_u32 s4, s6, 1638400
  buffer_load_dwordx4 v24, s[60:63], s4 offen lds
  s_add_u32 m0, s12, 35840
  s_add_u32 s4, s6, 1671168
  buffer_load_dwordx4 v25, s[60:63], s4 offen lds
  v_add_u32 v30, 49152, v28
  ds_read_b64_tr_b16 v[88:89], v30 offset:0
  ds_read_b64_tr_b16 v[90:91], v30 offset:2048
  ds_read_b64_tr_b16 v[92:93], v30 offset:4096
  ds_read_b64_tr_b16 v[94:95], v30 offset:6144
  v_add_u32 v30, 49152, v29
  ds_read_b64_tr_b16 v[96:97], v30 offset:0
  ds_read_b64_tr_b16 v[98:99], v30 offset:2048
  ds_read_b64_tr_b16 v[100:101], v30 offset:4096
  ds_read_b64_tr_b16 v[102:103], v30 offset:6144
  s_waitcnt vmcnt(32) lgkmcnt(0)
  s_barrier
  s_add_u32 m0, s12, 49152
  s_add_u32 s4, s6, 2621440
  buffer_load_dwordx4 v24, s[52:55], s4 offen lds
  s_add_u32 m0, s12, 50176
  s_add_u32 s4, s6, 2654208
  buffer_load_dwordx4 v25, s[52:55], s4 offen lds
  s_add_u32 m0, s12, 51200
  s_add_u32 s4, s6, 2686976
  buffer_load_dwordx4 v24, s[52:55], s4 offen lds
  s_add_u32 m0, s12, 52224
  s_add_u32 s4, s6, 2719744
  buffer_load_dwordx4 v25, s[52:55], s4 offen lds
  v_add_u32 v30, 65536, v28
  ds_read_b64_tr_b16 v[136:137], v30 offset:0
  ds_read_b64_tr_b16 v[138:139], v30 offset:2048
  ds_read_b64_tr_b16 v[140:141], v30 offset:4096
  ds_read_b64_tr_b16 v[142:143], v30 offset:6144
  v_add_u32 v30, 65536, v29
  ds_read_b64_tr_b16 v[144:145], v30 offset:0
  ds_read_b64_tr_b16 v[146:147], v30 offset:2048
  ds_read_b64_tr_b16 v[148:149], v30 offset:4096
  ds_read_b64_tr_b16 v[150:151], v30 offset:6144
  s_waitcnt vmcnt(32) lgkmcnt(0)
  s_barrier
  s_add_u32 m0, s12, 65536
  s_add_u32 s4, s6, 3145728
  buffer_load_dwordx4 v24, s[56:59], s4 offen lds
  s_add_u32 m0, s12, 66560
  s_add_u32 s4, s6, 3178496
  buffer_load_dwordx4 v25, s[56:59], s4 offen lds
  s_add_u32 m0, s12, 67584
  s_add_u32 s4, s6, 3211264
  buffer_load_dwordx4 v24, s[56:59], s4 offen lds
  s_add_u32 m0, s12, 68608
  s_add_u32 s4, s6, 3244032
  buffer_load_dwordx4 v25, s[56:59], s4 offen lds
  v_add_u32 v30, 81920, v28
  ds_read_b64_tr_b16 v[168:169], v30 offset:0
  ds_read_b64_tr_b16 v[170:171], v30 offset:2048
  ds_read_b64_tr_b16 v[172:173], v30 offset:4096
  ds_read_b64_tr_b16 v[174:175], v30 offset:6144
  v_add_u32 v30, 81920, v29
  ds_read_b64_tr_b16 v[176:177], v30 offset:0
  ds_read_b64_tr_b16 v[178:179], v30 offset:2048
  ds_read_b64_tr_b16 v[180:181], v30 offset:4096
  ds_read_b64_tr_b16 v[182:183], v30 offset:6144
  s_waitcnt vmcnt(32) lgkmcnt(0)
  s_barrier
  s_add_u32 m0, s12, 81920
  s_add_u32 s4, s6, 4194304
  buffer_load_dwordx4 v24, s[60:63], s4 offen lds
  s_add_u32 m0, s12, 82944
  s_add_u32 s4, s6, 4227072
  buffer_load_dwordx4 v25, s[60:63], s4 offen lds
  s_add_u32 m0, s12, 83968
  s_add_u32 s4, s6, 4259840
  buffer_load_dwordx4 v24, s[60:63], s4 offen lds
  s_add_u32 m0, s12, 84992
  s_add_u32 s4, s6, 4292608
  buffer_load_dwordx4 v25, s[60:63], s4 offen lds
  v_add_u32 v30, 98304, v28
  ds_read_b64_tr_b16 v[248:249], v30 offset:0
  ds_read_b64_tr_b16 v[250:251], v30 offset:2048
  ds_read_b64_tr_b16 v[252:253], v30 offset:4096
  ds_read_b64_tr_b16 v[254:255], v30 offset:6144
  v_add_u32 v30, 98304, v29
  ds_read_b64_tr_b16 a[0:1], v30 offset:0
  ds_read_b64_tr_b16 a[2:3], v30 offset:2048
  ds_read_b64_tr_b16 a[4:5], v30 offset:4096
  ds_read_b64_tr_b16 a[6:7], v30 offset:6144
  s_waitcnt vmcnt(32) lgkmcnt(0)
  s_barrier
  v_add_u32 v30, 114688, v28
  ds_read_b64_tr_b16 a[24:25], v30 offset:0
  ds_read_b64_tr_b16 a[26:27], v30 offset:2048
  ds_read_b64_tr_b16 a[28:29], v30 offset:4096
  ds_read_b64_tr_b16 a[30:31], v30 offset:6144
  v_add_u32 v30, 114688, v29
  ds_read_b64_tr_b16 a[32:33], v30 offset:0
  ds_read_b64_tr_b16 a[34:35], v30 offset:2048
  ds_read_b64_tr_b16 a[36:37], v30 offset:4096
  ds_read_b64_tr_b16 a[38:39], v30 offset:6144
  s_waitcnt vmcnt(28) lgkmcnt(0)
  s_barrier
  v_add_u32 v30, 131072, v28
  ds_read_b64_tr_b16 a[56:57], v30 offset:0
  ds_read_b64_tr_b16 a[58:59], v30 offset:2048
  ds_read_b64_tr_b16 a[60:61], v30 offset:4096
  ds_read_b64_tr_b16 a[62:63], v30 offset:6144
  v_add_u32 v30, 131072, v29
  ds_read_b64_tr_b16 a[64:65], v30 offset:0
  ds_read_b64_tr_b16 a[66:67], v30 offset:2048
  ds_read_b64_tr_b16 a[68:69], v30 offset:4096
  ds_read_b64_tr_b16 a[70:71], v30 offset:6144
  s_waitcnt vmcnt(24) lgkmcnt(0)
  s_barrier
  v_add_u32 v30, 147456, v28
  ds_read_b64_tr_b16 a[104:105], v30 offset:0
  ds_read_b64_tr_b16 a[106:107], v30 offset:2048
  ds_read_b64_tr_b16 a[108:109], v30 offset:4096
  ds_read_b64_tr_b16 a[110:111], v30 offset:6144
  v_add_u32 v30, 147456, v29
  ds_read_b64_tr_b16 a[112:113], v30 offset:0
  ds_read_b64_tr_b16 a[114:115], v30 offset:2048
  ds_read_b64_tr_b16 a[116:117], v30 offset:4096
  ds_read_b64_tr_b16 a[118:119], v30 offset:6144
  s_waitcnt vmcnt(20) lgkmcnt(0)
  s_barrier
  ds_write_b128 v5, v[32:35] offset:0
  ds_write_b128 v5, v[36:39] offset:1024
  ds_write_b128 v5, v[40:43] offset:8192
  ds_write_b128 v5, v[44:47] offset:9216
  ds_write_b128 v5, v[48:51] offset:16384
  ds_write_b128 v5, v[52:55] offset:17408
  ds_write_b128 v5, v[56:59] offset:24576
  ds_write_b128 v5, v[60:63] offset:25600
  ds_write_b128 v5, v[64:67] offset:32768
  ds_write_b128 v5, v[68:71] offset:33792
  s_waitcnt lgkmcnt(0)
  v_add_u32 v30, 0, v28
  ds_read_b64_tr_b16 v[32:33], v30 offset:0
  ds_read_b64_tr_b16 v[34:35], v30 offset:2048
  ds_read_b64_tr_b16 v[36:37], v30 offset:4096
  ds_read_b64_tr_b16 v[38:39], v30 offset:6144
  v_add_u32 v30, 0, v29
  ds_read_b64_tr_b16 v[40:41], v30 offset:0
  ds_read_b64_tr_b16 v[42:43], v30 offset:2048
  ds_read_b64_tr_b16 v[44:45], v30 offset:4096
  ds_read_b64_tr_b16 v[46:47], v30 offset:6144
  s_waitcnt lgkmcnt(0)
  s_barrier
  ds_write_b128 v3, v[32:35] offset:0
  ds_write_b128 v3, v[36:39] offset:1024
  ds_write_b128 v3, v[40:43] offset:2048
  ds_write_b128 v3, v[44:47] offset:3072
  s_waitcnt vmcnt(16) lgkmcnt(0)
  s_barrier
  v_add_u32 v30, 16384, v28
  ds_read_b64_tr_b16 v[32:33], v30 offset:0
  ds_read_b64_tr_b16 v[34:35], v30 offset:2048
  ds_read_b64_tr_b16 v[36:37], v30 offset:4096
  ds_read_b64_tr_b16 v[38:39], v30 offset:6144
  v_add_u32 v30, 16384, v29
  ds_read_b64_tr_b16 v[40:41], v30 offset:0
  ds_read_b64_tr_b16 v[42:43], v30 offset:2048
  ds_read_b64_tr_b16 v[44:45], v30 offset:4096
  ds_read_b64_tr_b16 v[46:47], v30 offset:6144
  s_waitcnt lgkmcnt(0)
  s_barrier
  ds_write_b128 v3, v[32:35] offset:16384
  ds_write_b128 v3, v[36:39] offset:17408
  ds_write_b128 v3, v[40:43] offset:18432
  ds_write_b128 v3, v[44:47] offset:19456
  s_waitcnt vmcnt(12) lgkmcnt(0)
  s_barrier
  v_add_u32 v30, 32768, v28
  ds_read_b64_tr_b16 v[32:33], v30 offset:0
  ds_read_b64_tr_b16 v[34:35], v30 offset:2048
  ds_read_b64_tr_b16 v[36:37], v30 offset:4096
  ds_read_b64_tr_b16 v[38:39], v30 offset:6144
  v_add_u32 v30, 32768, v29
  ds_read_b64_tr_b16 v[40:41], v30 offset:0
  ds_read_b64_tr_b16 v[42:43], v30 offset:2048
  ds_read_b64_tr_b16 v[44:45], v30 offset:4096
  ds_read_b64_tr_b16 v[46:47], v30 offset:6144
  s_waitcnt lgkmcnt(0)
  s_barrier
  ds_write_b128 v3, v[32:35] offset:32768
  ds_write_b128 v3, v[36:39] offset:33792
  ds_write_b128 v3, v[40:43] offset:34816
  ds_write_b128 v3, v[44:47] offset:35840
  s_waitcnt vmcnt(8) lgkmcnt(0)
  s_barrier
  v_mov_b32 v12, 0
  global_load_dwordx2 v[14:15], v12, s[42:43] sc1
  v_add_u32 v30, 49152, v28
  ds_read_b64_tr_b16 v[32:33], v30 offset:0
  ds_read_b64_tr_b16 v[34:35], v30 offset:2048
  ds_read_b64_tr_b16 v[36:37], v30 offset:4096
  ds_read_b64_tr_b16 v[38:39], v30 offset:6144
  v_add_u32 v30, 49152, v29
  ds_read_b64_tr_b16 v[40:41], v30 offset:0
  ds_read_b64_tr_b16 v[42:43], v30 offset:2048
  ds_read_b64_tr_b16 v[44:45], v30 offset:4096
  ds_read_b64_tr_b16 v[46:47], v30 offset:6144
  s_waitcnt lgkmcnt(0)
  s_barrier
  ds_write_b128 v3, v[32:35] offset:49152
  ds_write_b128 v3, v[36:39] offset:50176
  ds_write_b128 v3, v[40:43] offset:51200
  ds_write_b128 v3, v[44:47] offset:52224
  s_waitcnt vmcnt(4) lgkmcnt(0)
  s_barrier
  v_add_u32 v30, 65536, v28
  ds_read_b64_tr_b16 v[32:33], v30 offset:0
  ds_read_b64_tr_b16 v[34:35], v30 offset:2048
  ds_read_b64_tr_b16 v[36:37], v30 offset:4096
  ds_read_b64_tr_b16 v[38:39], v30 offset:6144
  v_add_u32 v30, 65536, v29
  ds_read_b64_tr_b16 v[40:41], v30 offset:0
  ds_read_b64_tr_b16 v[42:43], v30 offset:2048
  ds_read_b64_tr_b16 v[44:45], v30 offset:4096
  ds_read_b64_tr_b16 v[46:47], v30 offset:6144
  s_waitcnt lgkmcnt(0)
  s_barrier
  ds_write_b128 v4, v[32:35] offset:0
  ds_write_b128 v4, v[36:39] offset:1024
  ds_write_b128 v4, v[40:43] offset:2048
  ds_write_b128 v4, v[44:47] offset:3072
  s_waitcnt vmcnt(0) lgkmcnt(0)
  s_barrier
  v_add_u32 v30, 81920, v28
  ds_read_b64_tr_b16 v[32:33], v30 offset:0
  ds_read_b64_tr_b16 v[34:35], v30 offset:2048
  ds_read_b64_tr_b16 v[36:37], v30 offset:4096
  ds_read_b64_tr_b16 v[38:39], v30 offset:6144
  v_add_u32 v30, 81920, v29
  ds_read_b64_tr_b16 v[40:41], v30 offset:0
  ds_read_b64_tr_b16 v[42:43], v30 offset:2048
  ds_read_b64_tr_b16 v[44:45], v30 offset:4096
  ds_read_b64_tr_b16 v[46:47], v30 offset:6144
  s_waitcnt lgkmcnt(0)
  s_barrier
  ds_write_b128 v4, v[32:35] offset:16384
  ds_write_b128 v4, v[36:39] offset:17408
  ds_write_b128 v4, v[40:43] offset:18432
  ds_write_b128 v4, v[44:47] offset:19456
  s_waitcnt vmcnt(0) lgkmcnt(0)
  s_barrier
  v_readfirstlane_b32 s8, v14
  v_readfirstlane_b32 s9, v15
  v_mov_b32 v12, 0
  s_mov_b32 s4, s8
  s_mov_b32 s5, s9
  s_branch L_ci_w2
L_ci_w:
  global_load_dwordx2 v[14:15], v12, s[42:43] sc1
  s_waitcnt vmcnt(0)
  v_readfirstlane_b32 s4, v14
  v_readfirstlane_b32 s5, v15
L_ci_w2:
  s_mov_b32 s6, 0
  s_mov_b32 s7, 0
  s_and_b32 s10, s4, 127
  s_add_u32 s6, s6, s10
  s_max_u32 s7, s7, s10
  s_lshr_b64 s[4:5], s[4:5], 7
  s_and_b32 s10, s4, 127
  s_add_u32 s6, s6, s10
  s_max_u32 s7, s7, s10
  s_lshr_b64 s[4:5], s[4:5], 7
  s_and_b32 s10, s4, 127
  s_add_u32 s6, s6, s10
  s_max_u32 s7, s7, s10
  s_lshr_b64 s[4:5], s[4:5], 7
  s_and_b32 s10, s4, 127
  s_add_u32 s6, s6, s10
  s_max_u32 s7, s7, s10
  s_lshr_b64 s[4:5], s[4:5], 7
  s_and_b32 s10, s4, 127
  s_add_u32 s6, s6, s10
  s_max_u32 s7, s7, s10
  s_lshr_b64 s[4:5], s[4:5], 7
  s_and_b32 s10, s4, 127
  s_add_u32 s6, s6, s10
  s_max_u32 s7, s7, s10
  s_lshr_b64 s[4:5], s[4:5], 7
  s_and_b32 s10, s4, 127
  s_add_u32 s6, s6, s10
  s_max_u32 s7, s7, s10
  s_lshr_b64 s[4:5], s[4:5], 7
  s_and_b32 s10, s4, 127
  s_add_u32 s6, s6, s10
  s_max_u32 s7, s7, s10
  s_lshr_b64 s[4:5], s[4:5], 7
  s_cmp_ge_u32 s6, 32
  s_cbranch_scc1 L_ci_go
  s_sleep 2
  s_add_u32 s47, s47, 1
  s_cmp_gt_u32 s47, 131072
  s_cbranch_scc1 L_exit
  s_branch L_ci_w
L_ci_go:
  s_cmp_ge_u32 s7, 32
  s_cselect_b32 s69, 0, 1
  v_lshlrev_b32 v71, 3, v1
  v_and_b32 v71, 0xf80, v71
  s_mov_b32 s4, 0
  buffer_load_dword v71, v71, s[48:51], s4 offen sc1
  v_bfe_u32 v12, v0, 1, 1
  v_mov_b32 v2, 0x4444
  v_mov_b32 v13, 0xeeee
  v_cmp_eq_u32 vcc, 1, v12
  s_nop 1
  v_cndmask_b32 v2, v2, v13, vcc
  v_lshrrev_b32 v12, 2, v0
  v_lshlrev_b32 v12, 5, v12
  v_and_b32 v13, 3, v0
  v_lshlrev_b32 v13, 3, v13
  v_add_u32 v12, v12, v13
  v_add_u32 v6, 148480, v12
  v_and_b32 v12, 15, v0
  s_lshl_b32 s4, s3, 5
  v_add_u32 v12, s4, v12
  v_lshlrev_b32 v12, 5, v12
  v_lshrrev_b32 v13, 4, v0
  v_lshlrev_b32 v13, 3, v13
  v_add_u32 v12, v12, v13
  v_add_u32 v7, 148480, v12
  v_bfe_u32 v12, v0, 2, 2
  v_lshlrev_b32 v12, 2, v12
  v_and_b32 v13, 1, v0
  s_and_b32 s4, s3, 1
  s_lshl_b32 s4, s4, 1
  v_add3_u32 v12, v12, v13, s4
  v_lshrrev_b32 v13, 5, v0
  v_lshlrev_b32 v13, 4, v13
  v_add_u32 v12, v12, v13
  v_lshlrev_b32 v12, 4, v12
  v_bfe_u32 v13, v0, 4, 1
  v_lshlrev_b32 v13, 3, v13
  v_add_u32 v12, v12, v13
  s_lshr_b32 s4, s3, 1
  s_lshl_b32 s4, s4, 10
  s_add_u32 s4, s4, 152576
  v_add_u32 v8, s4, v12
  v_lshlrev_b32 v12, 3, v0
  v_add_u32 v12, 139264, v12
  v_bfe_u32 v13, v0, 1, 1
  v_cmp_eq_u32 vcc, 0, v13
  s_nop 1
  v_cndmask_b32 v8, v8, v12, vcc
  s_mov_b32 s84, 0xcccccccc
  s_mov_b32 s85, 0xcccccccc
  s_mov_b32 s78, 0x3e0293ee
  s_mov_b32 s75, -1
  s_cmp_eq_u32 s3, 0
  s_cselect_b32 s75, s68, s75
  s_add_u32 s4, s68, 32
  s_cmp_lt_u32 s68, 4
  s_cselect_b32 s4, s4, -1
  s_cmp_eq_u32 s3, 1
  s_cselect_b32 s75, s4, s75
  s_lshr_b32 s4, s75, 2
  s_lshl_b32 s4, s4, 10
  s_and_b32 s5, s75, 1
  s_lshl_b32 s5, s5, 9
  s_add_u32 s4, s4, s5
  s_bfe_u32 s5, s75, 0x10001
  s_lshl_b32 s5, s5, 5
  s_add_u32 s4, s4, s5
  v_bfe_u32 v12, v0, 2, 1
  v_lshlrev_b32 v12, 8, v12
  v_lshrrev_b32 v13, 4, v0
  v_lshlrev_b32 v13, 6, v13
  v_add_u32 v12, v12, v13
  v_and_b32 v13, 1, v0
  v_lshlrev_b32 v13, 4, v13
  v_add_u32 v12, v12, v13
  v_bfe_u32 v13, v0, 1, 1
  v_lshlrev_b32 v13, 3, v13
  v_add_u32 v12, v12, v13
  v_add_u32 v10, s4, v12
  v_bfe_u32 v13, v0, 3, 1
  v_mul_u32_u24 v13, 0, v13
  v_add_u32 v10, v10, v13
  v_and_b32 v12, 7, v0
  v_lshrrev_b32 v13, 1, v12
  v_and_b32 v16, 1, v12
  v_lshlrev_b32 v16, 4, v16
  v_mov_b32 v17, 0x3f80
  v_lshlrev_b32 v17, v16, v17
  v_cmp_eq_u32 vcc, 0, v13
  s_nop 1
  v_cndmask_b32 v20, 0, v17, vcc
  v_cmp_eq_u32 vcc, 1, v13
  s_nop 1
  v_cndmask_b32 v21, 0, v17, vcc
  v_cmp_eq_u32 vcc, 2, v13
  s_nop 1
  v_cndmask_b32 v22, 0, v17, vcc
  v_cmp_eq_u32 vcc, 3, v13
  s_nop 1
  v_cndmask_b32 v23, 0, v17, vcc
  v_add_u32 v16, 162816, v1
  ds_write_b128 v16, v[20:23]
  s_waitcnt lgkmcnt(0)
  s_mov_b32 s70, -1
  v_add_u32 v11, 131072, v1
  s_lshl_b32 s30, s3, 10
  s_lshl_b32 s4, s68, 13
  s_lshl_b32 s5, s3, 11
  s_add_u32 s4, s4, s5
  s_add_u32 s24, s4, 1048576
  s_add_u32 s25, s4, 17563648
  s_lshl_b32 s4, s68, 12
  s_add_u32 s4, s4, s30
  s_add_u32 s27, s4, 51380224
  s_lshl_b32 s4, s68, 7
  s_add_u32 s29, s4, 20480
  s_mov_b32 s28, s29
  s_cmp_eq_u32 s3, 3
  s_cselect_b32 s29, s29, 268435456
  s_lshl_b32 s4, s3, 13
  s_add_u32 s4, s4, s76
  s_add_u32 s18, s4, 360448
  s_add_u32 s5, s4, 65536
  s_xor_b32 s19, s18, s5
  s_lshl_b32 s4, s75, 13
  s_add_u32 s16, s4, 65536
  s_add_u32 s5, s4, 360448
  s_xor_b32 s17, s16, s5
  s_mov_b32 s20, 196608
  s_and_b32 s4, s68, 0
  s_mul_i32 s4, s4, 9472
  s_add_u32 s77, s4, 655360
  s_lshl_b32 s4, s68, 13
  s_lshl_b32 s5, s3, 11
  s_add_u32 s4, s4, s5
  s_add_u32 s41, s4, 65536
  s_add_u32 s5, s4, 360448
  s_xor_b32 s86, s41, s5
  s_add_u32 s42, s41, 262144
  s_add_u32 s5, s5, 262144
  s_xor_b32 s87, s42, s5
  s_cmp_lt_u32 s68, 4
  s_cselect_b32 s42, s42, 268435456
  s_cselect_b32 s87, s87, 0
  s_mov_b32 s79, s78
  s_mov_b32 s43, 268435456
  s_mov_b32 s83, 0x42700000
  s_mov_b32 s80, 0
  s_waitcnt vmcnt(0)
  v_cmp_le_u32 vcc, 32, v71
  s_nop 1
  s_not_b32 s4, vcc_lo
  s_ff1_i32_b32 s4, s4
  s_cmp_eq_u32 s4, -1
  s_cselect_b32 s81, 32, s4
  s_cmp_gt_u32 s81, 0
  s_cbranch_scc1 L_kv0d_128
L_kv0_127:
L_kvr_129:
  v_lshlrev_b32 v12, 3, v1
  v_and_b32 v12, 0xf80, v12
  s_mov_b32 s4, 0
  buffer_load_dword v12, v12, s[48:51], s4 offen sc1
  s_waitcnt vmcnt(0)
  v_cmp_le_u32 vcc, 32, v12
  s_nop 1
  s_not_b32 s4, vcc_lo
  s_ff1_i32_b32 s4, s4
  s_cmp_eq_u32 s4, -1
  s_cselect_b32 s81, 32, s4
  s_cmp_gt_u32 s81, s80
  s_cbranch_scc1 L_kvd_130
  s_sleep 4
  s_add_u32 s47, s47, 1
  s_cmp_gt_u32 s47, 131072
  s_cbranch_scc1 L_exit
  s_branch L_kvr_129
L_kvd_130:
L_kv0d_128:
  s_add_u32 m0, s30, s30
  s_add_u32 m0, m0, 154624
  s_nop 0
  buffer_load_dwordx4 v1, s[48:51], s24 offen sc1 lds
  buffer_load_dwordx4 v1, s[48:51], s24 offen offset:1024 sc1 lds
  s_add_u32 s24, s24, 262144
  s_add_u32 s20, s20, 65536
  s_and_b32 s20, s20, 0x3ffff
  s_add_u32 s71, s20, s77
  s_add_u32 s21, s71, s30
  s_mov_b32 s26, s71
  s_add_u32 s70, s70, 1
  s_add_u32 s22, s21, 4096
  s_lshr_b32 s4, s30, 2
  s_add_u32 s23, s71, s4
  s_add_u32 s23, s23, 8192
  s_add_u32 s73, s4, 147456
  s_xor_b32 s18, s18, s19
  s_mov_b32 s32, s18
  s_add_u32 s33, s18, 32768
  s_add_u32 s34, s18, 65536
  s_add_u32 s35, s18, 98304
  s_add_u32 s36, s18, 131072
  s_add_u32 s37, s18, 163840
  s_add_u32 s38, s18, 196608
  s_add_u32 s39, s18, 229376
  s_add_u32 s40, s18, 262144
  s_xor_b32 s41, s41, s86
  s_xor_b32 s42, s42, s87
  s_add_u32 s25, s25, 262144
  s_add_u32 s4, s70, 1
  s_lshr_b32 s4, s4, 1
  s_min_u32 s80, s4, 31
  s_cmp_lg_u32 s69, 0
  s_cbranch_scc1 L_book_s
  s_branch L_book_f
  .p2align 8
L_common_f:
  s_cmp_eq_u32 s70, 63
  s_cbranch_scc1 L_common_fz
  v_add_u32 v14, s30, v11
  v_add_u32 v15, s73, v9
  v_mov_b32 v13, -1
  s_cmp_ge_u32 s80, s81
  s_cbranch_scc1 L_flslow_f
L_fl_ok_f:
L_pA0_f:
  s_waitcnt vmcnt(0)
  v_cmp_eq_u32 vcc, -1, v24
  s_cbranch_vccnz L_pA0f_f
  ds_write_b128 v14, v[24:27] offset:8192
  buffer_load_dwordx4 v[16:19], v1, s[48:51], s22 offen sc1
  buffer_load_dword v20, v9, s[48:51], s23 offen sc1
L_pAdone_f:
  s_waitcnt lgkmcnt(0)
  s_barrier
  ds_read_b128 v[24:27], v11 offset:8192
  ds_read_b128 v[28:31], v11 offset:9216
  s_waitcnt lgkmcnt(1)
  v_smfmac_f32_16x16x64_bf16 v[56:59], v[24:27], v[72:79], v2
  buffer_store_dword v13, v10, s[48:51], s43 offen
  v_smfmac_f32_16x16x64_bf16 v[48:51], v[24:27], v[32:39], v2
  ds_read_b128 v[32:35], v3 offset:16384
  v_smfmac_f32_16x16x64_bf16 v[60:63], v[24:27], v[80:87], v2
  ds_read_b128 v[36:39], v3 offset:17408
  v_smfmac_f32_16x16x64_bf16 v[64:67], v[24:27], v[88:95], v2
  v_smfmac_f32_16x16x64_bf16 v[52:55], v[24:27], v[40:47], v2
  ds_read_b128 v[40:43], v3 offset:18432
  v_smfmac_f32_16x16x64_bf16 v[68:71], v[24:27], v[96:103], v2
  ds_read_b128 v[44:47], v3 offset:19456
  s_waitcnt lgkmcnt(4)
  v_smfmac_f32_16x16x64_bf16 v[48:51], v[28:31], v[104:111], v2
  ds_read_b128 v[24:27], v11 offset:10240
  v_smfmac_f32_16x16x64_bf16 v[52:55], v[28:31], v[112:119], v2
  buffer_store_dword v13, v1, s[48:51], s41 offen offset:0
  v_smfmac_f32_16x16x64_bf16 v[56:59], v[28:31], v[120:127], v2
  v_smfmac_f32_16x16x64_bf16 v[60:63], v[28:31], v[128:135], v2
  v_smfmac_f32_16x16x64_bf16 v[64:67], v[28:31], v[136:143], v2
  v_smfmac_f32_16x16x64_bf16 v[68:71], v[28:31], v[144:151], v2
  buffer_store_dword v13, v1, s[48:51], s41 offen offset:1024
  buffer_store_dword v13, v1, s[48:51], s42 offen offset:0
  buffer_store_dword v13, v1, s[48:51], s42 offen offset:1024
  s_waitcnt vmcnt(5)
L_chkB_f:
  v_max_u32 v22, v16, v20
  v_cmp_eq_u32 vcc, -1, v22
  s_cbranch_vccnz L_retryB_f
  s_waitcnt lgkmcnt(0)
  v_smfmac_f32_16x16x64_bf16 v[48:51], v[24:27], v[152:159], v2
  ds_write_b128 v14, v[16:19] offset:12288
  v_smfmac_f32_16x16x64_bf16 v[56:59], v[24:27], v[32:39], v2
  ds_write_b32 v15, v20
  v_smfmac_f32_16x16x64_bf16 v[52:55], v[24:27], v[160:167], v2
  ds_read_b128 v[28:31], v11 offset:11264
  v_smfmac_f32_16x16x64_bf16 v[64:67], v[24:27], v[168:175], v2
  ds_read_b128 v[32:35], v3 offset:32768
  v_smfmac_f32_16x16x64_bf16 v[60:63], v[24:27], v[40:47], v2
  ds_read_b128 v[40:43], v3 offset:34816
  v_smfmac_f32_16x16x64_bf16 v[68:71], v[24:27], v[176:183], v2
  ds_read_b128 v[44:47], v3 offset:35840
  ds_read_b128 v[36:39], v3 offset:33792
  s_waitcnt lgkmcnt(5)
  s_barrier
  v_sub_u32 v14, 0, v1
  v_mov_b32 v15, s70
  s_waitcnt lgkmcnt(4)
  v_smfmac_f32_16x16x64_bf16 v[48:51], v[28:31], v[184:191], v2
  ds_read_b128 v[24:27], v11 offset:12288
  s_waitcnt lgkmcnt(1)
  v_smfmac_f32_16x16x64_bf16 v[64:67], v[28:31], v[32:39], v2
  ds_read_b128 v[32:35], v3 offset:49152
  v_smfmac_f32_16x16x64_bf16 v[52:55], v[28:31], v[192:199], v2
  ds_read_b128 v[36:39], v3 offset:50176
  v_smfmac_f32_16x16x64_bf16 v[56:59], v[28:31], v[200:207], v2
  buffer_load_dwordx4 v[16:19], v1, s[48:51], s25 offen sc1
  v_smfmac_f32_16x16x64_bf16 v[68:71], v[28:31], v[40:47], v2
  ds_read_b128 v[40:43], v3 offset:51200
  v_smfmac_f32_16x16x64_bf16 v[60:63], v[28:31], v[208:215], v2
  ds_read_b128 v[44:47], v3 offset:52224
  s_waitcnt lgkmcnt(4)
  v_smfmac_f32_16x16x64_bf16 v[48:51], v[24:27], v[216:223], v2
  ds_read_b128 v[28:31], v11 offset:13312
  v_smfmac_f32_16x16x64_bf16 v[52:55], v[24:27], v[224:231], v2
  buffer_load_dwordx4 v[20:23], v1, s[48:51], s25 offen offset:1024 sc1
  v_smfmac_f32_16x16x64_bf16 v[56:59], v[24:27], v[232:239], v2
  v_smfmac_f32_16x16x64_bf16 v[60:63], v[24:27], v[240:247], v2
  v_smfmac_f32_16x16x64_bf16 v[64:67], v[24:27], v[248:255], v2
  v_smfmac_f32_16x16x64_bf16 v[68:71], v[24:27], a[0:7], v2
  buffer_store_dword v15, v14, s[48:51], s29 offen sc1
  s_waitcnt lgkmcnt(0)
  v_smfmac_f32_16x16x64_bf16 v[56:59], v[28:31], a[8:15], v2
  ds_read_b128 v[24:27], v11 offset:14336
  v_smfmac_f32_16x16x64_bf16 v[48:51], v[28:31], v[32:39], v2
  ds_read_b128 v[32:35], v4 offset:0
  v_smfmac_f32_16x16x64_bf16 v[60:63], v[28:31], a[16:23], v2
  ds_read_b128 v[36:39], v4 offset:1024
  v_smfmac_f32_16x16x64_bf16 v[64:67], v[28:31], a[24:31], v2
  v_smfmac_f32_16x16x64_bf16 v[52:55], v[28:31], v[40:47], v2
  ds_read_b128 v[40:43], v4 offset:2048
  v_smfmac_f32_16x16x64_bf16 v[68:71], v[28:31], a[32:39], v2
  ds_read_b128 v[44:47], v4 offset:3072
  s_waitcnt lgkmcnt(4)
  v_smfmac_f32_16x16x64_bf16 v[48:51], v[24:27], a[40:47], v2
  ds_read_b128 v[28:31], v11 offset:15360
  s_waitcnt lgkmcnt(3)
  v_smfmac_f32_16x16x64_bf16 v[56:59], v[24:27], v[32:39], v2
  ds_read_b128 v[32:35], v4 offset:16384
  v_smfmac_f32_16x16x64_bf16 v[52:55], v[24:27], a[48:55], v2
  ds_read_b128 v[36:39], v4 offset:17408
  v_smfmac_f32_16x16x64_bf16 v[64:67], v[24:27], a[56:63], v2
  s_waitcnt lgkmcnt(3)
  v_smfmac_f32_16x16x64_bf16 v[60:63], v[24:27], v[40:47], v2
  ds_read_b128 v[40:43], v4 offset:18432
  v_smfmac_f32_16x16x64_bf16 v[68:71], v[24:27], a[64:71], v2
  ds_read_b128 v[44:47], v4 offset:19456
  s_waitcnt lgkmcnt(4)
  v_smfmac_f32_16x16x64_bf16 v[48:51], v[28:31], a[72:79], v2
  ds_read_b128 v[24:27], v11 offset:16384
  v_smfmac_f32_16x16x64_bf16 v[56:59], v[28:31], a[88:95], v2
  v_smfmac_f32_16x16x64_bf16 v[52:55], v[28:31], a[80:87], v2
  v_smfmac_f32_16x16x64_bf16 v[60:63], v[28:31], a[96:103], v2
  s_waitcnt lgkmcnt(0)
  v_smfmac_f32_16x16x64_bf16 v[48:51], v[24:27], a[120:127], v2
  v_smfmac_f32_16x16x64_bf16 v[56:59], v[24:27], a[136:143], v2
  v_smfmac_f32_16x16x64_bf16 v[52:55], v[24:27], a[128:135], v2
  v_smfmac_f32_16x16x64_bf16 v[60:63], v[24:27], a[144:151], v2
  v_pk_add_f32 v[48:49], v[48:49], v[50:51]
  v_pk_add_f32 v[56:57], v[56:57], v[58:59]
  v_pk_mul_f32 v[48:49], v[48:49], s[78:79]
  v_cvt_pk_bf16_f32 v56, v56, v57
  v_cvt_pk_bf16_f32 v57, v48, v49
  ds_write_b64 v7, v[56:57]
  v_pk_add_f32 v[52:53], v[52:53], v[54:55]
  v_pk_add_f32 v[60:61], v[60:61], v[62:63]
  v_pk_mul_f32 v[52:53], v[52:53], s[78:79]
  v_cvt_pk_bf16_f32 v58, v60, v61
  v_cvt_pk_bf16_f32 v59, v52, v53
  ds_write_b64 v7, v[58:59] offset:512
  v_smfmac_f32_16x16x64_bf16 v[64:67], v[28:31], a[104:111], v2
  v_smfmac_f32_16x16x64_bf16 v[68:71], v[28:31], a[112:119], v2
  v_smfmac_f32_16x16x64_bf16 v[64:67], v[24:27], v[32:39], v2
  v_smfmac_f32_16x16x64_bf16 v[68:71], v[24:27], v[40:47], v2
  s_waitcnt lgkmcnt(0)
  s_barrier
  ds_read_b64_tr_b16 v[32:33], v6 offset:0
  ds_read_b64_tr_b16 v[34:35], v6 offset:512
  ds_read_b64_tr_b16 v[36:37], v6 offset:1024
  ds_read_b64_tr_b16 v[38:39], v6 offset:1536
  ds_read_b64_tr_b16 v[40:41], v6 offset:2048
  ds_read_b64_tr_b16 v[42:43], v6 offset:2560
  ds_read_b64_tr_b16 v[44:45], v6 offset:3072
  ds_read_b64_tr_b16 v[46:47], v6 offset:3584
  ds_read_b128 v[24:27], v11 offset:23552
  ds_read_b128 v[28:31], v11 offset:24576
  ds_read_b128 v[12:15], v11 offset:25600
  v_pk_add_f32 v[64:65], v[64:65], v[66:67]
  v_pk_add_f32 v[68:69], v[68:69], v[70:71]
  v_cvt_pk_bf16_f32 v57, v64, v65
  v_cvt_pk_bf16_f32 v59, v68, v69
  v_cvt_pk_bf16_f32 v64, v64, v65
  v_cvt_pk_bf16_f32 v66, v68, v69
  v_mov_b32 v65, 0
  v_mov_b32 v67, 0
  s_waitcnt lgkmcnt(3)
  v_mfma_f32_16x16x32_bf16 v[48:51], v[32:35], v[32:35], 0
  v_mov_b32 v68, 0x3f803f80
  v_mfma_f32_16x16x32_bf16 v[48:51], v[36:39], v[36:39], v[48:51]
  v_mov_b32 v69, 0x3f803f80
  buffer_store_dwordx4 v[56:59], v1, s[48:51], s27 offen sc1
  v_mfma_f32_16x16x32_bf16 v[48:51], v[40:43], v[40:43], v[48:51]
  v_mov_b32 v70, 0x3f803f80
  v_mfma_f32_16x16x32_bf16 v[48:51], v[44:47], v[44:47], v[48:51]
  v_mov_b32 v71, 0x3f803f80
  s_waitcnt lgkmcnt(2)
  v_mfma_f32_16x16x32_bf16 v[52:55], v[24:27], v[32:35], 0
  ds_read_b128 v[24:27], v11 offset:26624
  s_waitcnt lgkmcnt(2)
  v_mfma_f32_16x16x32_bf16 v[52:55], v[28:31], v[36:39], v[52:55]
  ds_read_b128 v[28:31], v11 offset:27648
  s_waitcnt lgkmcnt(2)
  v_mfma_f32_16x16x32_bf16 v[52:55], v[12:15], v[40:43], v[52:55]
  ds_read_b128 v[12:15], v11 offset:28672
  s_waitcnt lgkmcnt(2)
  v_mfma_f32_16x16x32_bf16 v[52:55], v[24:27], v[44:47], v[52:55]
  ds_read_b128 v[24:27], v11 offset:29696
  s_waitcnt lgkmcnt(2)
  v_mfma_f32_16x16x32_bf16 v[60:63], v[28:31], v[32:35], 0
  ds_read_b128 v[28:31], v11 offset:30720
  s_waitcnt lgkmcnt(2)
  v_mfma_f32_16x16x32_bf16 v[60:63], v[12:15], v[36:39], v[60:63]
  s_waitcnt lgkmcnt(1)
  v_mfma_f32_16x16x32_bf16 v[60:63], v[24:27], v[40:43], v[60:63]
  s_add_u32 s27, s27, 131072
  s_waitcnt lgkmcnt(0)
  v_mfma_f32_16x16x32_bf16 v[60:63], v[28:31], v[44:47], v[60:63]
  ds_read_b128 v[40:43], v5 offset:0
  ds_read_b128 v[44:47], v5 offset:1024
  v_max3_f32 v24, |v48|, |v49|, |v52|
  v_max3_f32 v25, |v53|, |v54|, |v55|
  s_nop 3
  v_max3_f32 v24, v24, |v60|, |v61|
  v_max3_f32 v25, v25, |v62|, |v63|
  v_max_f32 v24, v24, v25
  v_cmp_ngt_f32 vcc, s83, v24
  s_and_b64 vcc, vcc, s[84:85]
  s_cbranch_scc1 L_tmax_f
L_tmaxr_f:
  v_exp_f32 v48, v48
  v_exp_f32 v49, v49
  v_exp_f32 v52, v52
  v_exp_f32 v53, v53
  v_exp_f32 v54, v54
  v_exp_f32 v55, v55
  v_exp_f32 v60, v60
  v_exp_f32 v61, v61
  v_exp_f32 v62, v62
  v_exp_f32 v63, v63
  v_mov_b32 v33, 0
  v_cvt_pk_bf16_f32 v32, v48, v49
  v_cvt_pk_bf16_f32 v36, v52, v53
  v_cvt_pk_bf16_f32 v37, v54, v55
  v_cvt_pk_bf16_f32 v38, v60, v61
  v_cvt_pk_bf16_f32 v39, v62, v63
  s_waitcnt vmcnt(2)
  s_nop 0
  v_mfma_f32_16x16x32_bf16 v[28:31], v[68:71], v[36:39], 0
  v_mfma_f32_16x16x32_bf16 v[48:51], v[16:19], v[36:39], 0
  ds_read_b128 v[56:59], v5 offset:8192
  v_mfma_f32_16x16x32_bf16 v[52:55], v[20:23], v[36:39], 0
  ds_read_b128 v[60:63], v5 offset:9216
  v_mfma_f32_16x16x16_bf16 v[28:31], v[68:69], v[32:33], v[28:31]
  v_mfma_f32_16x16x16_bf16 v[48:51], v[64:65], v[32:33], v[48:51]
  v_mfma_f32_16x16x16_bf16 v[52:55], v[66:67], v[32:33], v[52:55]
  v_mov_b64 v[12:13], 0
  v_mov_b64 v[14:15], 0
  v_mov_b64 v[16:17], 0
  v_mov_b64 v[18:19], 0
  s_nop 1
  v_rcp_f32 v24, v28
  v_mov_b64 v[20:21], 0
  v_pk_mul_f32 v[48:49], v[48:49], v[24:25] op_sel_hi:[1,0]
  v_pk_mul_f32 v[50:51], v[50:51], v[24:25] op_sel_hi:[1,0]
  v_pk_mul_f32 v[52:53], v[52:53], v[24:25] op_sel_hi:[1,0]
  v_pk_mul_f32 v[54:55], v[54:55], v[24:25] op_sel_hi:[1,0]
  v_cvt_pk_bf16_f32 v48, v48, v49
  v_cvt_pk_bf16_f32 v49, v50, v51
  ds_write_b64 v8, v[48:49]
  v_cvt_pk_bf16_f32 v52, v52, v53
  v_cvt_pk_bf16_f32 v53, v54, v55
  ds_write_b64 v8, v[52:53] offset:512
  v_mov_b64 v[22:23], 0
  v_mov_b64 v[24:25], 0
  v_mov_b64 v[26:27], 0
  v_mov_b64 v[28:29], 0
  v_mov_b64 v[30:31], 0
  v_mov_b64 v[64:65], 0
  v_mov_b64 v[66:67], 0
  v_mov_b64 v[68:69], 0
  v_mov_b64 v[70:71], 0
  s_add_u32 m0, s30, s30
  s_add_u32 m0, m0, 154624
  s_waitcnt lgkmcnt(0)
  s_barrier
  ds_read_b128 v[32:35], v11 offset:21504
  ds_read_b128 v[36:39], v11 offset:22528
  buffer_load_dwordx4 v1, s[48:51], s24 offen sc1 lds
  buffer_load_dwordx4 v1, s[48:51], s24 offen offset:1024 sc1 lds
  v_mov_b64 v[48:49], 0
  v_mov_b64 v[50:51], 0
  v_mov_b64 v[52:53], 0
  v_mov_b64 v[54:55], 0
  s_add_u32 s24, s24, 262144
  s_waitcnt lgkmcnt(0)
  v_smfmac_f32_16x16x64_bf16 v[16:19], v[32:35], a[152:159], v2
  v_smfmac_f32_16x16x64_bf16 v[16:19], v[36:39], a[160:167], v2
  v_smfmac_f32_16x16x64_bf16 v[20:23], v[32:35], a[168:175], v2
  v_smfmac_f32_16x16x64_bf16 v[20:23], v[36:39], v[40:47], v2
  ds_read_b128 v[40:43], v5 offset:16384
  v_pk_add_f32 v[16:17], v[16:17], v[18:19]
  v_cvt_pk_bf16_f32 v16, v16, v17
  v_smfmac_f32_16x16x64_bf16 v[24:27], v[32:35], a[176:183], v2
  buffer_store_dword v16, v9, s[48:51], s32 offen
  v_smfmac_f32_16x16x64_bf16 v[24:27], v[36:39], a[184:191], v2
  ds_read_b128 v[44:47], v5 offset:17408
  v_pk_add_f32 v[20:21], v[20:21], v[22:23]
  v_cvt_pk_bf16_f32 v20, v20, v21
  v_smfmac_f32_16x16x64_bf16 v[28:31], v[32:35], a[192:199], v2
  buffer_store_dword v20, v9, s[48:51], s33 offen
  v_smfmac_f32_16x16x64_bf16 v[28:31], v[36:39], v[56:63], v2
  ds_read_b128 v[56:59], v5 offset:24576
  v_pk_add_f32 v[24:25], v[24:25], v[26:27]
  v_cvt_pk_bf16_f32 v24, v24, v25
  v_smfmac_f32_16x16x64_bf16 v[68:71], v[32:35], a[200:207], v2
  buffer_store_dword v24, v9, s[48:51], s34 offen
  v_smfmac_f32_16x16x64_bf16 v[68:71], v[36:39], a[208:215], v2
  ds_read_b128 v[60:63], v5 offset:25600
  v_pk_add_f32 v[28:29], v[28:29], v[30:31]
  v_cvt_pk_bf16_f32 v28, v28, v29
  v_smfmac_f32_16x16x64_bf16 v[64:67], v[32:35], a[216:223], v2
  buffer_store_dword v28, v9, s[48:51], s35 offen
  s_waitcnt lgkmcnt(2)
  v_smfmac_f32_16x16x64_bf16 v[64:67], v[36:39], v[40:47], v2
  ds_read_b128 v[40:43], v5 offset:32768
  v_pk_add_f32 v[68:69], v[68:69], v[70:71]
  v_cvt_pk_bf16_f32 v68, v68, v69
  v_smfmac_f32_16x16x64_bf16 v[12:15], v[32:35], a[224:231], v2
  buffer_store_dword v68, v9, s[48:51], s36 offen
  v_smfmac_f32_16x16x64_bf16 v[12:15], v[36:39], a[232:239], v2
  ds_read_b128 v[44:47], v5 offset:33792
  v_pk_add_f32 v[64:65], v[64:65], v[66:67]
  v_cvt_pk_bf16_f32 v64, v64, v65
  v_smfmac_f32_16x16x64_bf16 v[48:51], v[32:35], a[240:247], v2
  buffer_store_dword v64, v9, s[48:51], s37 offen
  s_waitcnt lgkmcnt(2)
  v_smfmac_f32_16x16x64_bf16 v[48:51], v[36:39], v[56:63], v2
  v_pk_add_f32 v[12:13], v[12:13], v[14:15]
  v_cvt_pk_bf16_f32 v12, v12, v13
  v_smfmac_f32_16x16x64_bf16 v[52:55], v[32:35], a[248:255], v2
  s_waitcnt lgkmcnt(0)
  v_smfmac_f32_16x16x64_bf16 v[52:55], v[36:39], v[40:47], v2
  buffer_store_dword v12, v9, s[48:51], s38 offen
  v_pk_add_f32 v[48:49], v[48:49], v[50:51]
  v_cvt_pk_bf16_f32 v48, v48, v49
  buffer_store_dword v48, v9, s[48:51], s39 offen
  s_nop 5
  v_pk_add_f32 v[52:53], v[52:53], v[54:55]
  v_cvt_pk_bf16_f32 v52, v52, v53
  buffer_store_dword v52, v9, s[48:51], s40 offen
  s_cmp_eq_u32 s75, -1
  s_cbranch_scc1 L_nonred_f
  ds_read_b128 v[68:71], v11 offset:31744
  s_add_u32 s72, s16, 4096
  s_waitcnt vmcnt(7)
  s_cmp_lt_u32 s75, 16
  s_cbranch_scc1 L_poll1_f
  s_waitcnt vmcnt(3)
  s_cmp_lt_u32 s75, 20
  s_cbranch_scc1 L_poll1_f
  s_waitcnt vmcnt(0)
L_poll1_f:
  buffer_load_dwordx4 v[16:19], v1, s[48:51], s16 offen offset:0 sc1
  buffer_load_dwordx4 v[20:23], v1, s[48:51], s16 offen offset:1024 sc1
  buffer_load_dwordx4 v[24:27], v1, s[48:51], s16 offen offset:2048 sc1
  buffer_load_dwordx4 v[28:31], v1, s[48:51], s16 offen offset:3072 sc1
  buffer_load_dwordx4 v[32:35], v1, s[48:51], s72 offen offset:0 sc1
  buffer_load_dwordx4 v[36:39], v1, s[48:51], s72 offen offset:1024 sc1
  buffer_load_dwordx4 v[40:43], v1, s[48:51], s72 offen offset:2048 sc1
  buffer_load_dwordx4 v[44:47], v1, s[48:51], s72 offen offset:3072 sc1
  s_add_u32 s20, s20, 65536
  s_and_b32 s20, s20, 0x3ffff
  s_add_u32 s71, s20, s77
  s_add_u32 s21, s71, s30
  s_mov_b32 s26, s71
  s_add_u32 s70, s70, 1
  s_add_u32 s22, s21, 4096
  s_lshr_b32 s4, s30, 2
  s_add_u32 s23, s71, s4
  s_add_u32 s23, s23, 8192
  s_add_u32 s73, s4, 147456
  s_xor_b32 s18, s18, s19
  s_mov_b32 s32, s18
  s_add_u32 s33, s18, 32768
  s_add_u32 s34, s18, 65536
  s_add_u32 s35, s18, 98304
  s_add_u32 s36, s18, 131072
  s_add_u32 s37, s18, 163840
  s_add_u32 s38, s18, 196608
  s_add_u32 s39, s18, 229376
  s_add_u32 s40, s18, 262144
  s_xor_b32 s41, s41, s86
  s_xor_b32 s42, s42, s87
  s_add_u32 s25, s25, 262144
  s_add_u32 s4, s70, 1
  s_lshr_b32 s4, s4, 1
  s_min_u32 s80, s4, 31
  s_add_u32 s5, s20, 655360
  s_add_u32 s6, s5, 18944
  s_xor_b32 s4, s20, 0x20000
  s_add_u32 s43, s4, 655360
  s_add_u32 s31, s43, 18944
  v_mov_b64 v[48:49], 0
  v_mov_b64 v[50:51], 0
  v_mov_b64 v[52:53], 0
  v_mov_b64 v[54:55], 0
  v_mov_b64 v[56:57], 0
  v_mov_b64 v[58:59], 0
  v_mov_b64 v[60:61], 0
  v_mov_b64 v[62:63], 0
  v_mov_b32 v13, -1
  s_waitcnt lgkmcnt(0)
L_w1_f:
  s_waitcnt vmcnt(7)
  v_mfma_f32_16x16x32_bf16 v[64:67], v[16:19], v[68:71], 0
  s_waitcnt vmcnt(6)
  v_mfma_f32_16x16x32_bf16 v[64:67], v[20:23], v[68:71], v[64:67]
  s_waitcnt vmcnt(5)
  v_mfma_f32_16x16x32_bf16 v[64:67], v[24:27], v[68:71], v[64:67]
  v_max3_u32 v12, v16, v20, v24
  s_waitcnt vmcnt(4)
  v_mfma_f32_16x16x32_bf16 v[64:67], v[28:31], v[68:71], v[64:67]
  s_waitcnt vmcnt(3)
  v_mfma_f32_16x16x32_bf16 v[64:67], v[32:35], v[68:71], v[64:67]
  v_max3_u32 v12, v28, v32, v12
  s_waitcnt vmcnt(2)
  v_mfma_f32_16x16x32_bf16 v[64:67], v[36:39], v[68:71], v[64:67]
  s_waitcnt vmcnt(1)
  v_mfma_f32_16x16x32_bf16 v[64:67], v[40:43], v[68:71], v[64:67]
  v_max3_u32 v12, v36, v40, v12
  s_waitcnt vmcnt(0)
  v_mfma_f32_16x16x32_bf16 v[64:67], v[44:47], v[68:71], v[64:67]
  v_max_u32 v12, v12, v44
  v_cmp_eq_u32 vcc, -1, v12
  s_cbranch_vccnz L_retry1_f
  s_xor_b32 s16, s16, s17
  s_nop 3
  v_cvt_pk_bf16_f32 v64, v64, v65
  v_cvt_pk_bf16_f32 v65, v66, v67
  buffer_store_dwordx2 v[64:65], v10, s[48:51], s5 offen
  buffer_load_dwordx4 v[24:27], v1, s[48:51], s21 offen sc1
  ds_read_b128 v[32:35], v3 offset:0
  ds_read_b128 v[36:39], v3 offset:1024
  ds_read_b128 v[40:43], v3 offset:2048
  ds_read_b128 v[44:47], v3 offset:3072
  v_mov_b64 v[64:65], 0
  v_mov_b64 v[66:67], 0
  v_mov_b64 v[68:69], 0
  v_mov_b64 v[70:71], 0
  s_branch L_common_f
L_nonred_f:
  s_add_u32 s20, s20, 65536
  s_and_b32 s20, s20, 0x3ffff
  s_add_u32 s71, s20, s77
  s_add_u32 s21, s71, s30
  s_mov_b32 s26, s71
  s_add_u32 s70, s70, 1
  s_add_u32 s22, s21, 4096
  s_lshr_b32 s4, s30, 2
  s_add_u32 s23, s71, s4
  s_add_u32 s23, s23, 8192
  s_add_u32 s73, s4, 147456
  s_xor_b32 s18, s18, s19
  s_mov_b32 s32, s18
  s_add_u32 s33, s18, 32768
  s_add_u32 s34, s18, 65536
  s_add_u32 s35, s18, 98304
  s_add_u32 s36, s18, 131072
  s_add_u32 s37, s18, 163840
  s_add_u32 s38, s18, 196608
  s_add_u32 s39, s18, 229376
  s_add_u32 s40, s18, 262144
  s_xor_b32 s41, s41, s86
  s_xor_b32 s42, s42, s87
  s_add_u32 s25, s25, 262144
  s_add_u32 s4, s70, 1
  s_lshr_b32 s4, s4, 1
  s_min_u32 s80, s4, 31
L_book_f:
  v_mov_b64 v[48:49], 0
  v_mov_b64 v[50:51], 0
  v_mov_b64 v[52:53], 0
  v_mov_b64 v[54:55], 0
  v_mov_b64 v[56:57], 0
  v_mov_b64 v[58:59], 0
  v_mov_b64 v[60:61], 0
  v_mov_b64 v[62:63], 0
  v_mov_b64 v[64:65], 0
  v_mov_b64 v[66:67], 0
  v_mov_b64 v[68:69], 0
  v_mov_b64 v[70:71], 0
  ds_read_b128 v[32:35], v3 offset:0
  ds_read_b128 v[36:39], v3 offset:1024
  ds_read_b128 v[40:43], v3 offset:2048
  ds_read_b128 v[44:47], v3 offset:3072
  buffer_load_dwordx4 v[24:27], v1, s[48:51], s21 offen sc1
  s_branch L_common_f
L_common_fz:
  v_add_u32 v14, s30, v11
  v_add_u32 v15, s73, v9
  v_mov_b32 v13, -1
  s_cmp_ge_u32 s80, s81
  s_cbranch_scc1 L_flslow_fz
L_fl_ok_fz:
L_pA0_fz:
  s_waitcnt vmcnt(0)
  v_cmp_eq_u32 vcc, -1, v24
  s_cbranch_vccnz L_pA0f_fz
  ds_write_b128 v14, v[24:27] offset:8192
  buffer_load_dwordx4 v[16:19], v1, s[48:51], s22 offen sc1
  buffer_load_dword v20, v9, s[48:51], s23 offen sc1
L_pAdone_fz:
  s_waitcnt lgkmcnt(0)
  s_barrier
  ds_read_b128 v[24:27], v11 offset:8192
  ds_read_b128 v[28:31], v11 offset:9216
  s_waitcnt lgkmcnt(1)
  v_smfmac_f32_16x16x64_bf16 v[56:59], v[24:27], v[72:79], v2
  v_smfmac_f32_16x16x64_bf16 v[60:63], v[24:27], v[80:87], v2
  v_smfmac_f32_16x16x64_bf16 v[64:67], v[24:27], v[88:95], v2
  v_smfmac_f32_16x16x64_bf16 v[68:71], v[24:27], v[96:103], v2
  s_waitcnt lgkmcnt(0)
  v_smfmac_f32_16x16x64_bf16 v[56:59], v[28:31], v[120:127], v2
  ds_read_b128 v[24:27], v11 offset:10240
  v_smfmac_f32_16x16x64_bf16 v[60:63], v[28:31], v[128:135], v2
  ds_read_b128 v[40:43], v3 offset:18432
  v_smfmac_f32_16x16x64_bf16 v[64:67], v[28:31], v[136:143], v2
  ds_read_b128 v[44:47], v3 offset:19456
  v_smfmac_f32_16x16x64_bf16 v[68:71], v[28:31], v[144:151], v2
  ds_read_b128 v[32:35], v3 offset:16384
  ds_read_b128 v[36:39], v3 offset:17408
  s_waitcnt vmcnt(0)
L_chkB_fz:
  v_max_u32 v22, v16, v20
  v_cmp_eq_u32 vcc, -1, v22
  s_cbranch_vccnz L_retryB_fz
  s_waitcnt lgkmcnt(4)
  v_smfmac_f32_16x16x64_bf16 v[64:67], v[24:27], v[168:175], v2
  ds_write_b128 v14, v[16:19] offset:12288
  s_waitcnt lgkmcnt(1)
  v_smfmac_f32_16x16x64_bf16 v[56:59], v[24:27], v[32:39], v2
  ds_write_b32 v15, v20
  v_smfmac_f32_16x16x64_bf16 v[68:71], v[24:27], v[176:183], v2
  ds_read_b128 v[28:31], v11 offset:11264
  v_smfmac_f32_16x16x64_bf16 v[60:63], v[24:27], v[40:47], v2
  ds_read_b128 v[40:43], v3 offset:34816
  ds_read_b128 v[44:47], v3 offset:35840
  ds_read_b128 v[32:35], v3 offset:32768
  ds_read_b128 v[36:39], v3 offset:33792
  s_waitcnt lgkmcnt(5)
  s_barrier
  v_sub_u32 v14, 0, v1
  v_mov_b32 v15, s70
  s_waitcnt lgkmcnt(4)
  v_smfmac_f32_16x16x64_bf16 v[56:59], v[28:31], v[200:207], v2
  ds_read_b128 v[24:27], v11 offset:12288
  s_waitcnt lgkmcnt(1)
  v_smfmac_f32_16x16x64_bf16 v[64:67], v[28:31], v[32:39], v2
  ds_read_b128 v[32:35], v4 offset:0
  v_smfmac_f32_16x16x64_bf16 v[60:63], v[28:31], v[208:215], v2
  ds_read_b128 v[36:39], v4 offset:1024
  v_smfmac_f32_16x16x64_bf16 v[68:71], v[28:31], v[40:47], v2
  ds_read_b128 v[40:43], v4 offset:2048
  s_waitcnt lgkmcnt(3)
  v_smfmac_f32_16x16x64_bf16 v[56:59], v[24:27], v[232:239], v2
  ds_read_b128 v[28:31], v11 offset:13312
  v_smfmac_f32_16x16x64_bf16 v[60:63], v[24:27], v[240:247], v2
  ds_read_b128 v[44:47], v4 offset:3072
  v_smfmac_f32_16x16x64_bf16 v[64:67], v[24:27], v[248:255], v2
  buffer_store_dword v15, v14, s[48:51], s29 offen sc1
  v_smfmac_f32_16x16x64_bf16 v[68:71], v[24:27], a[0:7], v2
  s_waitcnt lgkmcnt(1)
  v_smfmac_f32_16x16x64_bf16 v[56:59], v[28:31], a[8:15], v2
  ds_read_b128 v[24:27], v11 offset:14336
  v_smfmac_f32_16x16x64_bf16 v[60:63], v[28:31], a[16:23], v2
  v_smfmac_f32_16x16x64_bf16 v[64:67], v[28:31], a[24:31], v2
  v_smfmac_f32_16x16x64_bf16 v[68:71], v[28:31], a[32:39], v2
  s_waitcnt lgkmcnt(0)
  v_smfmac_f32_16x16x64_bf16 v[64:67], v[24:27], a[56:63], v2
  ds_read_b128 v[28:31], v11 offset:15360
  v_smfmac_f32_16x16x64_bf16 v[56:59], v[24:27], v[32:39], v2
  ds_read_b128 v[32:35], v4 offset:16384
  v_smfmac_f32_16x16x64_bf16 v[68:71], v[24:27], a[64:71], v2
  ds_read_b128 v[36:39], v4 offset:17408
  v_smfmac_f32_16x16x64_bf16 v[60:63], v[24:27], v[40:47], v2
  ds_read_b128 v[40:43], v4 offset:18432
  s_waitcnt lgkmcnt(3)
  v_smfmac_f32_16x16x64_bf16 v[56:59], v[28:31], a[88:95], v2
  ds_read_b128 v[24:27], v11 offset:16384
  v_smfmac_f32_16x16x64_bf16 v[60:63], v[28:31], a[96:103], v2
  ds_read_b128 v[44:47], v4 offset:19456
  s_waitcnt lgkmcnt(1)
  v_smfmac_f32_16x16x64_bf16 v[56:59], v[24:27], a[136:143], v2
  v_smfmac_f32_16x16x64_bf16 v[60:63], v[24:27], a[144:151], v2
  v_smfmac_f32_16x16x64_bf16 v[64:67], v[28:31], a[104:111], v2
  v_smfmac_f32_16x16x64_bf16 v[68:71], v[28:31], a[112:119], v2
  s_nop 1
  s_waitcnt lgkmcnt(0)
  v_smfmac_f32_16x16x64_bf16 v[64:67], v[24:27], v[32:39], v2
  v_smfmac_f32_16x16x64_bf16 v[68:71], v[24:27], v[40:47], v2
  s_nop 7
  v_pk_add_f32 v[56:57], v[56:57], v[58:59]
  v_pk_add_f32 v[60:61], v[60:61], v[62:63]
  v_cvt_pk_bf16_f32 v56, v56, v57
  v_cvt_pk_bf16_f32 v58, v60, v61
  v_pk_add_f32 v[64:65], v[64:65], v[66:67]
  v_pk_add_f32 v[68:69], v[68:69], v[70:71]
  v_cvt_pk_bf16_f32 v57, v64, v65
  v_cvt_pk_bf16_f32 v59, v68, v69
  buffer_store_dwordx4 v[56:59], v1, s[48:51], s27 offen sc1
  s_branch L_chain_last
L_pA0f_f:
  s_add_u32 s47, s47, 1
  s_cmp_gt_u32 s47, 131072
  s_cbranch_scc1 L_exit
  buffer_load_dwordx4 v[24:27], v1, s[48:51], s21 offen sc1
  s_branch L_pA0_f
L_retryB_f:
  s_add_u32 s47, s47, 1
  s_cmp_gt_u32 s47, 131072
  s_cbranch_scc1 L_exit
  buffer_load_dwordx4 v[16:19], v1, s[48:51], s22 offen sc1
  buffer_load_dword v20, v9, s[48:51], s23 offen sc1
  s_waitcnt vmcnt(0)
  s_branch L_chkB_f
L_flslow_f:
L_kvr_131:
  v_lshlrev_b32 v22, 3, v1
  v_and_b32 v22, 0xf80, v22
  s_mov_b32 s4, 0
  buffer_load_dword v22, v22, s[48:51], s4 offen sc1
  s_waitcnt vmcnt(0)
  v_cmp_le_u32 vcc, 32, v22
  s_nop 1
  s_not_b32 s4, vcc_lo
  s_ff1_i32_b32 s4, s4
  s_cmp_eq_u32 s4, -1
  s_cselect_b32 s81, 32, s4
  s_cmp_gt_u32 s81, s80
  s_cbranch_scc1 L_kvd_132
  s_sleep 4
  s_add_u32 s47, s47, 1
  s_cmp_gt_u32 s47, 131072
  s_cbranch_scc1 L_exit
  s_branch L_kvr_131
L_kvd_132:
  s_branch L_fl_ok_f
L_tmax_f:
  v_max3_f32 v24, v48, v49, v52
  v_max3_f32 v25, v53, v54, v55
  v_max3_f32 v24, v24, v60, v61
  v_max3_f32 v25, v25, v62, v63
  v_max_f32 v24, v24, v25
  v_mov_b32 v25, v24
  s_nop 1
  v_permlane16_swap_b32 v24, v25
  s_nop 0
  v_max_f32 v24, v24, v25
  v_mov_b32 v25, v24
  s_nop 1
  v_permlane32_swap_b32 v24, v25
  s_nop 0
  v_max_f32 v24, v24, v25
  v_pk_add_f32 v[48:49], v[48:49], v[24:25] op_sel_hi:[1,0] neg_lo:[0,1] neg_hi:[0,1]
  v_pk_add_f32 v[52:53], v[52:53], v[24:25] op_sel_hi:[1,0] neg_lo:[0,1] neg_hi:[0,1]
  v_pk_add_f32 v[54:55], v[54:55], v[24:25] op_sel_hi:[1,0] neg_lo:[0,1] neg_hi:[0,1]
  v_pk_add_f32 v[60:61], v[60:61], v[24:25] op_sel_hi:[1,0] neg_lo:[0,1] neg_hi:[0,1]
  v_pk_add_f32 v[62:63], v[62:63], v[24:25] op_sel_hi:[1,0] neg_lo:[0,1] neg_hi:[0,1]
  s_branch L_tmaxr_f
L_retry1_f:
  s_add_u32 s47, s47, 1
  s_cmp_gt_u32 s47, 131072
  s_cbranch_scc1 L_exit
  buffer_load_dwordx4 v[16:19], v1, s[48:51], s16 offen offset:0 sc1
  buffer_load_dwordx4 v[20:23], v1, s[48:51], s16 offen offset:1024 sc1
  buffer_load_dwordx4 v[24:27], v1, s[48:51], s16 offen offset:2048 sc1
  buffer_load_dwordx4 v[28:31], v1, s[48:51], s16 offen offset:3072 sc1
  buffer_load_dwordx4 v[32:35], v1, s[48:51], s72 offen offset:0 sc1
  buffer_load_dwordx4 v[36:39], v1, s[48:51], s72 offen offset:1024 sc1
  buffer_load_dwordx4 v[40:43], v1, s[48:51], s72 offen offset:2048 sc1
  buffer_load_dwordx4 v[44:47], v1, s[48:51], s72 offen offset:3072 sc1
  s_branch L_w1_f
L_pA0f_fz:
  s_add_u32 s47, s47, 1
  s_cmp_gt_u32 s47, 131072
  s_cbranch_scc1 L_exit
  buffer_load_dwordx4 v[24:27], v1, s[48:51], s21 offen sc1
  s_branch L_pA0_fz
L_retryB_fz:
  s_add_u32 s47, s47, 1
  s_cmp_gt_u32 s47, 131072
  s_cbranch_scc1 L_exit
  buffer_load_dwordx4 v[16:19], v1, s[48:51], s22 offen sc1
  buffer_load_dword v20, v9, s[48:51], s23 offen sc1
  s_waitcnt vmcnt(0)
  s_branch L_chkB_fz
L_flslow_fz:
L_kvr_133:
  v_lshlrev_b32 v22, 3, v1
  v_and_b32 v22, 0xf80, v22
  s_mov_b32 s4, 0
  buffer_load_dword v22, v22, s[48:51], s4 offen sc1
  s_waitcnt vmcnt(0)
  v_cmp_le_u32 vcc, 32, v22
  s_nop 1
  s_not_b32 s4, vcc_lo
  s_ff1_i32_b32 s4, s4
  s_cmp_eq_u32 s4, -1
  s_cselect_b32 s81, 32, s4
  s_cmp_gt_u32 s81, s80
  s_cbranch_scc1 L_kvd_134
  s_sleep 4
  s_add_u32 s47, s47, 1
  s_cmp_gt_u32 s47, 131072
  s_cbranch_scc1 L_exit
  s_branch L_kvr_133
L_kvd_134:
  s_branch L_fl_ok_fz
  .p2align 8
L_common_s:
  s_cmp_eq_u32 s70, 63
  s_cbranch_scc1 L_common_sz
  v_add_u32 v14, s30, v11
  v_add_u32 v15, s73, v9
  v_mov_b32 v13, -1
  s_cmp_ge_u32 s80, s81
  s_cbranch_scc1 L_flslow_s
L_fl_ok_s:
L_pA0_s:
  s_waitcnt vmcnt(0)
  v_cmp_eq_u32 vcc, -1, v24
  s_cbranch_vccnz L_pA0f_s
  ds_write_b128 v14, v[24:27] offset:8192
  buffer_load_dwordx4 v[16:19], v1, s[48:51], s22 offen sc1
  buffer_load_dword v20, v9, s[48:51], s23 offen sc1
L_pAdone_s:
  s_waitcnt lgkmcnt(0)
  s_barrier
  ds_read_b128 v[24:27], v11 offset:8192
  ds_read_b128 v[28:31], v11 offset:9216
  s_waitcnt lgkmcnt(1)
  v_smfmac_f32_16x16x64_bf16 v[56:59], v[24:27], v[72:79], v2
  buffer_store_dword v13, v10, s[48:51], s43 offen sc1
  v_smfmac_f32_16x16x64_bf16 v[48:51], v[24:27], v[32:39], v2
  ds_read_b128 v[32:35], v3 offset:16384
  v_smfmac_f32_16x16x64_bf16 v[60:63], v[24:27], v[80:87], v2
  ds_read_b128 v[36:39], v3 offset:17408
  v_smfmac_f32_16x16x64_bf16 v[64:67], v[24:27], v[88:95], v2
  v_smfmac_f32_16x16x64_bf16 v[52:55], v[24:27], v[40:47], v2
  ds_read_b128 v[40:43], v3 offset:18432
  v_smfmac_f32_16x16x64_bf16 v[68:71], v[24:27], v[96:103], v2
  ds_read_b128 v[44:47], v3 offset:19456
  s_waitcnt lgkmcnt(4)
  v_smfmac_f32_16x16x64_bf16 v[48:51], v[28:31], v[104:111], v2
  ds_read_b128 v[24:27], v11 offset:10240
  v_smfmac_f32_16x16x64_bf16 v[52:55], v[28:31], v[112:119], v2
  buffer_store_dword v13, v1, s[48:51], s41 offen offset:0 sc1
  v_smfmac_f32_16x16x64_bf16 v[56:59], v[28:31], v[120:127], v2
  v_smfmac_f32_16x16x64_bf16 v[60:63], v[28:31], v[128:135], v2
  v_smfmac_f32_16x16x64_bf16 v[64:67], v[28:31], v[136:143], v2
  v_smfmac_f32_16x16x64_bf16 v[68:71], v[28:31], v[144:151], v2
  buffer_store_dword v13, v1, s[48:51], s41 offen offset:1024 sc1
  buffer_store_dword v13, v1, s[48:51], s42 offen offset:0 sc1
  buffer_store_dword v13, v1, s[48:51], s42 offen offset:1024 sc1
  s_waitcnt vmcnt(5)
L_chkB_s:
  v_max_u32 v22, v16, v20
  v_cmp_eq_u32 vcc, -1, v22
  s_cbranch_vccnz L_retryB_s
  s_waitcnt lgkmcnt(0)
  v_smfmac_f32_16x16x64_bf16 v[48:51], v[24:27], v[152:159], v2
  ds_write_b128 v14, v[16:19] offset:12288
  v_smfmac_f32_16x16x64_bf16 v[56:59], v[24:27], v[32:39], v2
  ds_write_b32 v15, v20
  v_smfmac_f32_16x16x64_bf16 v[52:55], v[24:27], v[160:167], v2
  ds_read_b128 v[28:31], v11 offset:11264
  v_smfmac_f32_16x16x64_bf16 v[64:67], v[24:27], v[168:175], v2
  ds_read_b128 v[32:35], v3 offset:32768
  v_smfmac_f32_16x16x64_bf16 v[60:63], v[24:27], v[40:47], v2
  ds_read_b128 v[40:43], v3 offset:34816
  v_smfmac_f32_16x16x64_bf16 v[68:71], v[24:27], v[176:183], v2
  ds_read_b128 v[44:47], v3 offset:35840
  ds_read_b128 v[36:39], v3 offset:33792
  s_waitcnt lgkmcnt(5)
  s_barrier
  v_sub_u32 v14, 0, v1
  v_mov_b32 v15, s70
  s_waitcnt lgkmcnt(4)
  v_smfmac_f32_16x16x64_bf16 v[48:51], v[28:31], v[184:191], v2
  ds_read_b128 v[24:27], v11 offset:12288
  s_waitcnt lgkmcnt(1)
  v_smfmac_f32_16x16x64_bf16 v[64:67], v[28:31], v[32:39], v2
  ds_read_b128 v[32:35], v3 offset:49152
  v_smfmac_f32_16x16x64_bf16 v[52:55], v[28:31], v[192:199], v2
  ds_read_b128 v[36:39], v3 offset:50176
  v_smfmac_f32_16x16x64_bf16 v[56:59], v[28:31], v[200:207], v2
  buffer_load_dwordx4 v[16:19], v1, s[48:51], s25 offen sc1
  v_smfmac_f32_16x16x64_bf16 v[68:71], v[28:31], v[40:47], v2
  ds_read_b128 v[40:43], v3 offset:51200
  v_smfmac_f32_16x16x64_bf16 v[60:63], v[28:31], v[208:215], v2
  ds_read_b128 v[44:47], v3 offset:52224
  s_waitcnt lgkmcnt(4)
  v_smfmac_f32_16x16x64_bf16 v[48:51], v[24:27], v[216:223], v2
  ds_read_b128 v[28:31], v11 offset:13312
  v_smfmac_f32_16x16x64_bf16 v[52:55], v[24:27], v[224:231], v2
  buffer_load_dwordx4 v[20:23], v1, s[48:51], s25 offen offset:1024 sc1
  v_smfmac_f32_16x16x64_bf16 v[56:59], v[24:27], v[232:239], v2
  v_smfmac_f32_16x16x64_bf16 v[60:63], v[24:27], v[240:247], v2
  v_smfmac_f32_16x16x64_bf16 v[64:67], v[24:27], v[248:255], v2
  v_smfmac_f32_16x16x64_bf16 v[68:71], v[24:27], a[0:7], v2
  buffer_store_dword v15, v14, s[48:51], s29 offen sc1
  s_waitcnt lgkmcnt(0)
  v_smfmac_f32_16x16x64_bf16 v[56:59], v[28:31], a[8:15], v2
  ds_read_b128 v[24:27], v11 offset:14336
  v_smfmac_f32_16x16x64_bf16 v[48:51], v[28:31], v[32:39], v2
  ds_read_b128 v[32:35], v4 offset:0
  v_smfmac_f32_16x16x64_bf16 v[60:63], v[28:31], a[16:23], v2
  ds_read_b128 v[36:39], v4 offset:1024
  v_smfmac_f32_16x16x64_bf16 v[64:67], v[28:31], a[24:31], v2
  v_smfmac_f32_16x16x64_bf16 v[52:55], v[28:31], v[40:47], v2
  ds_read_b128 v[40:43], v4 offset:2048
  v_smfmac_f32_16x16x64_bf16 v[68:71], v[28:31], a[32:39], v2
  ds_read_b128 v[44:47], v4 offset:3072
  s_waitcnt lgkmcnt(4)
  v_smfmac_f32_16x16x64_bf16 v[48:51], v[24:27], a[40:47], v2
  ds_read_b128 v[28:31], v11 offset:15360
  s_waitcnt lgkmcnt(3)
  v_smfmac_f32_16x16x64_bf16 v[56:59], v[24:27], v[32:39], v2
  ds_read_b128 v[32:35], v4 offset:16384
  v_smfmac_f32_16x16x64_bf16 v[52:55], v[24:27], a[48:55], v2
  ds_read_b128 v[36:39], v4 offset:17408
  v_smfmac_f32_16x16x64_bf16 v[64:67], v[24:27], a[56:63], v2
  s_waitcnt lgkmcnt(3)
  v_smfmac_f32_16x16x64_bf16 v[60:63], v[24:27], v[40:47], v2
  ds_read_b128 v[40:43], v4 offset:18432
  v_smfmac_f32_16x16x64_bf16 v[68:71], v[24:27], a[64:71], v2
  ds_read_b128 v[44:47], v4 offset:19456
  s_waitcnt lgkmcnt(4)
  v_smfmac_f32_16x16x64_bf16 v[48:51], v[28:31], a[72:79], v2
  ds_read_b128 v[24:27], v11 offset:16384
  v_smfmac_f32_16x16x64_bf16 v[56:59], v[28:31], a[88:95], v2
  v_smfmac_f32_16x16x64_bf16 v[52:55], v[28:31], a[80:87], v2
  v_smfmac_f32_16x16x64_bf16 v[60:63], v[28:31], a[96:103], v2
  s_waitcnt lgkmcnt(0)
  v_smfmac_f32_16x16x64_bf16 v[48:51], v[24:27], a[120:127], v2
  v_smfmac_f32_16x16x64_bf16 v[56:59], v[24:27], a[136:143], v2
  v_smfmac_f32_16x16x64_bf16 v[52:55], v[24:27], a[128:135], v2
  v_smfmac_f32_16x16x64_bf16 v[60:63], v[24:27], a[144:151], v2
  v_pk_add_f32 v[48:49], v[48:49], v[50:51]
  v_pk_add_f32 v[56:57], v[56:57], v[58:59]
  v_pk_mul_f32 v[48:49], v[48:49], s[78:79]
  v_cvt_pk_bf16_f32 v56, v56, v57
  v_cvt_pk_bf16_f32 v57, v48, v49
  ds_write_b64 v7, v[56:57]
  v_pk_add_f32 v[52:53], v[52:53], v[54:55]
  v_pk_add_f32 v[60:61], v[60:61], v[62:63]
  v_pk_mul_f32 v[52:53], v[52:53], s[78:79]
  v_cvt_pk_bf16_f32 v58, v60, v61
  v_cvt_pk_bf16_f32 v59, v52, v53
  ds_write_b64 v7, v[58:59] offset:512
  v_smfmac_f32_16x16x64_bf16 v[64:67], v[28:31], a[104:111], v2
  v_smfmac_f32_16x16x64_bf16 v[68:71], v[28:31], a[112:119], v2
  v_smfmac_f32_16x16x64_bf16 v[64:67], v[24:27], v[32:39], v2
  v_smfmac_f32_16x16x64_bf16 v[68:71], v[24:27], v[40:47], v2
  s_waitcnt lgkmcnt(0)
  s_barrier
  ds_read_b64_tr_b16 v[32:33], v6 offset:0
  ds_read_b64_tr_b16 v[34:35], v6 offset:512
  ds_read_b64_tr_b16 v[36:37], v6 offset:1024
  ds_read_b64_tr_b16 v[38:39], v6 offset:1536
  ds_read_b64_tr_b16 v[40:41], v6 offset:2048
  ds_read_b64_tr_b16 v[42:43], v6 offset:2560
  ds_read_b64_tr_b16 v[44:45], v6 offset:3072
  ds_read_b64_tr_b16 v[46:47], v6 offset:3584
  ds_read_b128 v[24:27], v11 offset:23552
  ds_read_b128 v[28:31], v11 offset:24576
  ds_read_b128 v[12:15], v11 offset:25600
  v_pk_add_f32 v[64:65], v[64:65], v[66:67]
  v_pk_add_f32 v[68:69], v[68:69], v[70:71]
  v_cvt_pk_bf16_f32 v57, v64, v65
  v_cvt_pk_bf16_f32 v59, v68, v69
  v_cvt_pk_bf16_f32 v64, v64, v65
  v_cvt_pk_bf16_f32 v66, v68, v69
  v_mov_b32 v65, 0
  v_mov_b32 v67, 0
  s_waitcnt lgkmcnt(3)
  v_mfma_f32_16x16x32_bf16 v[48:51], v[32:35], v[32:35], 0
  v_mov_b32 v68, 0x3f803f80
  v_mfma_f32_16x16x32_bf16 v[48:51], v[36:39], v[36:39], v[48:51]
  v_mov_b32 v69, 0x3f803f80
  buffer_store_dwordx4 v[56:59], v1, s[48:51], s27 offen sc1
  v_mfma_f32_16x16x32_bf16 v[48:51], v[40:43], v[40:43], v[48:51]
  v_mov_b32 v70, 0x3f803f80
  v_mfma_f32_16x16x32_bf16 v[48:51], v[44:47], v[44:47], v[48:51]
  v_mov_b32 v71, 0x3f803f80
  s_waitcnt lgkmcnt(2)
  v_mfma_f32_16x16x32_bf16 v[52:55], v[24:27], v[32:35], 0
  ds_read_b128 v[24:27], v11 offset:26624
  s_waitcnt lgkmcnt(2)
  v_mfma_f32_16x16x32_bf16 v[52:55], v[28:31], v[36:39], v[52:55]
  ds_read_b128 v[28:31], v11 offset:27648
  s_waitcnt lgkmcnt(2)
  v_mfma_f32_16x16x32_bf16 v[52:55], v[12:15], v[40:43], v[52:55]
  ds_read_b128 v[12:15], v11 offset:28672
  s_waitcnt lgkmcnt(2)
  v_mfma_f32_16x16x32_bf16 v[52:55], v[24:27], v[44:47], v[52:55]
  ds_read_b128 v[24:27], v11 offset:29696
  s_waitcnt lgkmcnt(2)
  v_mfma_f32_16x16x32_bf16 v[60:63], v[28:31], v[32:35], 0
  ds_read_b128 v[28:31], v11 offset:30720
  s_waitcnt lgkmcnt(2)
  v_mfma_f32_16x16x32_bf16 v[60:63], v[12:15], v[36:39], v[60:63]
  s_waitcnt lgkmcnt(1)
  v_mfma_f32_16x16x32_bf16 v[60:63], v[24:27], v[40:43], v[60:63]
  s_add_u32 s27, s27, 131072
  s_waitcnt lgkmcnt(0)
  v_mfma_f32_16x16x32_bf16 v[60:63], v[28:31], v[44:47], v[60:63]
  ds_read_b128 v[40:43], v5 offset:0
  ds_read_b128 v[44:47], v5 offset:1024
  v_max3_f32 v24, |v48|, |v49|, |v52|
  v_max3_f32 v25, |v53|, |v54|, |v55|
  s_nop 3
  v_max3_f32 v24, v24, |v60|, |v61|
  v_max3_f32 v25, v25, |v62|, |v63|
  v_max_f32 v24, v24, v25
  v_cmp_ngt_f32 vcc, s83, v24
  s_and_b64 vcc, vcc, s[84:85]
  s_cbranch_scc1 L_tmax_s
L_tmaxr_s:
  v_exp_f32 v48, v48
  v_exp_f32 v49, v49
  v_exp_f32 v52, v52
  v_exp_f32 v53, v53
  v_exp_f32 v54, v54
  v_exp_f32 v55, v55
  v_exp_f32 v60, v60
  v_exp_f32 v61, v61
  v_exp_f32 v62, v62
  v_exp_f32 v63, v63
  v_mov_b32 v33, 0
  v_cvt_pk_bf16_f32 v32, v48, v49
  v_cvt_pk_bf16_f32 v36, v52, v53
  v_cvt_pk_bf16_f32 v37, v54, v55
  v_cvt_pk_bf16_f32 v38, v60, v61
  v_cvt_pk_bf16_f32 v39, v62, v63
  s_waitcnt vmcnt(2)
  s_nop 0
  v_mfma_f32_16x16x32_bf16 v[28:31], v[68:71], v[36:39], 0
  v_mfma_f32_16x16x32_bf16 v[48:51], v[16:19], v[36:39], 0
  ds_read_b128 v[56:59], v5 offset:8192
  v_mfma_f32_16x16x32_bf16 v[52:55], v[20:23], v[36:39], 0
  ds_read_b128 v[60:63], v5 offset:9216
  v_mfma_f32_16x16x16_bf16 v[28:31], v[68:69], v[32:33], v[28:31]
  v_mfma_f32_16x16x16_bf16 v[48:51], v[64:65], v[32:33], v[48:51]
  v_mfma_f32_16x16x16_bf16 v[52:55], v[66:67], v[32:33], v[52:55]
  v_mov_b64 v[12:13], 0
  v_mov_b64 v[14:15], 0
  v_mov_b64 v[16:17], 0
  v_mov_b64 v[18:19], 0
  s_nop 1
  v_rcp_f32 v24, v28
  v_mov_b64 v[20:21], 0
  v_pk_mul_f32 v[48:49], v[48:49], v[24:25] op_sel_hi:[1,0]
  v_pk_mul_f32 v[50:51], v[50:51], v[24:25] op_sel_hi:[1,0]
  v_pk_mul_f32 v[52:53], v[52:53], v[24:25] op_sel_hi:[1,0]
  v_pk_mul_f32 v[54:55], v[54:55], v[24:25] op_sel_hi:[1,0]
  v_cvt_pk_bf16_f32 v48, v48, v49
  v_cvt_pk_bf16_f32 v49, v50, v51
  ds_write_b64 v8, v[48:49]
  v_cvt_pk_bf16_f32 v52, v52, v53
  v_cvt_pk_bf16_f32 v53, v54, v55
  ds_write_b64 v8, v[52:53] offset:512
  v_mov_b64 v[22:23], 0
  v_mov_b64 v[24:25], 0
  v_mov_b64 v[26:27], 0
  v_mov_b64 v[28:29], 0
  v_mov_b64 v[30:31], 0
  v_mov_b64 v[64:65], 0
  v_mov_b64 v[66:67], 0
  v_mov_b64 v[68:69], 0
  v_mov_b64 v[70:71], 0
  s_add_u32 m0, s30, s30
  s_add_u32 m0, m0, 154624
  s_waitcnt lgkmcnt(0)
  s_barrier
  ds_read_b128 v[32:35], v11 offset:21504
  ds_read_b128 v[36:39], v11 offset:22528
  buffer_load_dwordx4 v1, s[48:51], s24 offen sc1 lds
  buffer_load_dwordx4 v1, s[48:51], s24 offen offset:1024 sc1 lds
  v_mov_b64 v[48:49], 0
  v_mov_b64 v[50:51], 0
  v_mov_b64 v[52:53], 0
  v_mov_b64 v[54:55], 0
  s_add_u32 s24, s24, 262144
  s_waitcnt lgkmcnt(0)
  v_smfmac_f32_16x16x64_bf16 v[16:19], v[32:35], a[152:159], v2
  v_smfmac_f32_16x16x64_bf16 v[16:19], v[36:39], a[160:167], v2
  v_smfmac_f32_16x16x64_bf16 v[20:23], v[32:35], a[168:175], v2
  v_smfmac_f32_16x16x64_bf16 v[20:23], v[36:39], v[40:47], v2
  ds_read_b128 v[40:43], v5 offset:16384
  v_pk_add_f32 v[16:17], v[16:17], v[18:19]
  v_cvt_pk_bf16_f32 v16, v16, v17
  v_smfmac_f32_16x16x64_bf16 v[24:27], v[32:35], a[176:183], v2
  buffer_store_dword v16, v9, s[48:51], s32 offen sc1
  v_smfmac_f32_16x16x64_bf16 v[24:27], v[36:39], a[184:191], v2
  ds_read_b128 v[44:47], v5 offset:17408
  v_pk_add_f32 v[20:21], v[20:21], v[22:23]
  v_cvt_pk_bf16_f32 v20, v20, v21
  v_smfmac_f32_16x16x64_bf16 v[28:31], v[32:35], a[192:199], v2
  buffer_store_dword v20, v9, s[48:51], s33 offen sc1
  v_smfmac_f32_16x16x64_bf16 v[28:31], v[36:39], v[56:63], v2
  ds_read_b128 v[56:59], v5 offset:24576
  v_pk_add_f32 v[24:25], v[24:25], v[26:27]
  v_cvt_pk_bf16_f32 v24, v24, v25
  v_smfmac_f32_16x16x64_bf16 v[68:71], v[32:35], a[200:207], v2
  buffer_store_dword v24, v9, s[48:51], s34 offen sc1
  v_smfmac_f32_16x16x64_bf16 v[68:71], v[36:39], a[208:215], v2
  ds_read_b128 v[60:63], v5 offset:25600
  v_pk_add_f32 v[28:29], v[28:29], v[30:31]
  v_cvt_pk_bf16_f32 v28, v28, v29
  v_smfmac_f32_16x16x64_bf16 v[64:67], v[32:35], a[216:223], v2
  buffer_store_dword v28, v9, s[48:51], s35 offen sc1
  s_waitcnt lgkmcnt(2)
  v_smfmac_f32_16x16x64_bf16 v[64:67], v[36:39], v[40:47], v2
  ds_read_b128 v[40:43], v5 offset:32768
  v_pk_add_f32 v[68:69], v[68:69], v[70:71]
  v_cvt_pk_bf16_f32 v68, v68, v69
  v_smfmac_f32_16x16x64_bf16 v[12:15], v[32:35], a[224:231], v2
  buffer_store_dword v68, v9, s[48:51], s36 offen sc1
  v_smfmac_f32_16x16x64_bf16 v[12:15], v[36:39], a[232:239], v2
  ds_read_b128 v[44:47], v5 offset:33792
  v_pk_add_f32 v[64:65], v[64:65], v[66:67]
  v_cvt_pk_bf16_f32 v64, v64, v65
  v_smfmac_f32_16x16x64_bf16 v[48:51], v[32:35], a[240:247], v2
  buffer_store_dword v64, v9, s[48:51], s37 offen sc1
  s_waitcnt lgkmcnt(2)
  v_smfmac_f32_16x16x64_bf16 v[48:51], v[36:39], v[56:63], v2
  v_pk_add_f32 v[12:13], v[12:13], v[14:15]
  v_cvt_pk_bf16_f32 v12, v12, v13
  v_smfmac_f32_16x16x64_bf16 v[52:55], v[32:35], a[248:255], v2
  s_waitcnt lgkmcnt(0)
  v_smfmac_f32_16x16x64_bf16 v[52:55], v[36:39], v[40:47], v2
  buffer_store_dword v12, v9, s[48:51], s38 offen sc1
  v_pk_add_f32 v[48:49], v[48:49], v[50:51]
  v_cvt_pk_bf16_f32 v48, v48, v49
  buffer_store_dword v48, v9, s[48:51], s39 offen sc1
  s_nop 5
  v_pk_add_f32 v[52:53], v[52:53], v[54:55]
  v_cvt_pk_bf16_f32 v52, v52, v53
  buffer_store_dword v52, v9, s[48:51], s40 offen sc1
  s_cmp_eq_u32 s75, -1
  s_cbranch_scc1 L_nonred_s
  ds_read_b128 v[68:71], v11 offset:31744
  s_add_u32 s72, s16, 4096
  s_waitcnt vmcnt(7)
  s_cmp_lt_u32 s75, 16
  s_cbranch_scc1 L_poll1_s
  s_waitcnt vmcnt(3)
  s_cmp_lt_u32 s75, 20
  s_cbranch_scc1 L_poll1_s
  s_waitcnt vmcnt(0)
L_poll1_s:
  buffer_load_dwordx4 v[16:19], v1, s[48:51], s16 offen offset:0 sc1
  buffer_load_dwordx4 v[20:23], v1, s[48:51], s16 offen offset:1024 sc1
  buffer_load_dwordx4 v[24:27], v1, s[48:51], s16 offen offset:2048 sc1
  buffer_load_dwordx4 v[28:31], v1, s[48:51], s16 offen offset:3072 sc1
  buffer_load_dwordx4 v[32:35], v1, s[48:51], s72 offen offset:0 sc1
  buffer_load_dwordx4 v[36:39], v1, s[48:51], s72 offen offset:1024 sc1
  buffer_load_dwordx4 v[40:43], v1, s[48:51], s72 offen offset:2048 sc1
  buffer_load_dwordx4 v[44:47], v1, s[48:51], s72 offen offset:3072 sc1
  s_add_u32 s20, s20, 65536
  s_and_b32 s20, s20, 0x3ffff
  s_add_u32 s71, s20, s77
  s_add_u32 s21, s71, s30
  s_mov_b32 s26, s71
  s_add_u32 s70, s70, 1
  s_add_u32 s22, s21, 4096
  s_lshr_b32 s4, s30, 2
  s_add_u32 s23, s71, s4
  s_add_u32 s23, s23, 8192
  s_add_u32 s73, s4, 147456
  s_xor_b32 s18, s18, s19
  s_mov_b32 s32, s18
  s_add_u32 s33, s18, 32768
  s_add_u32 s34, s18, 65536
  s_add_u32 s35, s18, 98304
  s_add_u32 s36, s18, 131072
  s_add_u32 s37, s18, 163840
  s_add_u32 s38, s18, 196608
  s_add_u32 s39, s18, 229376
  s_add_u32 s40, s18, 262144
  s_xor_b32 s41, s41, s86
  s_xor_b32 s42, s42, s87
  s_add_u32 s25, s25, 262144
  s_add_u32 s4, s70, 1
  s_lshr_b32 s4, s4, 1
  s_min_u32 s80, s4, 31
  s_add_u32 s5, s20, 655360
  s_add_u32 s6, s5, 18944
  s_xor_b32 s4, s20, 0x20000
  s_add_u32 s43, s4, 655360
  s_add_u32 s31, s43, 18944
  v_mov_b64 v[48:49], 0
  v_mov_b64 v[50:51], 0
  v_mov_b64 v[52:53], 0
  v_mov_b64 v[54:55], 0
  v_mov_b64 v[56:57], 0
  v_mov_b64 v[58:59], 0
  v_mov_b64 v[60:61], 0
  v_mov_b64 v[62:63], 0
  v_mov_b32 v13, -1
  s_waitcnt lgkmcnt(0)
L_w1_s:
  s_waitcnt vmcnt(7)
  v_mfma_f32_16x16x32_bf16 v[64:67], v[16:19], v[68:71], 0
  s_waitcnt vmcnt(6)
  v_mfma_f32_16x16x32_bf16 v[64:67], v[20:23], v[68:71], v[64:67]
  s_waitcnt vmcnt(5)
  v_mfma_f32_16x16x32_bf16 v[64:67], v[24:27], v[68:71], v[64:67]
  v_max3_u32 v12, v16, v20, v24
  s_waitcnt vmcnt(4)
  v_mfma_f32_16x16x32_bf16 v[64:67], v[28:31], v[68:71], v[64:67]
  s_waitcnt vmcnt(3)
  v_mfma_f32_16x16x32_bf16 v[64:67], v[32:35], v[68:71], v[64:67]
  v_max3_u32 v12, v28, v32, v12
  s_waitcnt vmcnt(2)
  v_mfma_f32_16x16x32_bf16 v[64:67], v[36:39], v[68:71], v[64:67]
  s_waitcnt vmcnt(1)
  v_mfma_f32_16x16x32_bf16 v[64:67], v[40:43], v[68:71], v[64:67]
  v_max3_u32 v12, v36, v40, v12
  s_waitcnt vmcnt(0)
  v_mfma_f32_16x16x32_bf16 v[64:67], v[44:47], v[68:71], v[64:67]
  v_max_u32 v12, v12, v44
  v_cmp_eq_u32 vcc, -1, v12
  s_cbranch_vccnz L_retry1_s
  s_xor_b32 s16, s16, s17
  s_nop 3
  v_cvt_pk_bf16_f32 v64, v64, v65
  v_cvt_pk_bf16_f32 v65, v66, v67
  buffer_store_dwordx2 v[64:65], v10, s[48:51], s5 offen sc1
  buffer_load_dwordx4 v[24:27], v1, s[48:51], s21 offen sc1
  ds_read_b128 v[32:35], v3 offset:0
  ds_read_b128 v[36:39], v3 offset:1024
  ds_read_b128 v[40:43], v3 offset:2048
  ds_read_b128 v[44:47], v3 offset:3072
  v_mov_b64 v[64:65], 0
  v_mov_b64 v[66:67], 0
  v_mov_b64 v[68:69], 0
  v_mov_b64 v[70:71], 0
  s_branch L_common_s
L_nonred_s:
  s_add_u32 s20, s20, 65536
  s_and_b32 s20, s20, 0x3ffff
  s_add_u32 s71, s20, s77
  s_add_u32 s21, s71, s30
  s_mov_b32 s26, s71
  s_add_u32 s70, s70, 1
  s_add_u32 s22, s21, 4096
  s_lshr_b32 s4, s30, 2
  s_add_u32 s23, s71, s4
  s_add_u32 s23, s23, 8192
  s_add_u32 s73, s4, 147456
  s_xor_b32 s18, s18, s19
  s_mov_b32 s32, s18
  s_add_u32 s33, s18, 32768
  s_add_u32 s34, s18, 65536
  s_add_u32 s35, s18, 98304
  s_add_u32 s36, s18, 131072
  s_add_u32 s37, s18, 163840
  s_add_u32 s38, s18, 196608
  s_add_u32 s39, s18, 229376
  s_add_u32 s40, s18, 262144
  s_xor_b32 s41, s41, s86
  s_xor_b32 s42, s42, s87
  s_add_u32 s25, s25, 262144
  s_add_u32 s4, s70, 1
  s_lshr_b32 s4, s4, 1
  s_min_u32 s80, s4, 31
L_book_s:
  v_mov_b64 v[48:49], 0
  v_mov_b64 v[50:51], 0
  v_mov_b64 v[52:53], 0
  v_mov_b64 v[54:55], 0
  v_mov_b64 v[56:57], 0
  v_mov_b64 v[58:59], 0
  v_mov_b64 v[60:61], 0
  v_mov_b64 v[62:63], 0
  v_mov_b64 v[64:65], 0
  v_mov_b64 v[66:67], 0
  v_mov_b64 v[68:69], 0
  v_mov_b64 v[70:71], 0
  ds_read_b128 v[32:35], v3 offset:0
  ds_read_b128 v[36:39], v3 offset:1024
  ds_read_b128 v[40:43], v3 offset:2048
  ds_read_b128 v[44:47], v3 offset:3072
  buffer_load_dwordx4 v[24:27], v1, s[48:51], s21 offen sc1
  s_branch L_common_s
L_common_sz:
  v_add_u32 v14, s30, v11
  v_add_u32 v15, s73, v9
  v_mov_b32 v13, -1
  s_cmp_ge_u32 s80, s81
  s_cbranch_scc1 L_flslow_sz
L_fl_ok_sz:
L_pA0_sz:
  s_waitcnt vmcnt(0)
  v_cmp_eq_u32 vcc, -1, v24
  s_cbranch_vccnz L_pA0f_sz
  ds_write_b128 v14, v[24:27] offset:8192
  buffer_load_dwordx4 v[16:19], v1, s[48:51], s22 offen sc1
  buffer_load_dword v20, v9, s[48:51], s23 offen sc1
L_pAdone_sz:
  s_waitcnt lgkmcnt(0)
  s_barrier
  ds_read_b128 v[24:27], v11 offset:8192
  ds_read_b128 v[28:31], v11 offset:9216
  s_waitcnt lgkmcnt(1)
  v_smfmac_f32_16x16x64_bf16 v[56:59], v[24:27], v[72:79], v2
  v_smfmac_f32_16x16x64_bf16 v[60:63], v[24:27], v[80:87], v2
  v_smfmac_f32_16x16x64_bf16 v[64:67], v[24:27], v[88:95], v2
  v_smfmac_f32_16x16x64_bf16 v[68:71], v[24:27], v[96:103], v2
  s_waitcnt lgkmcnt(0)
  v_smfmac_f32_16x16x64_bf16 v[56:59], v[28:31], v[120:127], v2
  ds_read_b128 v[24:27], v11 offset:10240
  v_smfmac_f32_16x16x64_bf16 v[60:63], v[28:31], v[128:135], v2
  ds_read_b128 v[40:43], v3 offset:18432
  v_smfmac_f32_16x16x64_bf16 v[64:67], v[28:31], v[136:143], v2
  ds_read_b128 v[44:47], v3 offset:19456
  v_smfmac_f32_16x16x64_bf16 v[68:71], v[28:31], v[144:151], v2
  ds_read_b128 v[32:35], v3 offset:16384
  ds_read_b128 v[36:39], v3 offset:17408
  s_waitcnt vmcnt(0)
L_chkB_sz:
  v_max_u32 v22, v16, v20
  v_cmp_eq_u32 vcc, -1, v22
  s_cbranch_vccnz L_retryB_sz
  s_waitcnt lgkmcnt(4)
  v_smfmac_f32_16x16x64_bf16 v[64:67], v[24:27], v[168:175], v2
  ds_write_b128 v14, v[16:19] offset:12288
  s_waitcnt lgkmcnt(1)
  v_smfmac_f32_16x16x64_bf16 v[56:59], v[24:27], v[32:39], v2
  ds_write_b32 v15, v20
  v_smfmac_f32_16x16x64_bf16 v[68:71], v[24:27], v[176:183], v2
  ds_read_b128 v[28:31], v11 offset:11264
  v_smfmac_f32_16x16x64_bf16 v[60:63], v[24:27], v[40:47], v2
  ds_read_b128 v[40:43], v3 offset:34816
  ds_read_b128 v[44:47], v3 offset:35840
  ds_read_b128 v[32:35], v3 offset:32768
  ds_read_b128 v[36:39], v3 offset:33792
  s_waitcnt lgkmcnt(5)
  s_barrier
  v_sub_u32 v14, 0, v1
  v_mov_b32 v15, s70
  s_waitcnt lgkmcnt(4)
  v_smfmac_f32_16x16x64_bf16 v[56:59], v[28:31], v[200:207], v2
  ds_read_b128 v[24:27], v11 offset:12288
  s_waitcnt lgkmcnt(1)
  v_smfmac_f32_16x16x64_bf16 v[64:67], v[28:31], v[32:39], v2
  ds_read_b128 v[32:35], v4 offset:0
  v_smfmac_f32_16x16x64_bf16 v[60:63], v[28:31], v[208:215], v2
  ds_read_b128 v[36:39], v4 offset:1024
  v_smfmac_f32_16x16x64_bf16 v[68:71], v[28:31], v[40:47], v2
  ds_read_b128 v[40:43], v4 offset:2048
  s_waitcnt lgkmcnt(3)
  v_smfmac_f32_16x16x64_bf16 v[56:59], v[24:27], v[232:239], v2
  ds_read_b128 v[28:31], v11 offset:13312
  v_smfmac_f32_16x16x64_bf16 v[60:63], v[24:27], v[240:247], v2
  ds_read_b128 v[44:47], v4 offset:3072
  v_smfmac_f32_16x16x64_bf16 v[64:67], v[24:27], v[248:255], v2
  buffer_store_dword v15, v14, s[48:51], s29 offen sc1
  v_smfmac_f32_16x16x64_bf16 v[68:71], v[24:27], a[0:7], v2
  s_waitcnt lgkmcnt(1)
  v_smfmac_f32_16x16x64_bf16 v[56:59], v[28:31], a[8:15], v2
  ds_read_b128 v[24:27], v11 offset:14336
  v_smfmac_f32_16x16x64_bf16 v[60:63], v[28:31], a[16:23], v2
  v_smfmac_f32_16x16x64_bf16 v[64:67], v[28:31], a[24:31], v2
  v_smfmac_f32_16x16x64_bf16 v[68:71], v[28:31], a[32:39], v2
  s_waitcnt lgkmcnt(0)
  v_smfmac_f32_16x16x64_bf16 v[64:67], v[24:27], a[56:63], v2
  ds_read_b128 v[28:31], v11 offset:15360
  v_smfmac_f32_16x16x64_bf16 v[56:59], v[24:27], v[32:39], v2
  ds_read_b128 v[32:35], v4 offset:16384
  v_smfmac_f32_16x16x64_bf16 v[68:71], v[24:27], a[64:71], v2
  ds_read_b128 v[36:39], v4 offset:17408
  v_smfmac_f32_16x16x64_bf16 v[60:63], v[24:27], v[40:47], v2
  ds_read_b128 v[40:43], v4 offset:18432
  s_waitcnt lgkmcnt(3)
  v_smfmac_f32_16x16x64_bf16 v[56:59], v[28:31], a[88:95], v2
  ds_read_b128 v[24:27], v11 offset:16384
  v_smfmac_f32_16x16x64_bf16 v[60:63], v[28:31], a[96:103], v2
  ds_read_b128 v[44:47], v4 offset:19456
  s_waitcnt lgkmcnt(1)
  v_smfmac_f32_16x16x64_bf16 v[56:59], v[24:27], a[136:143], v2
  v_smfmac_f32_16x16x64_bf16 v[60:63], v[24:27], a[144:151], v2
  v_smfmac_f32_16x16x64_bf16 v[64:67], v[28:31], a[104:111], v2
  v_smfmac_f32_16x16x64_bf16 v[68:71], v[28:31], a[112:119], v2
  s_nop 1
  s_waitcnt lgkmcnt(0)
  v_smfmac_f32_16x16x64_bf16 v[64:67], v[24:27], v[32:39], v2
  v_smfmac_f32_16x16x64_bf16 v[68:71], v[24:27], v[40:47], v2
  s_nop 7
  v_pk_add_f32 v[56:57], v[56:57], v[58:59]
  v_pk_add_f32 v[60:61], v[60:61], v[62:63]
  v_cvt_pk_bf16_f32 v56, v56, v57
  v_cvt_pk_bf16_f32 v58, v60, v61
  v_pk_add_f32 v[64:65], v[64:65], v[66:67]
  v_pk_add_f32 v[68:69], v[68:69], v[70:71]
  v_cvt_pk_bf16_f32 v57, v64, v65
  v_cvt_pk_bf16_f32 v59, v68, v69
  buffer_store_dwordx4 v[56:59], v1, s[48:51], s27 offen sc1
  s_branch L_chain_last
L_pA0f_s:
  s_add_u32 s47, s47, 1
  s_cmp_gt_u32 s47, 131072
  s_cbranch_scc1 L_exit
  buffer_load_dwordx4 v[24:27], v1, s[48:51], s21 offen sc1
  s_branch L_pA0_s
L_retryB_s:
  s_add_u32 s47, s47, 1
  s_cmp_gt_u32 s47, 131072
  s_cbranch_scc1 L_exit
  buffer_load_dwordx4 v[16:19], v1, s[48:51], s22 offen sc1
  buffer_load_dword v20, v9, s[48:51], s23 offen sc1
  s_waitcnt vmcnt(0)
  s_branch L_chkB_s
L_flslow_s:
L_kvr_135:
  v_lshlrev_b32 v22, 3, v1
  v_and_b32 v22, 0xf80, v22
  s_mov_b32 s4, 0
  buffer_load_dword v22, v22, s[48:51], s4 offen sc1
  s_waitcnt vmcnt(0)
  v_cmp_le_u32 vcc, 32, v22
  s_nop 1
  s_not_b32 s4, vcc_lo
  s_ff1_i32_b32 s4, s4
  s_cmp_eq_u32 s4, -1
  s_cselect_b32 s81, 32, s4
  s_cmp_gt_u32 s81, s80
  s_cbranch_scc1 L_kvd_136
  s_sleep 4
  s_add_u32 s47, s47, 1
  s_cmp_gt_u32 s47, 131072
  s_cbranch_scc1 L_exit
  s_branch L_kvr_135
L_kvd_136:
  s_branch L_fl_ok_s
L_tmax_s:
  v_max3_f32 v24, v48, v49, v52
  v_max3_f32 v25, v53, v54, v55
  v_max3_f32 v24, v24, v60, v61
  v_max3_f32 v25, v25, v62, v63
  v_max_f32 v24, v24, v25
  v_mov_b32 v25, v24
  s_nop 1
  v_permlane16_swap_b32 v24, v25
  s_nop 0
  v_max_f32 v24, v24, v25
  v_mov_b32 v25, v24
  s_nop 1
  v_permlane32_swap_b32 v24, v25
  s_nop 0
  v_max_f32 v24, v24, v25
  v_pk_add_f32 v[48:49], v[48:49], v[24:25] op_sel_hi:[1,0] neg_lo:[0,1] neg_hi:[0,1]
  v_pk_add_f32 v[52:53], v[52:53], v[24:25] op_sel_hi:[1,0] neg_lo:[0,1] neg_hi:[0,1]
  v_pk_add_f32 v[54:55], v[54:55], v[24:25] op_sel_hi:[1,0] neg_lo:[0,1] neg_hi:[0,1]
  v_pk_add_f32 v[60:61], v[60:61], v[24:25] op_sel_hi:[1,0] neg_lo:[0,1] neg_hi:[0,1]
  v_pk_add_f32 v[62:63], v[62:63], v[24:25] op_sel_hi:[1,0] neg_lo:[0,1] neg_hi:[0,1]
  s_branch L_tmaxr_s
L_retry1_s:
  s_add_u32 s47, s47, 1
  s_cmp_gt_u32 s47, 131072
  s_cbranch_scc1 L_exit
  buffer_load_dwordx4 v[16:19], v1, s[48:51], s16 offen offset:0 sc1
  buffer_load_dwordx4 v[20:23], v1, s[48:51], s16 offen offset:1024 sc1
  buffer_load_dwordx4 v[24:27], v1, s[48:51], s16 offen offset:2048 sc1
  buffer_load_dwordx4 v[28:31], v1, s[48:51], s16 offen offset:3072 sc1
  buffer_load_dwordx4 v[32:35], v1, s[48:51], s72 offen offset:0 sc1
  buffer_load_dwordx4 v[36:39], v1, s[48:51], s72 offen offset:1024 sc1
  buffer_load_dwordx4 v[40:43], v1, s[48:51], s72 offen offset:2048 sc1
  buffer_load_dwordx4 v[44:47], v1, s[48:51], s72 offen offset:3072 sc1
  s_branch L_w1_s
L_pA0f_sz:
  s_add_u32 s47, s47, 1
  s_cmp_gt_u32 s47, 131072
  s_cbranch_scc1 L_exit
  buffer_load_dwordx4 v[24:27], v1, s[48:51], s21 offen sc1
  s_branch L_pA0_sz
L_retryB_sz:
  s_add_u32 s47, s47, 1
  s_cmp_gt_u32 s47, 131072
  s_cbranch_scc1 L_exit
  buffer_load_dwordx4 v[16:19], v1, s[48:51], s22 offen sc1
  buffer_load_dword v20, v9, s[48:51], s23 offen sc1
  s_waitcnt vmcnt(0)
  s_branch L_chkB_sz
L_flslow_sz:
L_kvr_137:
  v_lshlrev_b32 v22, 3, v1
  v_and_b32 v22, 0xf80, v22
  s_mov_b32 s4, 0
  buffer_load_dword v22, v22, s[48:51], s4 offen sc1
  s_waitcnt vmcnt(0)
  v_cmp_le_u32 vcc, 32, v22
  s_nop 1
  s_not_b32 s4, vcc_lo
  s_ff1_i32_b32 s4, s4
  s_cmp_eq_u32 s4, -1
  s_cselect_b32 s81, 32, s4
  s_cmp_gt_u32 s81, s80
  s_cbranch_scc1 L_kvd_138
  s_sleep 4
  s_add_u32 s47, s47, 1
  s_cmp_gt_u32 s47, 131072
  s_cbranch_scc1 L_exit
  s_branch L_kvr_137
L_kvd_138:
  s_branch L_fl_ok_sz
L_chain_last:
  s_waitcnt vmcnt(0)
  s_barrier
  v_sub_u32 v12, 0, v1
  v_mov_b32 v13, 64
  buffer_store_dword v13, v12, s[48:51], s29 offen sc1
  s_waitcnt vmcnt(0)
L_exit:
  s_endpgm
.section .rodata,"a"
.p2align 6
.amdhsa_kernel gated_mix__memory_aug_recurrent_mem_tr__glu_gated_geglu__prompt_kernel
  .amdhsa_next_free_vgpr 512
  .amdhsa_next_free_sgpr 102
  .amdhsa_accum_offset 256
  .amdhsa_group_segment_fixed_size 0
  .amdhsa_kernarg_size 120
  .amdhsa_user_sgpr_count 2
  .amdhsa_user_sgpr_kernarg_segment_ptr 1
  .amdhsa_system_sgpr_workgroup_id_x 1
.end_amdhsa_kernel
```
